```python
import torch

def _softmax(x, axis=-1):
    return torch.softmax(x, dim=axis)
def _gelu(x):
    return torch.nn.functional.gelu(x, approximate="tanh")
def _silu(x):
    return torch.nn.functional.silu(x)
def _sigmoid(x):
    return torch.sigmoid(x)
def _layernorm(x, axis=-1, eps=1e-5):
    m = x.mean(dim=axis, keepdim=True)
    v = x.var(dim=axis, keepdim=True, unbiased=False)
    return (x - m) / torch.sqrt(v + eps)
def _scatter_add(tgt, idx, src, axis=0):
    return tgt.clone().index_add_(axis, idx, src)
def _segment_sum(src, seg, n):
    out = torch.zeros((n,) + src.shape[1:], dtype=src.dtype)
    return out.index_add_(0, seg, src)
def _pad(x, pw):
    flat = tuple(v for pair in reversed(pw) for v in pair)
    return torch.nn.functional.pad(x, flat)

kernel_name = 'standalone__mha_softmax__near_ridge'

def setup_inputs():

    _w = (lambda a: (lambda t: t.to(torch.bfloat16) if t.is_floating_point() else t)(torch.as_tensor(a)))
    B, H, Sq, Sk, D = 8, 16, 384, 2048, 256
    return {
        "q": _w((lambda *s: torch.randn(*s, dtype=torch.bfloat16) * 0.8)(B, H, Sq, D)),
        "k": _w((lambda *s: torch.randn(*s, dtype=torch.bfloat16) * 0.8)(B, H, Sk, D)),
        "v": _w((lambda *s: torch.randn(*s, dtype=torch.bfloat16) * 0.05)(B, H, Sk, D)),
    }

def reference(q, k, v):
    scale = q.shape[-1] ** -0.5
    scores = torch.einsum("bhqd,bhkd->bhqk", q, k) * scale
    p = _softmax(scores, axis=-1)
    return torch.einsum("bhqk,bhkd->bhqd", p, v)
```

```asm
; @launch grid=(256,1,1) block=(256,1,1) lds=135168
.amdgcn_target "amdgcn-amd-amdhsa--gfx950"
.text
.globl standalone__mha_softmax__near_ridge_kernel
.p2align 8
.type standalone__mha_softmax__near_ridge_kernel,@function
standalone__mha_softmax__near_ridge_kernel:
    s_cmp_ge_u32 s2, 256
    s_cbranch_scc1 L_end
    s_load_dwordx4 s[4:7], s[0:1], 0
    s_load_dwordx4 s[8:11], s[0:1], 16
    s_getpc_b64 s[34:35]
L_pc:
    v_lshlrev_b32 v12, 7, v0
    v_min_u32 v12, L_code_end-L_pc-4, v12
    global_load_dword v108, v12, s[34:35]
    v_lshrrev_b32 v14, 6, v0
    v_and_b32 v13, 63, v0
    v_readfirstlane_b32 s20, v14
    s_and_b32 s30, s2, 7
    s_lshl_b32 s30, s30, 4
    s_lshr_b32 s31, s2, 4
    s_add_u32 s30, s30, s31
    s_bfe_u32 s31, s2, 0x10003
    s_lshl1_add_u32 s32, s30, s31
    s_lshl2_add_u32 s32, s32, s20
    s_mul_i32 s32, s32, 24576
    s_lshl_b32 s30, s30, 20
    v_and_b32 v12, 15, v0
    v_and_b32 v5, 48, v0
    v_lshrrev_b32 v16, 3, v13
    v_and_b32 v15, 7, v13
    v_xor_b32 v15, v15, v16
    v_lshlrev_b32 v15, 4, v15
    v_lshl_add_u32 v15, v16, 9, v15
    v_lshlrev_b32 v3, 4, v13
    v_lshlrev_b32 v17, 4, v13
    v_lshl_add_u32 v3, v14, 13, v3
    v_add_u32 v4, 4096, v3
    s_mul_i32 s23, s20, 8448
    s_mov_b32 s21, 0
    s_movk_i32 s27, 8192
    s_movk_i32 s28, 16384
    s_movk_i32 s14, 24576
    s_mov_b32 s15, 0x20000
    s_waitcnt lgkmcnt(0)
    s_add_u32 s12, s4, s32
    s_addc_u32 s13, s5, 0
    s_add_u32 s4, s6, s30
    s_addc_u32 s5, s7, 0
    s_mov_b32 s6, 1048576
    s_mov_b32 s7, 0x20000
    s_add_u32 m0, s23, 0
    s_nop 0
    buffer_load_dwordx4 v3, s[4:7], s21 offen offset:0 nt lds
    s_add_u32 m0, s23, 32
    s_nop 0
    buffer_load_dwordx4 v3, s[4:7], s21 offen offset:1024 nt lds
    s_add_u32 m0, s23, 64
    s_nop 0
    buffer_load_dwordx4 v3, s[4:7], s21 offen offset:2048 nt lds
    s_add_u32 m0, s23, 96
    s_nop 0
    buffer_load_dwordx4 v3, s[4:7], s21 offen offset:3072 nt lds
    s_add_u32 s16, s10, s32
    s_addc_u32 s17, s11, 0
    s_add_u32 s8, s8, s30
    s_addc_u32 s9, s9, 0
    s_mov_b32 s10, 1048576
    s_mov_b32 s11, 0x20000
    s_mov_b32 s33, 524288
    buffer_load_dwordx4 v[132:135], v17, s[8:11], s33 offen offset:0
    buffer_load_dwordx4 v[136:139], v17, s[8:11], s33 offen offset:1024
    buffer_load_dwordx4 v[140:143], v17, s[8:11], s33 offen offset:2048
    buffer_load_dwordx4 v[144:147], v17, s[8:11], s33 offen offset:3072
    s_add_u32 m0, s23, 4224
    s_nop 0
    buffer_load_dwordx4 v4, s[4:7], s21 offen offset:0 nt lds
    s_add_u32 m0, s23, 4256
    s_nop 0
    buffer_load_dwordx4 v4, s[4:7], s21 offen offset:1024 nt lds
    s_add_u32 m0, s23, 4288
    s_nop 0
    buffer_load_dwordx4 v4, s[4:7], s21 offen offset:2048 nt lds
    s_add_u32 m0, s23, 4320
    s_nop 0
    buffer_load_dwordx4 v4, s[4:7], s21 offen offset:3072 nt lds
    s_add_u32 s21, s21, 32768
    s_add_u32 m0, s23, 33792
    s_movk_i32 s33, 0
    buffer_load_dwordx4 v15, s[12:15], s33 offen offset:0 nt lds
    s_add_u32 m0, s23, 34816
    s_movk_i32 s33, 4096
    buffer_load_dwordx4 v15, s[12:15], s33 offen offset:0 nt lds
    s_add_u32 m0, s23, 35712
    s_movk_i32 s33, 0
    buffer_load_dwordx4 v15, s[12:15], s33 offen offset:128 nt lds
    s_add_u32 m0, s23, 36736
    s_movk_i32 s33, 4096
    buffer_load_dwordx4 v15, s[12:15], s33 offen offset:128 nt lds
    s_add_u32 m0, s23, 37632
    s_movk_i32 s33, 0
    buffer_load_dwordx4 v15, s[12:15], s33 offen offset:256 nt lds
    s_add_u32 m0, s23, 38656
    s_movk_i32 s33, 4096
    buffer_load_dwordx4 v15, s[12:15], s33 offen offset:256 nt lds
    s_add_u32 m0, s23, 39552
    s_movk_i32 s33, 0
    buffer_load_dwordx4 v15, s[12:15], s33 offen offset:384 nt lds
    s_add_u32 m0, s23, 40576
    s_movk_i32 s33, 4096
    buffer_load_dwordx4 v15, s[12:15], s33 offen offset:384 nt lds
    s_mov_b32 s10, 1048576
    s_mov_b32 s11, 0x20000
    s_mov_b32 s18, 24576
    s_mov_b32 s19, 0x20000
    v_mul_u32_u24 v1, 1056, v12
    v_add_u32 v1, v1, v5
    s_mul_i32 s31, s20, 16896
    v_mul_u32_u24 v25, 18, v5
    v_lshlrev_b32 v24, 3, v12
    v_lshl_add_u32 v24, v25, 1, v24
    v_add_u32 v24, s31, v24
    v_and_b32 v28, 3, v13
    v_lshl_add_u32 v25, v28, 6, v25
    v_lshlrev_b32 v26, 5, v28
    v_and_b32 v28, 12, v13
    v_lshl_add_u32 v25, v28, 1, v25
    v_add_u32 v25, s31, v25
    v_and_b32 v28, 4, v13
    v_lshl_add_u32 v26, v28, 2, v26
    v_lshrrev_b32 v28, 3, v13
    v_lshl_add_u32 v26, v28, 9, v26
    v_add_u32 v27, 4096, v26
    v_accvgpr_write_b32 a164, v24
    v_accvgpr_write_b32 a165, v25
    v_accvgpr_write_b32 a166, v26
    v_accvgpr_write_b32 a167, v27
    v_lshrrev_b32 v12, 2, v13
    v_mul_u32_u24 v2, 1056, v12
    v_and_b32 v12, 3, v13
    v_lshl_add_u32 v2, v12, 3, v2
    v_add_u32 v2, 67584, v2
    s_add_u32 s24, s23, 67584
    s_mov_b32 s22, 0
    s_mov_b32 s29, 0x3db8aa3b
    s_mov_b32 s26, 0x34800000
    s_mov_b32 s25, 15
    s_and_b32 s77, s20, 1
    v_and_b32 v12, 7, v13
    v_lshrrev_b32 v120, 4, v13
    v_xor_b32 v120, v120, v12
    v_lshlrev_b32 v120, 4, v120
    v_and_b32 v12, 15, v13
    v_lshl_add_u32 v120, v12, 7, v120
    v_xor_b32 v121, 64, v120
    s_add_u32 s31, s23, 33792
    v_add_u32 v120, s31, v120
    v_add_u32 v122, 67584, v120
    v_add_u32 v121, s31, v121
    v_add_u32 v123, 67584, v121
    v_mov_b32 v9, 0
    v_mov_b32 v10, 0
    v_mov_b32 v11, 0
    v_mov_b32 v110, s29
    v_mov_b32 v111, s29
    s_bfe_u32 s31, s2, 0x10003
    s_lshl2_add_u32 s31, s31, s20
    s_cmp_lt_u32 s31, 2
    s_cselect_b32 s72, s4, s8
    s_cselect_b32 s73, s5, s9
    s_cselect_b32 s32, 2, 8
    s_sub_u32 s31, s32, s31
    s_mul_i32 s31, s31, 16384
    s_sub_u32 s31, 1048576, s31
    s_add_u32 s72, s72, s31
    s_addc_u32 s73, s73, 0
    s_mov_b32 s74, 16384
    s_mov_b32 s75, 0x20000
    s_mov_b32 s76, 24576
    v_lshrrev_b32 v12, 3, v13
    v_lshlrev_b32 v5, 7, v13
    v_lshl_add_u32 v5, v12, 27, v5
    s_waitcnt vmcnt(12)
    s_mov_b32 s78, 0x7fff7fff
    v_and_b32 v132, s78, v132
    v_and_b32 v133, s78, v133
    v_and_b32 v134, s78, v134
    v_and_b32 v135, s78, v135
    v_and_b32 v136, s78, v136
    v_and_b32 v137, s78, v137
    v_and_b32 v138, s78, v138
    v_and_b32 v139, s78, v139
    v_and_b32 v140, s78, v140
    v_and_b32 v141, s78, v141
    v_and_b32 v142, s78, v142
    v_and_b32 v143, s78, v143
    v_and_b32 v144, s78, v144
    v_and_b32 v145, s78, v145
    v_and_b32 v146, s78, v146
    v_and_b32 v147, s78, v147
    v_pk_max_u16 v132, v132, v136
    v_pk_max_u16 v133, v133, v137
    v_pk_max_u16 v134, v134, v138
    v_pk_max_u16 v135, v135, v139
    v_pk_max_u16 v132, v132, v140
    v_pk_max_u16 v133, v133, v141
    v_pk_max_u16 v134, v134, v142
    v_pk_max_u16 v135, v135, v143
    v_pk_max_u16 v132, v132, v144
    v_pk_max_u16 v133, v133, v145
    v_pk_max_u16 v134, v134, v146
    v_pk_max_u16 v135, v135, v147
    v_pk_min_u16 v132, v132, v133
    v_pk_min_u16 v134, v134, v135
    v_pk_min_u16 v132, v132, v134
    v_lshlrev_b32 v133, 16, v132
    v_min_u32 v132, v132, v133
    s_nop 1
    v_min_u32_dpp v132, v132, v132 row_ror:1 row_mask:0xf bank_mask:0xf
    s_nop 1
    v_min_u32_dpp v132, v132, v132 row_ror:2 row_mask:0xf bank_mask:0xf
    s_nop 1
    v_min_u32_dpp v132, v132, v132 row_ror:4 row_mask:0xf bank_mask:0xf
    s_nop 1
    v_min_u32_dpp v132, v132, v132 row_ror:8 row_mask:0xf bank_mask:0xf
    v_mov_b32 v133, v132
    s_nop 1
    v_permlane16_swap_b32 v133, v132
    s_nop 1
    v_min_u32 v132, v133, v132
    v_mov_b32 v133, v132
    s_nop 1
    v_permlane32_swap_b32 v133, v132
    s_nop 1
    v_min_u32 v132, v133, v132
    v_min_u32 v132, 0x67800000, v132
    v_mul_f32 v132, 0x33a00000, v132
    v_and_b32 v132, 0x7f800000, v132
    v_mul_f32 v132, 0x3faaaaab, v132
    s_nop 0
    v_readfirstlane_b32 s78, v132
    v_readfirstlane_b32 s79, v132
    s_nop 1
    v_mov_b64 v[132:133], s[78:79]
    v_mov_b64 v[134:135], s[78:79]
    v_mov_b64 v[136:137], s[78:79]
    v_mov_b64 v[138:139], s[78:79]
    v_mov_b64 v[140:141], s[78:79]
    v_mov_b64 v[142:143], s[78:79]
    v_mov_b64 v[144:145], s[78:79]
    v_mov_b64 v[146:147], s[78:79]
    v_mov_b64 v[148:149], s[78:79]
    v_mov_b64 v[150:151], s[78:79]
    v_mov_b64 v[152:153], s[78:79]
    v_mov_b64 v[154:155], s[78:79]
    v_mov_b64 v[156:157], s[78:79]
    v_mov_b64 v[158:159], s[78:79]
    v_mov_b64 v[160:161], s[78:79]
    v_mov_b64 v[162:163], s[78:79]
    v_mov_b64 v[164:165], s[78:79]
    v_mov_b64 v[166:167], s[78:79]
    v_mov_b64 v[168:169], s[78:79]
    v_mov_b64 v[170:171], s[78:79]
    v_mov_b64 v[172:173], s[78:79]
    v_mov_b64 v[174:175], s[78:79]
    v_mov_b64 v[176:177], s[78:79]
    v_mov_b64 v[178:179], s[78:79]
    v_mov_b64 v[180:181], s[78:79]
    v_mov_b64 v[182:183], s[78:79]
    v_mov_b64 v[184:185], s[78:79]
    v_mov_b64 v[186:187], s[78:79]
    v_mov_b64 v[188:189], s[78:79]
    v_mov_b64 v[190:191], s[78:79]
    v_mov_b64 v[192:193], s[78:79]
    v_mov_b64 v[194:195], s[78:79]
    v_mov_b64 v[196:197], s[78:79]
    v_mov_b64 v[198:199], s[78:79]
    v_mov_b64 v[200:201], s[78:79]
    v_mov_b64 v[202:203], s[78:79]
    v_mov_b64 v[204:205], s[78:79]
    v_mov_b64 v[206:207], s[78:79]
    v_mov_b64 v[208:209], s[78:79]
    v_mov_b64 v[210:211], s[78:79]
    v_mov_b64 v[212:213], s[78:79]
    v_mov_b64 v[214:215], s[78:79]
    v_mov_b64 v[216:217], s[78:79]
    v_mov_b64 v[218:219], s[78:79]
    v_mov_b64 v[220:221], s[78:79]
    v_mov_b64 v[222:223], s[78:79]
    v_mov_b64 v[224:225], s[78:79]
    v_mov_b64 v[226:227], s[78:79]
    v_mov_b64 v[228:229], s[78:79]
    v_mov_b64 v[230:231], s[78:79]
    v_mov_b64 v[232:233], s[78:79]
    v_mov_b64 v[234:235], s[78:79]
    v_mov_b64 v[236:237], s[78:79]
    v_mov_b64 v[238:239], s[78:79]
    v_mov_b64 v[240:241], s[78:79]
    v_mov_b64 v[242:243], s[78:79]
    v_mov_b64 v[244:245], s[78:79]
    v_mov_b64 v[246:247], s[78:79]
    v_mov_b64 v[248:249], s[78:79]
    v_mov_b64 v[250:251], s[78:79]
    v_mov_b64 v[252:253], s[78:79]
    v_mov_b64 v[254:255], s[78:79]
    v_accvgpr_write_b32 a96, s78
    v_accvgpr_write_b32 a97, s78
    v_accvgpr_write_b32 a98, s78
    v_accvgpr_write_b32 a99, s78
    v_accvgpr_write_b32 a100, s78
    v_accvgpr_write_b32 a101, s78
    v_accvgpr_write_b32 a102, s78
    v_accvgpr_write_b32 a103, s78
    v_accvgpr_write_b32 a104, s78
    v_accvgpr_write_b32 a105, s78
    v_accvgpr_write_b32 a106, s78
    v_accvgpr_write_b32 a107, s78
    v_accvgpr_write_b32 a108, s78
    v_accvgpr_write_b32 a109, s78
    v_accvgpr_write_b32 a110, s78
    v_accvgpr_write_b32 a111, s78
    v_accvgpr_write_b32 a112, s78
    v_accvgpr_write_b32 a113, s78
    v_accvgpr_write_b32 a114, s78
    v_accvgpr_write_b32 a115, s78
    v_accvgpr_write_b32 a116, s78
    v_accvgpr_write_b32 a117, s78
    v_accvgpr_write_b32 a118, s78
    v_accvgpr_write_b32 a119, s78
    v_accvgpr_write_b32 a120, s78
    v_accvgpr_write_b32 a121, s78
    v_accvgpr_write_b32 a122, s78
    v_accvgpr_write_b32 a123, s78
    v_accvgpr_write_b32 a124, s78
    v_accvgpr_write_b32 a125, s78
    v_accvgpr_write_b32 a126, s78
    v_accvgpr_write_b32 a127, s78
    v_accvgpr_write_b32 a128, s78
    v_accvgpr_write_b32 a129, s78
    v_accvgpr_write_b32 a130, s78
    v_accvgpr_write_b32 a131, s78
    v_accvgpr_write_b32 a132, s78
    v_accvgpr_write_b32 a133, s78
    v_accvgpr_write_b32 a134, s78
    v_accvgpr_write_b32 a135, s78
    v_accvgpr_write_b32 a136, s78
    v_accvgpr_write_b32 a137, s78
    v_accvgpr_write_b32 a138, s78
    v_accvgpr_write_b32 a139, s78
    v_accvgpr_write_b32 a140, s78
    v_accvgpr_write_b32 a141, s78
    v_accvgpr_write_b32 a142, s78
    v_accvgpr_write_b32 a143, s78
    v_accvgpr_write_b32 a144, s78
    v_accvgpr_write_b32 a145, s78
    v_accvgpr_write_b32 a146, s78
    v_accvgpr_write_b32 a147, s78
    v_accvgpr_write_b32 a148, s78
    v_accvgpr_write_b32 a149, s78
    v_accvgpr_write_b32 a150, s78
    v_accvgpr_write_b32 a151, s78
    v_accvgpr_write_b32 a152, s78
    v_accvgpr_write_b32 a153, s78
    v_accvgpr_write_b32 a154, s78
    v_accvgpr_write_b32 a155, s78
    v_accvgpr_write_b32 a156, s78
    v_accvgpr_write_b32 a157, s78
    v_accvgpr_write_b32 a158, s78
    v_accvgpr_write_b32 a159, s78
    v_accvgpr_write_b32 a160, s78
    v_accvgpr_write_b32 a161, s78
    v_accvgpr_write_b32 a162, s78
    v_accvgpr_write_b32 a163, s78
    v_accvgpr_write_b32 a172, s78
    v_accvgpr_write_b32 a173, s78
    v_accvgpr_write_b32 a174, s78
    v_accvgpr_write_b32 a175, s78
    v_accvgpr_write_b32 a176, s78
    v_accvgpr_write_b32 a177, s78
    v_accvgpr_write_b32 a178, s78
    v_accvgpr_write_b32 a179, s78
    v_accvgpr_write_b32 a180, s78
    v_accvgpr_write_b32 a181, s78
    v_accvgpr_write_b32 a182, s78
    v_accvgpr_write_b32 a183, s78
    s_waitcnt vmcnt(19)
    s_waitcnt vmcnt(18)
    s_waitcnt vmcnt(17)
    s_waitcnt vmcnt(16)
    s_waitcnt vmcnt(11)
    s_add_u32 m0, s23, 67584
    s_movk_i32 s33, 8192
    buffer_load_dwordx4 v15, s[12:15], s33 offen offset:0 nt lds
    s_waitcnt vmcnt(11)
    s_add_u32 m0, s23, 68608
    s_movk_i32 s33, 12288
    buffer_load_dwordx4 v15, s[12:15], s33 offen offset:0 nt lds
    s_waitcnt vmcnt(11)
    s_add_u32 m0, s23, 69504
    s_movk_i32 s33, 8192
    buffer_load_dwordx4 v15, s[12:15], s33 offen offset:128 nt lds
    s_waitcnt vmcnt(11)
    s_add_u32 m0, s23, 70528
    s_movk_i32 s33, 12288
    buffer_load_dwordx4 v15, s[12:15], s33 offen offset:128 nt lds
    s_barrier
    ds_read_b128 a[192:195], v1 offset:0
    ds_read_b128 a[196:199], v1 offset:512
    ds_read_b128 a[200:203], v1 offset:16896
    ds_read_b128 a[204:207], v1 offset:17408
    ds_read_b128 a[208:211], v1 offset:64
    ds_read_b128 a[212:215], v1 offset:576
    ds_read_b128 a[216:219], v1 offset:16960
    ds_read_b128 a[220:223], v1 offset:17472
    ds_read_b128 a[224:227], v1 offset:128
    ds_read_b128 a[228:231], v1 offset:640
    ds_read_b128 a[232:235], v1 offset:17024
    ds_read_b128 a[236:239], v1 offset:17536
    ds_read_b128 a[240:243], v1 offset:192
    ds_read_b128 a[244:247], v1 offset:704
    ds_read_b128 a[248:251], v1 offset:17088
    s_waitcnt lgkmcnt(10)
    ds_read_b128 a[252:255], v1 offset:17600
    s_waitcnt vmcnt(10)
    ds_read_b128 v[112:115], v120 offset:0
    ds_read_b128 v[116:119], v121 offset:0
    s_add_u32 m0, s23, 71424
    s_movk_i32 s33, 8192
    buffer_load_dwordx4 v15, s[12:15], s33 offen offset:256 nt lds
    s_add_u32 m0, s23, 72448
    s_movk_i32 s33, 12288
    buffer_load_dwordx4 v15, s[12:15], s33 offen offset:256 nt lds
    s_waitcnt lgkmcnt(1)
    v_lshlrev_b32 v16, 16, v112
    v_and_b32 v17, 0xffff0000, v112
    v_lshlrev_b32 v18, 16, v113
    v_and_b32 v19, 0xffff0000, v113
    v_lshlrev_b32 v20, 16, v114
    v_and_b32 v21, 0xffff0000, v114
    v_lshlrev_b32 v22, 16, v115
    v_and_b32 v23, 0xffff0000, v115
    v_pk_mul_f32 v[16:17], v[16:17], v[110:111]
    v_pk_mul_f32 v[18:19], v[18:19], v[110:111]
    v_pk_mul_f32 v[20:21], v[20:21], v[110:111]
    v_pk_mul_f32 v[22:23], v[22:23], v[110:111]
    v_cvt_pk_bf16_f32 v16, v16, v17
    v_cvt_pk_bf16_f32 v18, v18, v19
    v_cvt_pk_bf16_f32 v20, v20, v21
    v_cvt_pk_bf16_f32 v22, v22, v23
    v_accvgpr_write_b32 a0, v16
    v_accvgpr_write_b32 a1, v18
    v_accvgpr_write_b32 a2, v20
    v_accvgpr_write_b32 a3, v22
    s_waitcnt lgkmcnt(0)
    v_lshlrev_b32 v16, 16, v116
    v_and_b32 v17, 0xffff0000, v116
    v_lshlrev_b32 v18, 16, v117
    v_and_b32 v19, 0xffff0000, v117
    v_lshlrev_b32 v20, 16, v118
    v_and_b32 v21, 0xffff0000, v118
    v_lshlrev_b32 v22, 16, v119
    v_and_b32 v23, 0xffff0000, v119
    v_pk_mul_f32 v[16:17], v[16:17], v[110:111]
    v_pk_mul_f32 v[18:19], v[18:19], v[110:111]
    v_pk_mul_f32 v[20:21], v[20:21], v[110:111]
    v_pk_mul_f32 v[22:23], v[22:23], v[110:111]
    v_cvt_pk_bf16_f32 v16, v16, v17
    v_cvt_pk_bf16_f32 v18, v18, v19
    v_cvt_pk_bf16_f32 v20, v20, v21
    v_cvt_pk_bf16_f32 v22, v22, v23
    v_accvgpr_write_b32 a4, v16
    v_accvgpr_write_b32 a5, v18
    v_accvgpr_write_b32 a6, v20
    v_accvgpr_write_b32 a7, v22
    s_waitcnt vmcnt(10)
    ds_read_b128 v[112:115], v120 offset:2048
    ds_read_b128 v[116:119], v121 offset:2048
    s_add_u32 m0, s23, 73344
    s_movk_i32 s33, 8192
    buffer_load_dwordx4 v15, s[12:15], s33 offen offset:384 nt lds
    s_add_u32 m0, s23, 74368
    s_movk_i32 s33, 12288
    buffer_load_dwordx4 v15, s[12:15], s33 offen offset:384 nt lds
    v_mfma_f32_16x16x32_bf16 v[36:39], a[192:195], a[0:3], 0
    v_mfma_f32_16x16x32_bf16 v[48:51], a[196:199], a[0:3], 0
    v_mfma_f32_16x16x32_bf16 v[60:63], a[200:203], a[0:3], 0
    v_mfma_f32_16x16x32_bf16 v[72:75], a[204:207], a[0:3], 0
    ds_read_b128 a[192:195], v1 offset:256
    ds_read_b128 a[196:199], v1 offset:768
    ds_read_b128 a[200:203], v1 offset:17152
    ds_read_b128 a[204:207], v1 offset:17664
    v_mfma_f32_16x16x32_bf16 v[36:39], a[208:211], a[4:7], v[36:39]
    v_mfma_f32_16x16x32_bf16 v[48:51], a[212:215], a[4:7], v[48:51]
    v_mfma_f32_16x16x32_bf16 v[60:63], a[216:219], a[4:7], v[60:63]
    v_mfma_f32_16x16x32_bf16 v[72:75], a[220:223], a[4:7], v[72:75]
    ds_read_b128 a[208:211], v1 offset:320
    ds_read_b128 a[212:215], v1 offset:832
    ds_read_b128 a[216:219], v1 offset:17216
    ds_read_b128 a[220:223], v1 offset:17728
    s_waitcnt lgkmcnt(9)
    v_lshlrev_b32 v16, 16, v112
    v_and_b32 v17, 0xffff0000, v112
    v_lshlrev_b32 v18, 16, v113
    v_and_b32 v19, 0xffff0000, v113
    v_lshlrev_b32 v20, 16, v114
    v_and_b32 v21, 0xffff0000, v114
    v_lshlrev_b32 v22, 16, v115
    v_and_b32 v23, 0xffff0000, v115
    v_pk_mul_f32 v[16:17], v[16:17], v[110:111]
    v_pk_mul_f32 v[18:19], v[18:19], v[110:111]
    v_pk_mul_f32 v[20:21], v[20:21], v[110:111]
    v_pk_mul_f32 v[22:23], v[22:23], v[110:111]
    v_cvt_pk_bf16_f32 v16, v16, v17
    v_cvt_pk_bf16_f32 v18, v18, v19
    v_cvt_pk_bf16_f32 v20, v20, v21
    v_cvt_pk_bf16_f32 v22, v22, v23
    v_accvgpr_write_b32 a8, v16
    v_accvgpr_write_b32 a9, v18
    v_accvgpr_write_b32 a10, v20
    v_accvgpr_write_b32 a11, v22
    s_waitcnt lgkmcnt(8)
    v_lshlrev_b32 v16, 16, v116
    v_and_b32 v17, 0xffff0000, v116
    v_lshlrev_b32 v18, 16, v117
    v_and_b32 v19, 0xffff0000, v117
    v_lshlrev_b32 v20, 16, v118
    v_and_b32 v21, 0xffff0000, v118
    v_lshlrev_b32 v22, 16, v119
    v_and_b32 v23, 0xffff0000, v119
    v_pk_mul_f32 v[16:17], v[16:17], v[110:111]
    v_pk_mul_f32 v[18:19], v[18:19], v[110:111]
    v_pk_mul_f32 v[20:21], v[20:21], v[110:111]
    v_pk_mul_f32 v[22:23], v[22:23], v[110:111]
    v_cvt_pk_bf16_f32 v16, v16, v17
    v_cvt_pk_bf16_f32 v18, v18, v19
    v_cvt_pk_bf16_f32 v20, v20, v21
    v_cvt_pk_bf16_f32 v22, v22, v23
    v_accvgpr_write_b32 a12, v16
    v_accvgpr_write_b32 a13, v18
    v_accvgpr_write_b32 a14, v20
    v_accvgpr_write_b32 a15, v22
    s_waitcnt vmcnt(10)
    ds_read_b128 v[112:115], v120 offset:4096
    ds_read_b128 v[116:119], v121 offset:4096
    s_add_u32 m0, s23, 101376
    s_movk_i32 s33, 16384
    buffer_load_dwordx4 v15, s[12:15], s33 offen offset:0 nt lds
    s_add_u32 m0, s23, 102400
    s_movk_i32 s33, 20480
    buffer_load_dwordx4 v15, s[12:15], s33 offen offset:0 nt lds
    v_mfma_f32_16x16x32_bf16 v[36:39], a[224:227], a[8:11], v[36:39]
    v_mfma_f32_16x16x32_bf16 v[48:51], a[228:231], a[8:11], v[48:51]
    v_mfma_f32_16x16x32_bf16 v[60:63], a[232:235], a[8:11], v[60:63]
    v_mfma_f32_16x16x32_bf16 v[72:75], a[236:239], a[8:11], v[72:75]
    ds_read_b128 a[224:227], v1 offset:384
    ds_read_b128 a[228:231], v1 offset:896
    ds_read_b128 a[232:235], v1 offset:17280
    ds_read_b128 a[236:239], v1 offset:17792
    v_mfma_f32_16x16x32_bf16 v[36:39], a[240:243], a[12:15], v[36:39]
    v_mfma_f32_16x16x32_bf16 v[48:51], a[244:247], a[12:15], v[48:51]
    v_mfma_f32_16x16x32_bf16 v[60:63], a[248:251], a[12:15], v[60:63]
    v_mfma_f32_16x16x32_bf16 v[72:75], a[252:255], a[12:15], v[72:75]
    ds_read_b128 a[240:243], v1 offset:448
    s_waitcnt lgkmcnt(10)
    ds_read_b128 a[244:247], v1 offset:960
    ds_read_b128 a[248:251], v1 offset:17344
    ds_read_b128 a[252:255], v1 offset:17856
    s_waitcnt lgkmcnt(9)
    v_lshlrev_b32 v16, 16, v112
    v_and_b32 v17, 0xffff0000, v112
    v_lshlrev_b32 v18, 16, v113
    v_and_b32 v19, 0xffff0000, v113
    v_lshlrev_b32 v20, 16, v114
    v_and_b32 v21, 0xffff0000, v114
    v_lshlrev_b32 v22, 16, v115
    v_and_b32 v23, 0xffff0000, v115
    v_pk_mul_f32 v[16:17], v[16:17], v[110:111]
    v_pk_mul_f32 v[18:19], v[18:19], v[110:111]
    v_pk_mul_f32 v[20:21], v[20:21], v[110:111]
    v_pk_mul_f32 v[22:23], v[22:23], v[110:111]
    v_cvt_pk_bf16_f32 v16, v16, v17
    v_cvt_pk_bf16_f32 v18, v18, v19
    v_cvt_pk_bf16_f32 v20, v20, v21
    v_cvt_pk_bf16_f32 v22, v22, v23
    v_accvgpr_write_b32 a16, v16
    v_accvgpr_write_b32 a17, v18
    v_accvgpr_write_b32 a18, v20
    v_accvgpr_write_b32 a19, v22
    s_waitcnt lgkmcnt(8)
    v_lshlrev_b32 v16, 16, v116
    v_and_b32 v17, 0xffff0000, v116
    v_lshlrev_b32 v18, 16, v117
    v_and_b32 v19, 0xffff0000, v117
    v_lshlrev_b32 v20, 16, v118
    v_and_b32 v21, 0xffff0000, v118
    v_lshlrev_b32 v22, 16, v119
    v_and_b32 v23, 0xffff0000, v119
    v_pk_mul_f32 v[16:17], v[16:17], v[110:111]
    v_pk_mul_f32 v[18:19], v[18:19], v[110:111]
    v_pk_mul_f32 v[20:21], v[20:21], v[110:111]
    v_pk_mul_f32 v[22:23], v[22:23], v[110:111]
    v_cvt_pk_bf16_f32 v16, v16, v17
    v_cvt_pk_bf16_f32 v18, v18, v19
    v_cvt_pk_bf16_f32 v20, v20, v21
    v_cvt_pk_bf16_f32 v22, v22, v23
    v_accvgpr_write_b32 a20, v16
    v_accvgpr_write_b32 a21, v18
    v_accvgpr_write_b32 a22, v20
    v_accvgpr_write_b32 a23, v22
    s_waitcnt vmcnt(10)
    ds_read_b128 v[112:115], v120 offset:6144
    ds_read_b128 v[116:119], v121 offset:6144
    s_add_u32 m0, s23, 103296
    s_movk_i32 s33, 16384
    buffer_load_dwordx4 v15, s[12:15], s33 offen offset:128 nt lds
    s_add_u32 m0, s23, 104320
    s_movk_i32 s33, 20480
    buffer_load_dwordx4 v15, s[12:15], s33 offen offset:128 nt lds
    v_mfma_f32_16x16x32_bf16 v[36:39], a[192:195], a[16:19], v[36:39]
    v_mfma_f32_16x16x32_bf16 v[48:51], a[196:199], a[16:19], v[48:51]
    v_mfma_f32_16x16x32_bf16 v[60:63], a[200:203], a[16:19], v[60:63]
    v_mfma_f32_16x16x32_bf16 v[72:75], a[204:207], a[16:19], v[72:75]
    ds_read_b128 a[192:195], v1 offset:0
    ds_read_b128 a[196:199], v1 offset:512
    ds_read_b128 a[200:203], v1 offset:16896
    ds_read_b128 a[204:207], v1 offset:17408
    v_mfma_f32_16x16x32_bf16 v[36:39], a[208:211], a[20:23], v[36:39]
    v_mfma_f32_16x16x32_bf16 v[48:51], a[212:215], a[20:23], v[48:51]
    v_mfma_f32_16x16x32_bf16 v[60:63], a[216:219], a[20:23], v[60:63]
    v_mfma_f32_16x16x32_bf16 v[72:75], a[220:223], a[20:23], v[72:75]
    ds_read_b128 a[208:211], v1 offset:64
    s_waitcnt lgkmcnt(10)
    ds_read_b128 a[212:215], v1 offset:576
    ds_read_b128 a[216:219], v1 offset:16960
    ds_read_b128 a[220:223], v1 offset:17472
    s_waitcnt lgkmcnt(9)
    v_lshlrev_b32 v16, 16, v112
    v_and_b32 v17, 0xffff0000, v112
    v_lshlrev_b32 v18, 16, v113
    v_and_b32 v19, 0xffff0000, v113
    v_lshlrev_b32 v20, 16, v114
    v_and_b32 v21, 0xffff0000, v114
    v_lshlrev_b32 v22, 16, v115
    v_and_b32 v23, 0xffff0000, v115
    v_pk_mul_f32 v[16:17], v[16:17], v[110:111]
    v_pk_mul_f32 v[18:19], v[18:19], v[110:111]
    v_pk_mul_f32 v[20:21], v[20:21], v[110:111]
    v_pk_mul_f32 v[22:23], v[22:23], v[110:111]
    v_cvt_pk_bf16_f32 v16, v16, v17
    v_cvt_pk_bf16_f32 v18, v18, v19
    v_cvt_pk_bf16_f32 v20, v20, v21
    v_cvt_pk_bf16_f32 v22, v22, v23
    v_accvgpr_write_b32 a24, v16
    v_accvgpr_write_b32 a25, v18
    v_accvgpr_write_b32 a26, v20
    v_accvgpr_write_b32 a27, v22
    s_waitcnt lgkmcnt(8)
    v_lshlrev_b32 v16, 16, v116
    v_and_b32 v17, 0xffff0000, v116
    v_lshlrev_b32 v18, 16, v117
    v_and_b32 v19, 0xffff0000, v117
    v_lshlrev_b32 v20, 16, v118
    v_and_b32 v21, 0xffff0000, v118
    v_lshlrev_b32 v22, 16, v119
    v_and_b32 v23, 0xffff0000, v119
    v_pk_mul_f32 v[16:17], v[16:17], v[110:111]
    v_pk_mul_f32 v[18:19], v[18:19], v[110:111]
    v_pk_mul_f32 v[20:21], v[20:21], v[110:111]
    v_pk_mul_f32 v[22:23], v[22:23], v[110:111]
    v_cvt_pk_bf16_f32 v16, v16, v17
    v_cvt_pk_bf16_f32 v18, v18, v19
    v_cvt_pk_bf16_f32 v20, v20, v21
    v_cvt_pk_bf16_f32 v22, v22, v23
    v_accvgpr_write_b32 a28, v16
    v_accvgpr_write_b32 a29, v18
    v_accvgpr_write_b32 a30, v20
    v_accvgpr_write_b32 a31, v22
    v_mfma_f32_16x16x32_bf16 v[36:39], a[224:227], a[24:27], v[36:39]
    v_mfma_f32_16x16x32_bf16 v[48:51], a[228:231], a[24:27], v[48:51]
    v_mfma_f32_16x16x32_bf16 v[60:63], a[232:235], a[24:27], v[60:63]
    v_mfma_f32_16x16x32_bf16 v[72:75], a[236:239], a[24:27], v[72:75]
    ds_read_b128 a[224:227], v1 offset:128
    ds_read_b128 a[228:231], v1 offset:640
    ds_read_b128 a[232:235], v1 offset:17024
    ds_read_b128 a[236:239], v1 offset:17536
    v_mfma_f32_16x16x32_bf16 v[36:39], a[240:243], a[28:31], v[36:39]
    v_mfma_f32_16x16x32_bf16 v[48:51], a[244:247], a[28:31], v[48:51]
    v_mfma_f32_16x16x32_bf16 v[60:63], a[248:251], a[28:31], v[60:63]
    v_mfma_f32_16x16x32_bf16 v[72:75], a[252:255], a[28:31], v[72:75]
    ds_read_b128 a[240:243], v1 offset:192
    ds_read_b128 a[244:247], v1 offset:704
    ds_read_b128 a[248:251], v1 offset:17088
    s_waitcnt lgkmcnt(10)
    ds_read_b128 a[252:255], v1 offset:17600
    v_max3_f32 v12, v36, v37, v38
    v_max3_f32 v12, v12, v39, v48
    v_max3_f32 v12, v12, v49, v50
    v_max3_f32 v12, v12, v51, v60
    v_max3_f32 v12, v12, v61, v62
    v_max3_f32 v12, v12, v63, v72
    v_max3_f32 v12, v12, v73, v74
    v_max_f32 v12, v12, v75
    v_mov_b32 v13, v12
    s_nop 1
    v_permlane16_swap_b32 v13, v12
    s_nop 1
    v_max_f32 v12, v13, v12
    v_mov_b32 v13, v12
    s_nop 1
    v_permlane32_swap_b32 v13, v12
    s_nop 1
    v_max_f32 v12, v13, v12
    v_add_f32 v12, 0x42080000, v12
    v_max_f32 v12, 0xff7fffff, v12
    v_sub_f32 v24, 0, v12
    v_sub_f32 v25, 0, v12
    v_sub_f32 v26, 0, v12
    v_sub_f32 v27, 0, v12
    v_sub_f32 v16, v36, v12
    v_sub_f32 v17, v37, v12
    v_sub_f32 v18, v38, v12
    v_sub_f32 v19, v39, v12
    v_exp_f32 v16, v16
    v_exp_f32 v17, v17
    v_exp_f32 v18, v18
    v_exp_f32 v19, v19
    v_add_f32 v6, v16, v17
    v_cvt_pk_bf16_f32 v84, v16, v17
    v_add_f32 v6, v6, v18
    v_add_f32 v6, v6, v19
    v_cvt_pk_bf16_f32 v85, v18, v19
    v_sub_f32 v20, v48, v12
    v_sub_f32 v21, v49, v12
    v_sub_f32 v22, v50, v12
    s_add_u32 m0, s23, 105216
    s_movk_i32 s33, 16384
    buffer_load_dwordx4 v15, s[12:15], s33 offen offset:256 nt lds
    v_sub_f32 v23, v51, v12
    v_exp_f32 v20, v20
    v_exp_f32 v21, v21
    v_exp_f32 v22, v22
    v_exp_f32 v23, v23
    v_add_f32 v6, v6, v20
    v_add_f32 v6, v6, v21
    v_cvt_pk_bf16_f32 v86, v20, v21
    v_add_f32 v6, v6, v22
    v_add_f32 v6, v6, v23
    v_cvt_pk_bf16_f32 v87, v22, v23
    v_sub_f32 v16, v60, v12
    v_sub_f32 v17, v61, v12
    v_sub_f32 v18, v62, v12
    v_sub_f32 v19, v63, v12
    v_exp_f32 v16, v16
    v_exp_f32 v17, v17
    v_exp_f32 v18, v18
    v_exp_f32 v19, v19
    v_add_f32 v6, v6, v16
    v_add_f32 v6, v6, v17
    v_cvt_pk_bf16_f32 v88, v16, v17
    v_add_f32 v6, v6, v18
    v_add_f32 v6, v6, v19
    v_cvt_pk_bf16_f32 v89, v18, v19
    v_sub_f32 v20, v72, v12
    v_sub_f32 v21, v73, v12
    v_sub_f32 v22, v74, v12
    v_sub_f32 v23, v75, v12
    v_exp_f32 v20, v20
    v_exp_f32 v21, v21
    v_exp_f32 v22, v22
    v_exp_f32 v23, v23
    v_add_f32 v6, v6, v20
    v_add_f32 v6, v6, v21
    v_cvt_pk_bf16_f32 v90, v20, v21
    v_add_f32 v6, v6, v22
    v_add_f32 v6, v6, v23
    v_cvt_pk_bf16_f32 v91, v22, v23
    s_waitcnt vmcnt(11)
    ds_read_b128 v[112:115], v120 offset:33792
    ds_read_b128 v[116:119], v121 offset:33792
    s_add_u32 m0, s23, 106240
    s_movk_i32 s33, 20480
    buffer_load_dwordx4 v15, s[12:15], s33 offen offset:256 nt lds
    s_waitcnt lgkmcnt(1)
    v_lshlrev_b32 v16, 16, v112
    v_and_b32 v17, 0xffff0000, v112
    v_lshlrev_b32 v18, 16, v113
    v_and_b32 v19, 0xffff0000, v113
    v_lshlrev_b32 v20, 16, v114
    v_and_b32 v21, 0xffff0000, v114
    v_lshlrev_b32 v22, 16, v115
    v_and_b32 v23, 0xffff0000, v115
    v_pk_mul_f32 v[16:17], v[16:17], v[110:111]
    v_pk_mul_f32 v[18:19], v[18:19], v[110:111]
    v_pk_mul_f32 v[20:21], v[20:21], v[110:111]
    v_pk_mul_f32 v[22:23], v[22:23], v[110:111]
    v_cvt_pk_bf16_f32 v16, v16, v17
    v_cvt_pk_bf16_f32 v18, v18, v19
    v_cvt_pk_bf16_f32 v20, v20, v21
    v_cvt_pk_bf16_f32 v22, v22, v23
    v_accvgpr_write_b32 a32, v16
    v_accvgpr_write_b32 a33, v18
    v_accvgpr_write_b32 a34, v20
    v_accvgpr_write_b32 a35, v22
    s_waitcnt lgkmcnt(0)
    v_lshlrev_b32 v16, 16, v116
    v_and_b32 v17, 0xffff0000, v116
    v_lshlrev_b32 v18, 16, v117
    v_and_b32 v19, 0xffff0000, v117
    v_lshlrev_b32 v20, 16, v118
    v_and_b32 v21, 0xffff0000, v118
    v_lshlrev_b32 v22, 16, v119
    v_and_b32 v23, 0xffff0000, v119
    v_pk_mul_f32 v[16:17], v[16:17], v[110:111]
    v_pk_mul_f32 v[18:19], v[18:19], v[110:111]
    v_pk_mul_f32 v[20:21], v[20:21], v[110:111]
    v_pk_mul_f32 v[22:23], v[22:23], v[110:111]
    v_cvt_pk_bf16_f32 v16, v16, v17
    v_cvt_pk_bf16_f32 v18, v18, v19
    v_cvt_pk_bf16_f32 v20, v20, v21
    v_cvt_pk_bf16_f32 v22, v22, v23
    v_accvgpr_write_b32 a36, v16
    v_accvgpr_write_b32 a37, v18
    v_accvgpr_write_b32 a38, v20
    v_accvgpr_write_b32 a39, v22
    s_waitcnt vmcnt(10)
    ds_read_b128 v[112:115], v120 offset:35840
    ds_read_b128 v[116:119], v121 offset:35840
    s_add_u32 m0, s23, 107136
    s_movk_i32 s33, 16384
    buffer_load_dwordx4 v15, s[12:15], s33 offen offset:384 nt lds
    s_add_u32 m0, s23, 108160
    s_movk_i32 s33, 20480
    buffer_load_dwordx4 v15, s[12:15], s33 offen offset:384 nt lds
    v_mfma_f32_16x16x32_bf16 v[40:43], a[192:195], a[32:35], 0
    v_mfma_f32_16x16x32_bf16 v[52:55], a[196:199], a[32:35], 0
    v_mfma_f32_16x16x32_bf16 v[64:67], a[200:203], a[32:35], 0
    v_mfma_f32_16x16x32_bf16 v[76:79], a[204:207], a[32:35], 0
    ds_read_b128 a[192:195], v1 offset:256
    ds_read_b128 a[196:199], v1 offset:768
    ds_read_b128 a[200:203], v1 offset:17152
    ds_read_b128 a[204:207], v1 offset:17664
    v_mfma_f32_16x16x32_bf16 v[40:43], a[208:211], a[36:39], v[40:43]
    v_mfma_f32_16x16x32_bf16 v[52:55], a[212:215], a[36:39], v[52:55]
    v_mfma_f32_16x16x32_bf16 v[64:67], a[216:219], a[36:39], v[64:67]
    v_mfma_f32_16x16x32_bf16 v[76:79], a[220:223], a[36:39], v[76:79]
    ds_read_b128 a[208:211], v1 offset:320
    ds_read_b128 a[212:215], v1 offset:832
    ds_read_b128 a[216:219], v1 offset:17216
    ds_read_b128 a[220:223], v1 offset:17728
    s_waitcnt lgkmcnt(9)
    v_lshlrev_b32 v16, 16, v112
    v_and_b32 v17, 0xffff0000, v112
    v_lshlrev_b32 v18, 16, v113
    v_and_b32 v19, 0xffff0000, v113
    v_lshlrev_b32 v20, 16, v114
    v_and_b32 v21, 0xffff0000, v114
    v_lshlrev_b32 v22, 16, v115
    v_and_b32 v23, 0xffff0000, v115
    v_pk_mul_f32 v[16:17], v[16:17], v[110:111]
    v_pk_mul_f32 v[18:19], v[18:19], v[110:111]
    v_pk_mul_f32 v[20:21], v[20:21], v[110:111]
    v_pk_mul_f32 v[22:23], v[22:23], v[110:111]
    v_cvt_pk_bf16_f32 v16, v16, v17
    v_cvt_pk_bf16_f32 v18, v18, v19
    v_cvt_pk_bf16_f32 v20, v20, v21
    v_cvt_pk_bf16_f32 v22, v22, v23
    v_accvgpr_write_b32 a40, v16
    v_accvgpr_write_b32 a41, v18
    v_accvgpr_write_b32 a42, v20
    v_accvgpr_write_b32 a43, v22
    s_waitcnt lgkmcnt(8)
    v_lshlrev_b32 v16, 16, v116
    v_and_b32 v17, 0xffff0000, v116
    v_lshlrev_b32 v18, 16, v117
    v_and_b32 v19, 0xffff0000, v117
    v_lshlrev_b32 v20, 16, v118
    v_and_b32 v21, 0xffff0000, v118
    v_lshlrev_b32 v22, 16, v119
    v_and_b32 v23, 0xffff0000, v119
    v_pk_mul_f32 v[16:17], v[16:17], v[110:111]
    v_pk_mul_f32 v[18:19], v[18:19], v[110:111]
    v_pk_mul_f32 v[20:21], v[20:21], v[110:111]
    v_pk_mul_f32 v[22:23], v[22:23], v[110:111]
    v_cvt_pk_bf16_f32 v16, v16, v17
    v_cvt_pk_bf16_f32 v18, v18, v19
    v_cvt_pk_bf16_f32 v20, v20, v21
    v_cvt_pk_bf16_f32 v22, v22, v23
    v_accvgpr_write_b32 a44, v16
    v_accvgpr_write_b32 a45, v18
    v_accvgpr_write_b32 a46, v20
    v_accvgpr_write_b32 a47, v22
    s_waitcnt vmcnt(10)
    ds_read_b128 v[112:115], v120 offset:37888
    ds_read_b128 v[116:119], v121 offset:37888
    s_add_u32 m0, s23, 33792
    s_nop 0
    buffer_load_dwordx4 v3, s[4:7], s21 offen offset:0 nt lds
    s_add_u32 m0, s23, 33824
    s_nop 0
    buffer_load_dwordx4 v3, s[4:7], s21 offen offset:1024 nt lds
    v_mfma_f32_16x16x32_bf16 v[40:43], a[224:227], a[40:43], v[40:43]
    v_mfma_f32_16x16x32_bf16 v[52:55], a[228:231], a[40:43], v[52:55]
    v_mfma_f32_16x16x32_bf16 v[64:67], a[232:235], a[40:43], v[64:67]
    v_mfma_f32_16x16x32_bf16 v[76:79], a[236:239], a[40:43], v[76:79]
    ds_read_b128 a[224:227], v1 offset:384
    ds_read_b128 a[228:231], v1 offset:896
    ds_read_b128 a[232:235], v1 offset:17280
    ds_read_b128 a[236:239], v1 offset:17792
    v_mfma_f32_16x16x32_bf16 v[40:43], a[240:243], a[44:47], v[40:43]
    v_mfma_f32_16x16x32_bf16 v[52:55], a[244:247], a[44:47], v[52:55]
    v_mfma_f32_16x16x32_bf16 v[64:67], a[248:251], a[44:47], v[64:67]
    v_mfma_f32_16x16x32_bf16 v[76:79], a[252:255], a[44:47], v[76:79]
    ds_read_b128 a[240:243], v1 offset:448
    s_waitcnt lgkmcnt(10)
    ds_read_b128 a[244:247], v1 offset:960
    ds_read_b128 a[248:251], v1 offset:17344
    ds_read_b128 a[252:255], v1 offset:17856
    s_waitcnt lgkmcnt(9)
    v_lshlrev_b32 v16, 16, v112
    v_and_b32 v17, 0xffff0000, v112
    v_lshlrev_b32 v18, 16, v113
    v_and_b32 v19, 0xffff0000, v113
    v_lshlrev_b32 v20, 16, v114
    v_and_b32 v21, 0xffff0000, v114
    v_lshlrev_b32 v22, 16, v115
    v_and_b32 v23, 0xffff0000, v115
    v_pk_mul_f32 v[16:17], v[16:17], v[110:111]
    v_pk_mul_f32 v[18:19], v[18:19], v[110:111]
    v_pk_mul_f32 v[20:21], v[20:21], v[110:111]
    v_pk_mul_f32 v[22:23], v[22:23], v[110:111]
    v_cvt_pk_bf16_f32 v16, v16, v17
    v_cvt_pk_bf16_f32 v18, v18, v19
    v_cvt_pk_bf16_f32 v20, v20, v21
    v_cvt_pk_bf16_f32 v22, v22, v23
    v_accvgpr_write_b32 a48, v16
    v_accvgpr_write_b32 a49, v18
    v_accvgpr_write_b32 a50, v20
    v_accvgpr_write_b32 a51, v22
    s_waitcnt lgkmcnt(8)
    v_lshlrev_b32 v16, 16, v116
    v_and_b32 v17, 0xffff0000, v116
    v_lshlrev_b32 v18, 16, v117
    v_and_b32 v19, 0xffff0000, v117
    v_lshlrev_b32 v20, 16, v118
    v_and_b32 v21, 0xffff0000, v118
    v_lshlrev_b32 v22, 16, v119
    v_and_b32 v23, 0xffff0000, v119
    v_pk_mul_f32 v[16:17], v[16:17], v[110:111]
    v_pk_mul_f32 v[18:19], v[18:19], v[110:111]
    v_pk_mul_f32 v[20:21], v[20:21], v[110:111]
    v_pk_mul_f32 v[22:23], v[22:23], v[110:111]
    v_cvt_pk_bf16_f32 v16, v16, v17
    v_cvt_pk_bf16_f32 v18, v18, v19
    v_cvt_pk_bf16_f32 v20, v20, v21
    v_cvt_pk_bf16_f32 v22, v22, v23
    v_accvgpr_write_b32 a52, v16
    v_accvgpr_write_b32 a53, v18
    v_accvgpr_write_b32 a54, v20
    v_accvgpr_write_b32 a55, v22
    s_waitcnt vmcnt(10)
    ds_read_b128 v[112:115], v120 offset:39936
    ds_read_b128 v[116:119], v121 offset:39936
    s_add_u32 m0, s23, 33856
    s_nop 0
    buffer_load_dwordx4 v3, s[4:7], s21 offen offset:2048 nt lds
    s_add_u32 m0, s23, 33888
    s_nop 0
    buffer_load_dwordx4 v3, s[4:7], s21 offen offset:3072 nt lds
    v_mfma_f32_16x16x32_bf16 v[40:43], a[192:195], a[48:51], v[40:43]
    v_mfma_f32_16x16x32_bf16 v[52:55], a[196:199], a[48:51], v[52:55]
    v_mfma_f32_16x16x32_bf16 v[64:67], a[200:203], a[48:51], v[64:67]
    v_mfma_f32_16x16x32_bf16 v[76:79], a[204:207], a[48:51], v[76:79]
    ds_read_b128 a[192:195], v1 offset:0
    ds_read_b128 a[196:199], v1 offset:512
    ds_read_b128 a[200:203], v1 offset:16896
    ds_read_b128 a[204:207], v1 offset:17408
    v_mfma_f32_16x16x32_bf16 v[40:43], a[208:211], a[52:55], v[40:43]
    v_mfma_f32_16x16x32_bf16 v[52:55], a[212:215], a[52:55], v[52:55]
    v_mfma_f32_16x16x32_bf16 v[64:67], a[216:219], a[52:55], v[64:67]
    v_mfma_f32_16x16x32_bf16 v[76:79], a[220:223], a[52:55], v[76:79]
    ds_read_b128 a[208:211], v1 offset:64
    s_waitcnt lgkmcnt(10)
    ds_read_b128 a[212:215], v1 offset:576
    ds_read_b128 a[216:219], v1 offset:16960
    ds_read_b128 a[220:223], v1 offset:17472
    s_waitcnt lgkmcnt(9)
    v_lshlrev_b32 v16, 16, v112
    v_and_b32 v17, 0xffff0000, v112
    v_lshlrev_b32 v18, 16, v113
    v_and_b32 v19, 0xffff0000, v113
    v_lshlrev_b32 v20, 16, v114
    v_and_b32 v21, 0xffff0000, v114
    v_lshlrev_b32 v22, 16, v115
    v_and_b32 v23, 0xffff0000, v115
    v_pk_mul_f32 v[16:17], v[16:17], v[110:111]
    v_pk_mul_f32 v[18:19], v[18:19], v[110:111]
    v_pk_mul_f32 v[20:21], v[20:21], v[110:111]
    v_pk_mul_f32 v[22:23], v[22:23], v[110:111]
    v_cvt_pk_bf16_f32 v16, v16, v17
    v_cvt_pk_bf16_f32 v18, v18, v19
    v_cvt_pk_bf16_f32 v20, v20, v21
    v_cvt_pk_bf16_f32 v22, v22, v23
    v_accvgpr_write_b32 a56, v16
    v_accvgpr_write_b32 a57, v18
    v_accvgpr_write_b32 a58, v20
    v_accvgpr_write_b32 a59, v22
    s_waitcnt lgkmcnt(8)
    v_lshlrev_b32 v16, 16, v116
    v_and_b32 v17, 0xffff0000, v116
    v_lshlrev_b32 v18, 16, v117
    v_and_b32 v19, 0xffff0000, v117
    v_lshlrev_b32 v20, 16, v118
    v_and_b32 v21, 0xffff0000, v118
    v_lshlrev_b32 v22, 16, v119
    v_and_b32 v23, 0xffff0000, v119
    v_pk_mul_f32 v[16:17], v[16:17], v[110:111]
    v_pk_mul_f32 v[18:19], v[18:19], v[110:111]
    v_pk_mul_f32 v[20:21], v[20:21], v[110:111]
    v_pk_mul_f32 v[22:23], v[22:23], v[110:111]
    v_cvt_pk_bf16_f32 v16, v16, v17
    v_cvt_pk_bf16_f32 v18, v18, v19
    v_cvt_pk_bf16_f32 v20, v20, v21
    v_cvt_pk_bf16_f32 v22, v22, v23
    v_accvgpr_write_b32 a60, v16
    v_accvgpr_write_b32 a61, v18
    v_accvgpr_write_b32 a62, v20
    v_accvgpr_write_b32 a63, v22
    v_mfma_f32_16x16x32_bf16 v[40:43], a[224:227], a[56:59], v[40:43]
    v_mfma_f32_16x16x32_bf16 v[52:55], a[228:231], a[56:59], v[52:55]
    v_mfma_f32_16x16x32_bf16 v[64:67], a[232:235], a[56:59], v[64:67]
    v_mfma_f32_16x16x32_bf16 v[76:79], a[236:239], a[56:59], v[76:79]
    ds_read_b128 a[224:227], v1 offset:128
    ds_read_b128 a[228:231], v1 offset:640
    ds_read_b128 a[232:235], v1 offset:17024
    ds_read_b128 a[236:239], v1 offset:17536
    v_mfma_f32_16x16x32_bf16 v[40:43], a[240:243], a[60:63], v[40:43]
    v_mfma_f32_16x16x32_bf16 v[52:55], a[244:247], a[60:63], v[52:55]
    v_mfma_f32_16x16x32_bf16 v[64:67], a[248:251], a[60:63], v[64:67]
    v_mfma_f32_16x16x32_bf16 v[76:79], a[252:255], a[60:63], v[76:79]
    ds_read_b128 a[240:243], v1 offset:192
    ds_read_b128 a[244:247], v1 offset:704
    ds_read_b128 a[248:251], v1 offset:17088
    s_waitcnt lgkmcnt(10)
    ds_read_b128 a[252:255], v1 offset:17600
    v_max3_f32 v12, v40, v41, v42
    v_max3_f32 v12, v12, v43, v52
    v_max3_f32 v12, v12, v53, v54
    v_max3_f32 v12, v12, v55, v64
    v_max3_f32 v12, v12, v65, v66
    v_max3_f32 v12, v12, v67, v76
    v_max3_f32 v12, v12, v77, v78
    v_max_f32 v12, v12, v79
    v_mov_b32 v13, v12
    s_nop 1
    v_permlane16_swap_b32 v13, v12
    s_nop 1
    v_max_f32 v12, v13, v12
    v_mov_b32 v13, v12
    s_nop 1
    v_permlane32_swap_b32 v13, v12
    s_nop 1
    v_max_f32 v12, v13, v12
    v_add_f32 v12, 0x42080000, v12
    v_max_f32 v12, 0xff7fffff, v12
    v_sub_f32 v28, 0, v12
    v_sub_f32 v29, 0, v12
    v_sub_f32 v30, 0, v12
    v_sub_f32 v31, 0, v12
    v_sub_f32 v16, v40, v12
    v_sub_f32 v17, v41, v12
    v_sub_f32 v18, v42, v12
    v_sub_f32 v19, v43, v12
    v_exp_f32 v16, v16
    v_exp_f32 v17, v17
    v_exp_f32 v18, v18
    v_exp_f32 v19, v19
    v_add_f32 v7, v16, v17
    v_cvt_pk_bf16_f32 v92, v16, v17
    v_add_f32 v7, v7, v18
    v_add_f32 v7, v7, v19
    v_cvt_pk_bf16_f32 v93, v18, v19
    v_sub_f32 v20, v52, v12
    v_sub_f32 v21, v53, v12
    v_sub_f32 v22, v54, v12
    s_add_u32 m0, s23, 38016
    s_nop 0
    buffer_load_dwordx4 v4, s[4:7], s21 offen offset:0 nt lds
    v_sub_f32 v23, v55, v12
    v_exp_f32 v20, v20
    v_exp_f32 v21, v21
    v_exp_f32 v22, v22
    v_exp_f32 v23, v23
    v_add_f32 v7, v7, v20
    v_add_f32 v7, v7, v21
    v_cvt_pk_bf16_f32 v94, v20, v21
    v_add_f32 v7, v7, v22
    v_add_f32 v7, v7, v23
    v_cvt_pk_bf16_f32 v95, v22, v23
    v_sub_f32 v16, v64, v12
    v_sub_f32 v17, v65, v12
    v_sub_f32 v18, v66, v12
    v_sub_f32 v19, v67, v12
    v_exp_f32 v16, v16
    v_exp_f32 v17, v17
    v_exp_f32 v18, v18
    v_exp_f32 v19, v19
    v_add_f32 v7, v7, v16
    v_add_f32 v7, v7, v17
    v_cvt_pk_bf16_f32 v96, v16, v17
    v_add_f32 v7, v7, v18
    v_add_f32 v7, v7, v19
    v_cvt_pk_bf16_f32 v97, v18, v19
    v_sub_f32 v20, v76, v12
    v_sub_f32 v21, v77, v12
    v_sub_f32 v22, v78, v12
    v_sub_f32 v23, v79, v12
    v_exp_f32 v20, v20
    v_exp_f32 v21, v21
    v_exp_f32 v22, v22
    v_exp_f32 v23, v23
    v_add_f32 v7, v7, v20
    v_add_f32 v7, v7, v21
    v_cvt_pk_bf16_f32 v98, v20, v21
    v_add_f32 v7, v7, v22
    v_add_f32 v7, v7, v23
    v_cvt_pk_bf16_f32 v99, v22, v23
    s_waitcnt vmcnt(11)
    ds_read_b128 v[112:115], v122 offset:0
    ds_read_b128 v[116:119], v123 offset:0
    s_add_u32 m0, s23, 38048
    s_nop 0
    buffer_load_dwordx4 v4, s[4:7], s21 offen offset:1024 nt lds
    s_waitcnt lgkmcnt(1)
    v_lshlrev_b32 v16, 16, v112
    v_and_b32 v17, 0xffff0000, v112
    v_lshlrev_b32 v18, 16, v113
    v_and_b32 v19, 0xffff0000, v113
    v_lshlrev_b32 v20, 16, v114
    v_and_b32 v21, 0xffff0000, v114
    v_lshlrev_b32 v22, 16, v115
    v_and_b32 v23, 0xffff0000, v115
    v_pk_mul_f32 v[16:17], v[16:17], v[110:111]
    v_pk_mul_f32 v[18:19], v[18:19], v[110:111]
    v_pk_mul_f32 v[20:21], v[20:21], v[110:111]
    v_pk_mul_f32 v[22:23], v[22:23], v[110:111]
    v_cvt_pk_bf16_f32 v16, v16, v17
    v_cvt_pk_bf16_f32 v18, v18, v19
    v_cvt_pk_bf16_f32 v20, v20, v21
    v_cvt_pk_bf16_f32 v22, v22, v23
    v_accvgpr_write_b32 a64, v16
    v_accvgpr_write_b32 a65, v18
    v_accvgpr_write_b32 a66, v20
    v_accvgpr_write_b32 a67, v22
    s_waitcnt lgkmcnt(0)
    v_lshlrev_b32 v16, 16, v116
    v_and_b32 v17, 0xffff0000, v116
    v_lshlrev_b32 v18, 16, v117
    v_and_b32 v19, 0xffff0000, v117
    v_lshlrev_b32 v20, 16, v118
    v_and_b32 v21, 0xffff0000, v118
    v_lshlrev_b32 v22, 16, v119
    v_and_b32 v23, 0xffff0000, v119
    v_pk_mul_f32 v[16:17], v[16:17], v[110:111]
    v_pk_mul_f32 v[18:19], v[18:19], v[110:111]
    v_pk_mul_f32 v[20:21], v[20:21], v[110:111]
    v_pk_mul_f32 v[22:23], v[22:23], v[110:111]
    v_cvt_pk_bf16_f32 v16, v16, v17
    v_cvt_pk_bf16_f32 v18, v18, v19
    v_cvt_pk_bf16_f32 v20, v20, v21
    v_cvt_pk_bf16_f32 v22, v22, v23
    v_accvgpr_write_b32 a68, v16
    v_accvgpr_write_b32 a69, v18
    v_accvgpr_write_b32 a70, v20
    v_accvgpr_write_b32 a71, v22
    s_waitcnt vmcnt(10)
    ds_read_b128 v[112:115], v122 offset:2048
    ds_read_b128 v[116:119], v123 offset:2048
    s_add_u32 m0, s23, 38080
    s_nop 0
    buffer_load_dwordx4 v4, s[4:7], s21 offen offset:2048 nt lds
    s_add_u32 m0, s23, 38112
    s_nop 0
    buffer_load_dwordx4 v4, s[4:7], s21 offen offset:3072 nt lds
    s_add_u32 s21, s21, 32768
    v_mfma_f32_16x16x32_bf16 v[44:47], a[192:195], a[64:67], 0
    v_mfma_f32_16x16x32_bf16 v[56:59], a[196:199], a[64:67], 0
    v_mfma_f32_16x16x32_bf16 v[68:71], a[200:203], a[64:67], 0
    v_mfma_f32_16x16x32_bf16 v[80:83], a[204:207], a[64:67], 0
    ds_read_b128 a[192:195], v1 offset:256
    ds_read_b128 a[196:199], v1 offset:768
    ds_read_b128 a[200:203], v1 offset:17152
    ds_read_b128 a[204:207], v1 offset:17664
    v_mfma_f32_16x16x32_bf16 v[44:47], a[208:211], a[68:71], v[44:47]
    v_mfma_f32_16x16x32_bf16 v[56:59], a[212:215], a[68:71], v[56:59]
    v_mfma_f32_16x16x32_bf16 v[68:71], a[216:219], a[68:71], v[68:71]
    v_mfma_f32_16x16x32_bf16 v[80:83], a[220:223], a[68:71], v[80:83]
    ds_read_b128 a[208:211], v1 offset:320
    ds_read_b128 a[212:215], v1 offset:832
    ds_read_b128 a[216:219], v1 offset:17216
    ds_read_b128 a[220:223], v1 offset:17728
    s_waitcnt lgkmcnt(9)
    v_lshlrev_b32 v16, 16, v112
    v_and_b32 v17, 0xffff0000, v112
    v_lshlrev_b32 v18, 16, v113
    v_and_b32 v19, 0xffff0000, v113
    v_lshlrev_b32 v20, 16, v114
    v_and_b32 v21, 0xffff0000, v114
    v_lshlrev_b32 v22, 16, v115
    v_and_b32 v23, 0xffff0000, v115
    v_pk_mul_f32 v[16:17], v[16:17], v[110:111]
    v_pk_mul_f32 v[18:19], v[18:19], v[110:111]
    v_pk_mul_f32 v[20:21], v[20:21], v[110:111]
    v_pk_mul_f32 v[22:23], v[22:23], v[110:111]
    v_cvt_pk_bf16_f32 v16, v16, v17
    v_cvt_pk_bf16_f32 v18, v18, v19
    v_cvt_pk_bf16_f32 v20, v20, v21
    v_cvt_pk_bf16_f32 v22, v22, v23
    v_accvgpr_write_b32 a72, v16
    v_accvgpr_write_b32 a73, v18
    v_accvgpr_write_b32 a74, v20
    v_accvgpr_write_b32 a75, v22
    s_waitcnt lgkmcnt(8)
    v_lshlrev_b32 v16, 16, v116
    v_and_b32 v17, 0xffff0000, v116
    v_lshlrev_b32 v18, 16, v117
    v_and_b32 v19, 0xffff0000, v117
    v_lshlrev_b32 v20, 16, v118
    v_and_b32 v21, 0xffff0000, v118
    v_lshlrev_b32 v22, 16, v119
    v_and_b32 v23, 0xffff0000, v119
    v_pk_mul_f32 v[16:17], v[16:17], v[110:111]
    v_pk_mul_f32 v[18:19], v[18:19], v[110:111]
    v_pk_mul_f32 v[20:21], v[20:21], v[110:111]
    v_pk_mul_f32 v[22:23], v[22:23], v[110:111]
    v_cvt_pk_bf16_f32 v16, v16, v17
    v_cvt_pk_bf16_f32 v18, v18, v19
    v_cvt_pk_bf16_f32 v20, v20, v21
    v_cvt_pk_bf16_f32 v22, v22, v23
    v_accvgpr_write_b32 a76, v16
    v_accvgpr_write_b32 a77, v18
    v_accvgpr_write_b32 a78, v20
    v_accvgpr_write_b32 a79, v22
    s_waitcnt vmcnt(10)
    ds_read_b128 v[112:115], v122 offset:4096
    ds_read_b128 v[116:119], v123 offset:4096
    s_add_u32 m0, s24, 0
    s_nop 0
    buffer_load_dwordx4 v3, s[8:11], s22 offen offset:0 nt lds
    s_add_u32 m0, s24, 32
    s_nop 0
    buffer_load_dwordx4 v3, s[8:11], s22 offen offset:1024 nt lds
    v_mfma_f32_16x16x32_bf16 v[44:47], a[224:227], a[72:75], v[44:47]
    v_mfma_f32_16x16x32_bf16 v[56:59], a[228:231], a[72:75], v[56:59]
    v_mfma_f32_16x16x32_bf16 v[68:71], a[232:235], a[72:75], v[68:71]
    v_mfma_f32_16x16x32_bf16 v[80:83], a[236:239], a[72:75], v[80:83]
    ds_read_b128 a[224:227], v1 offset:384
    ds_read_b128 a[228:231], v1 offset:896
    ds_read_b128 a[232:235], v1 offset:17280
    ds_read_b128 a[236:239], v1 offset:17792
    v_mfma_f32_16x16x32_bf16 v[44:47], a[240:243], a[76:79], v[44:47]
    v_mfma_f32_16x16x32_bf16 v[56:59], a[244:247], a[76:79], v[56:59]
    v_mfma_f32_16x16x32_bf16 v[68:71], a[248:251], a[76:79], v[68:71]
    v_mfma_f32_16x16x32_bf16 v[80:83], a[252:255], a[76:79], v[80:83]
    ds_read_b128 a[240:243], v1 offset:448
    s_waitcnt lgkmcnt(10)
    ds_read_b128 a[244:247], v1 offset:960
    ds_read_b128 a[248:251], v1 offset:17344
    ds_read_b128 a[252:255], v1 offset:17856
    s_waitcnt lgkmcnt(9)
    v_lshlrev_b32 v16, 16, v112
    v_and_b32 v17, 0xffff0000, v112
    v_lshlrev_b32 v18, 16, v113
    v_and_b32 v19, 0xffff0000, v113
    v_lshlrev_b32 v20, 16, v114
    v_and_b32 v21, 0xffff0000, v114
    v_lshlrev_b32 v22, 16, v115
    v_and_b32 v23, 0xffff0000, v115
    v_pk_mul_f32 v[16:17], v[16:17], v[110:111]
    v_pk_mul_f32 v[18:19], v[18:19], v[110:111]
    v_pk_mul_f32 v[20:21], v[20:21], v[110:111]
    v_pk_mul_f32 v[22:23], v[22:23], v[110:111]
    v_cvt_pk_bf16_f32 v16, v16, v17
    v_cvt_pk_bf16_f32 v18, v18, v19
    v_cvt_pk_bf16_f32 v20, v20, v21
    v_cvt_pk_bf16_f32 v22, v22, v23
    v_accvgpr_write_b32 a80, v16
    v_accvgpr_write_b32 a81, v18
    v_accvgpr_write_b32 a82, v20
    v_accvgpr_write_b32 a83, v22
    s_waitcnt lgkmcnt(8)
    v_lshlrev_b32 v16, 16, v116
    v_and_b32 v17, 0xffff0000, v116
    v_lshlrev_b32 v18, 16, v117
    v_and_b32 v19, 0xffff0000, v117
    v_lshlrev_b32 v20, 16, v118
    v_and_b32 v21, 0xffff0000, v118
    v_lshlrev_b32 v22, 16, v119
    v_and_b32 v23, 0xffff0000, v119
    v_pk_mul_f32 v[16:17], v[16:17], v[110:111]
    v_pk_mul_f32 v[18:19], v[18:19], v[110:111]
    v_pk_mul_f32 v[20:21], v[20:21], v[110:111]
    v_pk_mul_f32 v[22:23], v[22:23], v[110:111]
    v_cvt_pk_bf16_f32 v16, v16, v17
    v_cvt_pk_bf16_f32 v18, v18, v19
    v_cvt_pk_bf16_f32 v20, v20, v21
    v_cvt_pk_bf16_f32 v22, v22, v23
    v_accvgpr_write_b32 a84, v16
    v_accvgpr_write_b32 a85, v18
    v_accvgpr_write_b32 a86, v20
    v_accvgpr_write_b32 a87, v22
    s_waitcnt vmcnt(10)
    ds_read_b128 v[112:115], v122 offset:6144
    ds_read_b128 v[116:119], v123 offset:6144
    s_add_u32 m0, s24, 64
    s_nop 0
    buffer_load_dwordx4 v3, s[8:11], s22 offen offset:2048 nt lds
    s_add_u32 m0, s24, 96
    s_nop 0
    buffer_load_dwordx4 v3, s[8:11], s22 offen offset:3072 nt lds
    v_mfma_f32_16x16x32_bf16 v[44:47], a[192:195], a[80:83], v[44:47]
    v_mfma_f32_16x16x32_bf16 v[56:59], a[196:199], a[80:83], v[56:59]
    v_mfma_f32_16x16x32_bf16 v[68:71], a[200:203], a[80:83], v[68:71]
    v_mfma_f32_16x16x32_bf16 v[80:83], a[204:207], a[80:83], v[80:83]
    v_mfma_f32_16x16x32_bf16 v[44:47], a[208:211], a[84:87], v[44:47]
    v_mfma_f32_16x16x32_bf16 v[56:59], a[212:215], a[84:87], v[56:59]
    v_mfma_f32_16x16x32_bf16 v[68:71], a[216:219], a[84:87], v[68:71]
    v_mfma_f32_16x16x32_bf16 v[80:83], a[220:223], a[84:87], v[80:83]
    s_waitcnt lgkmcnt(1)
    v_lshlrev_b32 v16, 16, v112
    v_and_b32 v17, 0xffff0000, v112
    v_lshlrev_b32 v18, 16, v113
    v_and_b32 v19, 0xffff0000, v113
    v_lshlrev_b32 v20, 16, v114
    v_and_b32 v21, 0xffff0000, v114
    v_lshlrev_b32 v22, 16, v115
    v_and_b32 v23, 0xffff0000, v115
    v_pk_mul_f32 v[16:17], v[16:17], v[110:111]
    v_pk_mul_f32 v[18:19], v[18:19], v[110:111]
    v_pk_mul_f32 v[20:21], v[20:21], v[110:111]
    v_pk_mul_f32 v[22:23], v[22:23], v[110:111]
    v_cvt_pk_bf16_f32 v16, v16, v17
    v_cvt_pk_bf16_f32 v18, v18, v19
    v_cvt_pk_bf16_f32 v20, v20, v21
    v_cvt_pk_bf16_f32 v22, v22, v23
    v_accvgpr_write_b32 a88, v16
    v_accvgpr_write_b32 a89, v18
    v_accvgpr_write_b32 a90, v20
    v_accvgpr_write_b32 a91, v22
    s_waitcnt lgkmcnt(0)
    v_lshlrev_b32 v16, 16, v116
    v_and_b32 v17, 0xffff0000, v116
    v_lshlrev_b32 v18, 16, v117
    v_and_b32 v19, 0xffff0000, v117
    v_lshlrev_b32 v20, 16, v118
    v_and_b32 v21, 0xffff0000, v118
    v_lshlrev_b32 v22, 16, v119
    v_and_b32 v23, 0xffff0000, v119
    v_pk_mul_f32 v[16:17], v[16:17], v[110:111]
    v_pk_mul_f32 v[18:19], v[18:19], v[110:111]
    v_pk_mul_f32 v[20:21], v[20:21], v[110:111]
    v_pk_mul_f32 v[22:23], v[22:23], v[110:111]
    v_cvt_pk_bf16_f32 v16, v16, v17
    v_cvt_pk_bf16_f32 v18, v18, v19
    v_cvt_pk_bf16_f32 v20, v20, v21
    v_cvt_pk_bf16_f32 v22, v22, v23
    v_accvgpr_write_b32 a92, v16
    v_accvgpr_write_b32 a93, v18
    v_accvgpr_write_b32 a94, v20
    v_accvgpr_write_b32 a95, v22
    v_mfma_f32_16x16x32_bf16 v[44:47], a[224:227], a[88:91], v[44:47]
    v_mfma_f32_16x16x32_bf16 v[56:59], a[228:231], a[88:91], v[56:59]
    v_mfma_f32_16x16x32_bf16 v[68:71], a[232:235], a[88:91], v[68:71]
    v_mfma_f32_16x16x32_bf16 v[80:83], a[236:239], a[88:91], v[80:83]
    v_mfma_f32_16x16x32_bf16 v[44:47], a[240:243], a[92:95], v[44:47]
    v_mfma_f32_16x16x32_bf16 v[56:59], a[244:247], a[92:95], v[56:59]
    v_mfma_f32_16x16x32_bf16 v[68:71], a[248:251], a[92:95], v[68:71]
    v_mfma_f32_16x16x32_bf16 v[80:83], a[252:255], a[92:95], v[80:83]
    s_nop 4
    v_max3_f32 v12, v44, v45, v46
    v_max3_f32 v12, v12, v47, v56
    v_max3_f32 v12, v12, v57, v58
    v_max3_f32 v12, v12, v59, v68
    v_max3_f32 v12, v12, v69, v70
    v_max3_f32 v12, v12, v71, v80
    v_max3_f32 v12, v12, v81, v82
    v_max_f32 v12, v12, v83
    v_mov_b32 v13, v12
    s_nop 1
    v_permlane16_swap_b32 v13, v12
    s_nop 1
    v_max_f32 v12, v13, v12
    v_mov_b32 v13, v12
    s_nop 1
    v_permlane32_swap_b32 v13, v12
    s_nop 1
    v_max_f32 v12, v13, v12
    v_add_f32 v12, 0x42080000, v12
    v_max_f32 v12, 0xff7fffff, v12
    v_sub_f32 v32, 0, v12
    v_sub_f32 v33, 0, v12
    v_sub_f32 v34, 0, v12
    v_sub_f32 v35, 0, v12
    v_sub_f32 v16, v44, v12
    v_sub_f32 v17, v45, v12
    v_sub_f32 v18, v46, v12
    v_sub_f32 v19, v47, v12
    v_exp_f32 v16, v16
    v_exp_f32 v17, v17
    v_exp_f32 v18, v18
    v_exp_f32 v19, v19
    v_add_f32 v8, v16, v17
    v_cvt_pk_bf16_f32 v100, v16, v17
    v_add_f32 v8, v8, v18
    v_add_f32 v8, v8, v19
    v_cvt_pk_bf16_f32 v101, v18, v19
    v_sub_f32 v20, v56, v12
    v_sub_f32 v21, v57, v12
    v_sub_f32 v22, v58, v12
    s_add_u32 m0, s24, 4224
    s_nop 0
    buffer_load_dwordx4 v4, s[8:11], s22 offen offset:0 nt lds
    v_sub_f32 v23, v59, v12
    v_exp_f32 v20, v20
    v_exp_f32 v21, v21
    v_exp_f32 v22, v22
    v_exp_f32 v23, v23
    v_add_f32 v8, v8, v20
    v_add_f32 v8, v8, v21
    v_cvt_pk_bf16_f32 v102, v20, v21
    v_add_f32 v8, v8, v22
    v_add_f32 v8, v8, v23
    v_cvt_pk_bf16_f32 v103, v22, v23
    v_sub_f32 v16, v68, v12
    v_sub_f32 v17, v69, v12
    v_sub_f32 v18, v70, v12
    v_sub_f32 v19, v71, v12
    v_exp_f32 v16, v16
    v_exp_f32 v17, v17
    v_exp_f32 v18, v18
    v_exp_f32 v19, v19
    v_add_f32 v8, v8, v16
    v_add_f32 v8, v8, v17
    v_cvt_pk_bf16_f32 v104, v16, v17
    v_add_f32 v8, v8, v18
    v_add_f32 v8, v8, v19
    v_cvt_pk_bf16_f32 v105, v18, v19
    v_sub_f32 v20, v80, v12
    v_sub_f32 v21, v81, v12
    v_sub_f32 v22, v82, v12
    v_sub_f32 v23, v83, v12
    v_exp_f32 v20, v20
    v_exp_f32 v21, v21
    v_exp_f32 v22, v22
    v_exp_f32 v23, v23
    v_add_f32 v8, v8, v20
    v_add_f32 v8, v8, v21
    v_cvt_pk_bf16_f32 v106, v20, v21
    v_add_f32 v8, v8, v22
    v_add_f32 v8, v8, v23
    v_cvt_pk_bf16_f32 v107, v22, v23
    s_add_u32 m0, s24, 4256
    s_nop 0
    buffer_load_dwordx4 v4, s[8:11], s22 offen offset:1024 nt lds
    s_add_u32 m0, s24, 4288
    s_nop 0
    buffer_load_dwordx4 v4, s[8:11], s22 offen offset:2048 nt lds
    s_add_u32 m0, s24, 4320
    s_nop 0
    buffer_load_dwordx4 v4, s[8:11], s22 offen offset:3072 nt lds
    s_add_u32 s22, s22, 32768
    v_mov_b32 v15, v5
    buffer_load_dword a168, off, s[72:75], s76
    s_waitcnt lgkmcnt(0)
    s_barrier
    s_add_u32 m0, s23, 0
    s_nop 0
    buffer_load_dwordx4 v3, s[4:7], s21 offen offset:0 nt lds
    s_add_u32 m0, s23, 32
    s_nop 0
    buffer_load_dwordx4 v3, s[4:7], s21 offen offset:1024 nt lds
    s_add_u32 m0, s23, 64
    s_nop 0
    buffer_load_dwordx4 v3, s[4:7], s21 offen offset:2048 nt lds
    s_add_u32 m0, s23, 96
    s_nop 0
    buffer_load_dwordx4 v3, s[4:7], s21 offen offset:3072 nt lds
    s_add_u32 m0, s23, 4224
    s_nop 0
    buffer_load_dwordx4 v4, s[4:7], s21 offen offset:0 nt lds
    s_add_u32 m0, s23, 4256
    s_nop 0
    buffer_load_dwordx4 v4, s[4:7], s21 offen offset:1024 nt lds
    s_add_u32 m0, s23, 4288
    s_nop 0
    buffer_load_dwordx4 v4, s[4:7], s21 offen offset:2048 nt lds
    s_add_u32 m0, s23, 4320
    s_nop 0
    buffer_load_dwordx4 v4, s[4:7], s21 offen offset:3072 nt lds
    s_add_u32 s21, s21, 32768
    s_waitcnt vmcnt(17)
    s_barrier
    ds_read_b128 a[192:195], v1 offset:33792
    ds_read_b128 a[196:199], v1 offset:33856
    ds_read_b128 a[200:203], v1 offset:33920
    ds_read_b128 a[204:207], v1 offset:33984
    ds_read_b128 a[208:211], v1 offset:34048
    ds_read_b128 a[212:215], v1 offset:34112
    ds_read_b128 a[216:219], v1 offset:34176
    ds_read_b128 a[220:223], v1 offset:34240
    s_cmp_eq_u32 s77, 1
    s_cbranch_scc1 L_loop1
.p2align 6
L_loop0:
    s_waitcnt lgkmcnt(4)
    v_mfma_f32_16x16x32_bf16 v[36:39], a[192:195], a[0:3], v[24:27]
    s_add_u32 m0, s24, 33792
    ds_read_b128 a[252:255], v1 offset:34752
    v_add_f32 v9, v9, v6
    v_mfma_f32_16x16x32_bf16 v[36:39], a[196:199], a[4:7], v[36:39]
    buffer_load_dwordx4 v3, s[8:11], s22 offen offset:0 nt lds
    v_mfma_f32_16x16x32_bf16 v[36:39], a[200:203], a[8:11], v[36:39]
    ds_read_b128 a[248:251], v1 offset:34688
    v_add_f32 v10, v10, v7
    v_mfma_f32_16x16x32_bf16 v[36:39], a[204:207], a[12:15], v[36:39]
    s_waitcnt lgkmcnt(3)
    ds_read_b128 a[244:247], v1 offset:34624
    v_add_f32 v11, v11, v8
    v_mfma_f32_16x16x32_bf16 v[36:39], a[208:211], a[16:19], v[36:39]
    ds_read_b128 a[240:243], v1 offset:34560
    v_mfma_f32_16x16x32_bf16 v[36:39], a[212:215], a[20:23], v[36:39]
    ds_read_b128 a[236:239], v1 offset:34496
    v_mfma_f32_16x16x32_bf16 v[36:39], a[216:219], a[24:27], v[36:39]
    s_waitcnt lgkmcnt(5)
    ds_read_b128 a[232:235], v1 offset:34432
    v_mfma_f32_16x16x32_bf16 v[36:39], a[220:223], a[28:31], v[36:39]
    s_add_u32 m0, s24, 33824
    ds_read_b128 a[228:231], v1 offset:34368
    v_mfma_f32_16x16x32_bf16 v[40:43], a[220:223], a[60:63], v[28:31]
    buffer_load_dwordx4 v3, s[8:11], s22 offen offset:1024 nt lds
    v_mfma_f32_16x16x32_bf16 v[40:43], a[216:219], a[56:59], v[40:43]
    ds_read_b128 a[224:227], v1 offset:34304
    v_mfma_f32_16x16x32_bf16 v[40:43], a[212:215], a[52:55], v[40:43]
    v_mfma_f32_16x16x32_bf16 v[40:43], a[208:211], a[48:51], v[40:43]
    v_mfma_f32_16x16x32_bf16 v[40:43], a[204:207], a[44:47], v[40:43]
    v_mfma_f32_16x16x32_bf16 v[40:43], a[200:203], a[40:43], v[40:43]
    v_exp_f32 v16, v36
    v_mfma_f32_16x16x32_bf16 v[40:43], a[196:199], a[36:39], v[40:43]
    s_add_u32 m0, s24, 33856
    v_mfma_f32_16x16x32_bf16 v[40:43], a[192:195], a[32:35], v[40:43]
    buffer_load_dwordx4 v3, s[8:11], s22 offen offset:2048 nt lds
    v_mfma_f32_16x16x32_bf16 v[44:47], a[192:195], a[64:67], v[32:35]
    ds_read_b128 a[192:195], v1 offset:50688
    v_mfma_f32_16x16x32_bf16 v[44:47], a[196:199], a[68:71], v[44:47]
    v_exp_f32 v17, v37
    v_mfma_f32_16x16x32_bf16 v[44:47], a[200:203], a[72:75], v[44:47]
    ds_read_b128 a[196:199], v1 offset:50752
    v_add_f32 v6, v16, v17
    v_mfma_f32_16x16x32_bf16 v[44:47], a[204:207], a[76:79], v[44:47]
    ds_read_b128 a[200:203], v1 offset:50816
    v_cvt_pk_bf16_f32 v108, v16, v17
    v_mfma_f32_16x16x32_bf16 v[44:47], a[208:211], a[80:83], v[44:47]
    ds_read_b128 a[204:207], v1 offset:50880
    v_mfma_f32_16x16x32_bf16 v[44:47], a[212:215], a[84:87], v[44:47]
    s_add_u32 m0, s24, 33888
    v_exp_f32 v18, v38
    v_mfma_f32_16x16x32_bf16 v[44:47], a[216:219], a[88:91], v[44:47]
    buffer_load_dwordx4 v3, s[8:11], s22 offen offset:3072 nt lds
    v_mfma_f32_16x16x32_bf16 v[44:47], a[220:223], a[92:95], v[44:47]
    s_waitcnt lgkmcnt(4)
    ds_read_b128 a[208:211], v1 offset:50944
    v_add_f32 v6, v6, v18
    v_mfma_f32_16x16x32_bf16 v[56:59], a[252:255], a[92:95], v[32:35]
    v_exp_f32 v19, v39
    v_mfma_f32_16x16x32_bf16 v[56:59], a[248:251], a[88:91], v[56:59]
    ds_read_b128 a[212:215], v1 offset:51008
    v_add_f32 v6, v6, v19
    v_mfma_f32_16x16x32_bf16 v[56:59], a[244:247], a[84:87], v[56:59]
    ds_read_b128 a[216:219], v1 offset:51072
    v_cvt_pk_bf16_f32 v109, v18, v19
    v_mfma_f32_16x16x32_bf16 v[56:59], a[240:243], a[80:83], v[56:59]
    ds_read_b128 a[220:223], v1 offset:51136
    v_mfma_f32_16x16x32_bf16 v[56:59], a[236:239], a[76:79], v[56:59]
    s_add_u32 m0, s24, 38016
    v_exp_f32 v20, v40
    v_mfma_f32_16x16x32_bf16 v[56:59], a[232:235], a[72:75], v[56:59]
    buffer_load_dwordx4 v4, s[8:11], s22 offen offset:0 nt lds
    v_mfma_f32_16x16x32_bf16 v[56:59], a[228:231], a[68:71], v[56:59]
    v_mfma_f32_16x16x32_bf16 v[56:59], a[224:227], a[64:67], v[56:59]
    v_exp_f32 v21, v41
    v_mfma_f32_16x16x32_bf16 v[52:55], a[224:227], a[32:35], v[28:31]
    v_add_f32 v7, v20, v21
    v_cvt_pk_bf16_f32 v116, v20, v21
    v_mfma_f32_16x16x32_bf16 v[52:55], a[228:231], a[36:39], v[52:55]
    v_mfma_f32_16x16x32_bf16 v[52:55], a[232:235], a[40:43], v[52:55]
    v_mfma_f32_16x16x32_bf16 v[52:55], a[236:239], a[44:47], v[52:55]
    s_add_u32 m0, s24, 38048
    v_exp_f32 v22, v42
    v_mfma_f32_16x16x32_bf16 v[52:55], a[240:243], a[48:51], v[52:55]
    buffer_load_dwordx4 v4, s[8:11], s22 offen offset:1024 nt lds
    v_mfma_f32_16x16x32_bf16 v[52:55], a[244:247], a[52:55], v[52:55]
    v_add_f32 v7, v7, v22
    v_mfma_f32_16x16x32_bf16 v[52:55], a[248:251], a[56:59], v[52:55]
    v_mfma_f32_16x16x32_bf16 v[52:55], a[252:255], a[60:63], v[52:55]
    v_exp_f32 v23, v43
    v_mfma_f32_16x16x32_bf16 v[48:51], a[252:255], a[28:31], v[24:27]
    ds_read_b128 a[252:255], v1 offset:51648
    v_add_f32 v7, v7, v23
    v_mfma_f32_16x16x32_bf16 v[48:51], a[248:251], a[24:27], v[48:51]
    ds_read_b128 a[248:251], v1 offset:51584
    v_cvt_pk_bf16_f32 v117, v22, v23
    v_mfma_f32_16x16x32_bf16 v[48:51], a[244:247], a[20:23], v[48:51]
    s_add_u32 m0, s24, 38080
    v_exp_f32 v16, v44
    v_mfma_f32_16x16x32_bf16 v[48:51], a[240:243], a[16:19], v[48:51]
    buffer_load_dwordx4 v4, s[8:11], s22 offen offset:2048 nt lds
    v_mfma_f32_16x16x32_bf16 v[48:51], a[236:239], a[12:15], v[48:51]
    ds_read_b128 a[244:247], v1 offset:51520
    v_mfma_f32_16x16x32_bf16 v[48:51], a[232:235], a[8:11], v[48:51]
    ds_read_b128 a[240:243], v1 offset:51456
    v_mfma_f32_16x16x32_bf16 v[48:51], a[228:231], a[4:7], v[48:51]
    v_exp_f32 v17, v45
    v_mfma_f32_16x16x32_bf16 v[48:51], a[224:227], a[0:3], v[48:51]
    s_waitcnt lgkmcnt(4)
    ds_read_b128 a[236:239], v1 offset:51392
    v_add_f32 v8, v16, v17
    v_mfma_f32_16x16x32_bf16 v[60:63], a[192:195], a[0:3], v[24:27]
    ds_read_b128 a[232:235], v1 offset:51328
    v_cvt_pk_bf16_f32 v124, v16, v17
    v_mfma_f32_16x16x32_bf16 v[60:63], a[196:199], a[4:7], v[60:63]
    s_add_u32 m0, s24, 38112
    v_exp_f32 v18, v46
    v_mfma_f32_16x16x32_bf16 v[60:63], a[200:203], a[8:11], v[60:63]
    buffer_load_dwordx4 v4, s[8:11], s22 offen offset:3072 nt lds
    v_mfma_f32_16x16x32_bf16 v[60:63], a[204:207], a[12:15], v[60:63]
    ds_read_b128 a[228:231], v1 offset:51264
    v_add_f32 v8, v8, v18
    v_mfma_f32_16x16x32_bf16 v[60:63], a[208:211], a[16:19], v[60:63]
    ds_read_b128 a[224:227], v1 offset:51200
    v_mfma_f32_16x16x32_bf16 v[60:63], a[212:215], a[20:23], v[60:63]
    v_exp_f32 v19, v47
    v_mfma_f32_16x16x32_bf16 v[60:63], a[216:219], a[24:27], v[60:63]
    v_add_f32 v8, v8, v19
    v_cvt_pk_bf16_f32 v125, v18, v19
    v_mfma_f32_16x16x32_bf16 v[60:63], a[220:223], a[28:31], v[60:63]
    v_mfma_f32_16x16x32_bf16 v[64:67], a[220:223], a[60:63], v[28:31]
    v_mfma_f32_16x16x32_bf16 v[64:67], a[216:219], a[56:59], v[64:67]
    v_exp_f32 v20, v56
    v_mfma_f32_16x16x32_bf16 v[64:67], a[212:215], a[52:55], v[64:67]
    v_add_f32 v8, v8, v20
    v_mfma_f32_16x16x32_bf16 v[64:67], a[208:211], a[48:51], v[64:67]
    s_waitcnt vmcnt(17) lgkmcnt(0)
    s_barrier
    v_mfma_f32_16x16x32_bf16 v[64:67], a[204:207], a[44:47], v[64:67]
    s_add_u32 s22, s22, 32768
    v_exp_f32 v21, v57
    v_mfma_f32_16x16x32_bf16 v[64:67], a[200:203], a[40:43], v[64:67]
    v_add_f32 v8, v8, v21
    v_cvt_pk_bf16_f32 v126, v20, v21
    v_mfma_f32_16x16x32_bf16 v[64:67], a[196:199], a[36:39], v[64:67]
    buffer_load_dword a168, v15, s[72:75], s76 offen
    v_mfma_f32_16x16x32_bf16 v[64:67], a[192:195], a[32:35], v[64:67]
    v_mfma_f32_16x16x32_bf16 v[68:71], a[192:195], a[64:67], v[32:35]
    v_exp_f32 v22, v58
    v_mfma_f32_16x16x32_bf16 v[68:71], a[196:199], a[68:71], v[68:71]
    ds_read_b64_tr_b16 a[192:193], v2 offset:0
    v_add_f32 v8, v8, v22
    v_mfma_f32_16x16x32_bf16 v[68:71], a[200:203], a[72:75], v[68:71]
    ds_read_b64_tr_b16 a[194:195], v2 offset:512
    v_mfma_f32_16x16x32_bf16 v[68:71], a[204:207], a[76:79], v[68:71]
    s_add_u32 m0, s23, 33792
    v_exp_f32 v23, v59
    v_mfma_f32_16x16x32_bf16 v[68:71], a[208:211], a[80:83], v[68:71]
    buffer_load_dwordx4 v3, s[4:7], s21 offen offset:0 nt lds
    v_mfma_f32_16x16x32_bf16 v[68:71], a[212:215], a[84:87], v[68:71]
    ds_read_b64_tr_b16 a[196:197], v2 offset:16896
    v_add_f32 v8, v8, v23
    v_mfma_f32_16x16x32_bf16 v[68:71], a[216:219], a[88:91], v[68:71]
    ds_read_b64_tr_b16 a[198:199], v2 offset:17408
    v_cvt_pk_bf16_f32 v127, v22, v23
    v_mfma_f32_16x16x32_bf16 v[68:71], a[220:223], a[92:95], v[68:71]
    v_exp_f32 v16, v52
    v_mfma_f32_16x16x32_bf16 v[80:83], a[252:255], a[92:95], v[32:35]
    ds_read_b64_tr_b16 a[204:205], v2 offset:16928
    v_add_f32 v7, v7, v16
    v_mfma_f32_16x16x32_bf16 v[80:83], a[248:251], a[88:91], v[80:83]
    ds_read_b64_tr_b16 a[206:207], v2 offset:17440
    v_mfma_f32_16x16x32_bf16 v[80:83], a[244:247], a[84:87], v[80:83]
    ds_read_b64_tr_b16 a[200:201], v2 offset:32
    v_mfma_f32_16x16x32_bf16 v[80:83], a[240:243], a[80:83], v[80:83]
    v_exp_f32 v17, v53
    v_mfma_f32_16x16x32_bf16 v[80:83], a[236:239], a[76:79], v[80:83]
    ds_read_b64_tr_b16 a[202:203], v2 offset:544
    v_add_f32 v7, v7, v17
    v_mfma_f32_16x16x32_bf16 v[80:83], a[232:235], a[72:75], v[80:83]
    s_add_u32 m0, s23, 33824
    ds_read_b64_tr_b16 a[208:209], v2 offset:64
    v_cvt_pk_bf16_f32 v118, v16, v17
    v_mfma_f32_16x16x32_bf16 v[80:83], a[228:231], a[68:71], v[80:83]
    buffer_load_dwordx4 v3, s[4:7], s21 offen offset:1024 nt lds
    v_mfma_f32_16x16x32_bf16 v[80:83], a[224:227], a[64:67], v[80:83]
    v_exp_f32 v18, v54
    v_mfma_f32_16x16x32_bf16 v[76:79], a[224:227], a[32:35], v[28:31]
    ds_read_b64_tr_b16 a[210:211], v2 offset:576
    v_add_f32 v7, v7, v18
    v_mfma_f32_16x16x32_bf16 v[76:79], a[228:231], a[36:39], v[76:79]
    ds_read_b64_tr_b16 a[212:213], v2 offset:16960
    v_mfma_f32_16x16x32_bf16 v[76:79], a[232:235], a[40:43], v[76:79]
    v_exp_f32 v19, v55
    v_mfma_f32_16x16x32_bf16 v[76:79], a[236:239], a[44:47], v[76:79]
    ds_read_b64_tr_b16 a[214:215], v2 offset:17472
    v_add_f32 v7, v7, v19
    v_mfma_f32_16x16x32_bf16 v[76:79], a[240:243], a[48:51], v[76:79]
    ds_read_b64_tr_b16 a[220:221], v2 offset:16992
    v_cvt_pk_bf16_f32 v119, v18, v19
    v_mfma_f32_16x16x32_bf16 v[76:79], a[244:247], a[52:55], v[76:79]
    v_exp_f32 v20, v48
    v_mfma_f32_16x16x32_bf16 v[76:79], a[248:251], a[56:59], v[76:79]
    ds_read_b64_tr_b16 a[222:223], v2 offset:17504
    v_add_f32 v6, v6, v20
    v_mfma_f32_16x16x32_bf16 v[76:79], a[252:255], a[60:63], v[76:79]
    s_add_u32 m0, s23, 33856
    ds_read_b64_tr_b16 a[216:217], v2 offset:96
    v_mfma_f32_16x16x32_bf16 v[72:75], a[252:255], a[28:31], v[24:27]
    buffer_load_dwordx4 v3, s[4:7], s21 offen offset:2048 nt lds
    v_mfma_f32_16x16x32_bf16 v[72:75], a[248:251], a[24:27], v[72:75]
    v_exp_f32 v21, v49
    v_mfma_f32_16x16x32_bf16 v[72:75], a[244:247], a[20:23], v[72:75]
    ds_read_b64_tr_b16 a[218:219], v2 offset:608
    v_add_f32 v6, v6, v21
    v_mfma_f32_16x16x32_bf16 v[72:75], a[240:243], a[16:19], v[72:75]
    v_cvt_pk_bf16_f32 v110, v20, v21
    v_mfma_f32_16x16x32_bf16 v[72:75], a[236:239], a[12:15], v[72:75]
    v_mfma_f32_16x16x32_bf16 v[72:75], a[232:235], a[8:11], v[72:75]
    v_exp_f32 v22, v50
    v_mfma_f32_16x16x32_bf16 v[72:75], a[228:231], a[4:7], v[72:75]
    v_add_f32 v6, v6, v22
    v_mfma_f32_16x16x32_bf16 v[72:75], a[224:227], a[0:3], v[72:75]
    s_waitcnt lgkmcnt(1)
    ds_read_b64_tr_b16 a[224:225], v2 offset:128
    v_mfma_f32_16x16x32_bf16 a[96:99], v[84:87], a[192:195], a[96:99]
    v_exp_f32 v23, v51
    v_mfma_f32_16x16x32_bf16 a[96:99], v[88:91], a[196:199], a[96:99]
    s_add_u32 m0, s23, 33888
    ds_read_b64_tr_b16 a[226:227], v2 offset:640
    v_add_f32 v6, v6, v23
    v_mfma_f32_16x16x32_bf16 a[100:103], v[96:99], a[196:199], a[100:103]
    buffer_load_dwordx4 v3, s[4:7], s21 offen offset:3072 nt lds
    v_mfma_f32_16x16x32_bf16 a[100:103], v[92:95], a[192:195], a[100:103]
    ds_read_b64_tr_b16 a[228:229], v2 offset:17024
    v_cvt_pk_bf16_f32 v111, v22, v23
    v_mfma_f32_16x16x32_bf16 a[104:107], v[100:103], a[192:195], a[104:107]
    v_exp_f32 v16, v60
    v_mfma_f32_16x16x32_bf16 a[104:107], v[104:107], a[196:199], a[104:107]
    ds_read_b64_tr_b16 a[230:231], v2 offset:17536
    v_add_f32 v6, v6, v16
    v_mfma_f32_16x16x32_bf16 a[116:119], v[104:107], a[204:207], a[116:119]
    ds_read_b64_tr_b16 a[236:237], v2 offset:17056
    v_mfma_f32_16x16x32_bf16 a[116:119], v[100:103], a[200:203], a[116:119]
    ds_read_b64_tr_b16 a[238:239], v2 offset:17568
    v_mfma_f32_16x16x32_bf16 a[112:115], v[92:95], a[200:203], a[112:115]
    v_exp_f32 v17, v61
    v_mfma_f32_16x16x32_bf16 a[112:115], v[96:99], a[204:207], a[112:115]
    ds_read_b64_tr_b16 a[232:233], v2 offset:160
    v_add_f32 v6, v6, v17
    v_mfma_f32_16x16x32_bf16 a[108:111], v[88:91], a[204:207], a[108:111]
    ds_read_b64_tr_b16 a[234:235], v2 offset:672
    v_cvt_pk_bf16_f32 v112, v16, v17
    v_mfma_f32_16x16x32_bf16 a[108:111], v[84:87], a[200:203], a[108:111]
    s_add_u32 m0, s23, 38016
    v_exp_f32 v18, v62
    v_mfma_f32_16x16x32_bf16 a[120:123], v[84:87], a[208:211], a[120:123]
    buffer_load_dwordx4 v4, s[4:7], s21 offen offset:0 nt lds
    v_mfma_f32_16x16x32_bf16 a[120:123], v[88:91], a[212:215], a[120:123]
    ds_read_b64_tr_b16 a[240:241], v2 offset:192
    v_add_f32 v6, v6, v18
    v_mfma_f32_16x16x32_bf16 a[124:127], v[96:99], a[212:215], a[124:127]
    ds_read_b64_tr_b16 a[242:243], v2 offset:704
    v_mfma_f32_16x16x32_bf16 a[124:127], v[92:95], a[208:211], a[124:127]
    v_exp_f32 v19, v63
    v_mfma_f32_16x16x32_bf16 a[128:131], v[100:103], a[208:211], a[128:131]
    ds_read_b64_tr_b16 a[244:245], v2 offset:17088
    v_add_f32 v6, v6, v19
    v_mfma_f32_16x16x32_bf16 a[128:131], v[104:107], a[212:215], a[128:131]
    ds_read_b64_tr_b16 a[246:247], v2 offset:17600
    v_cvt_pk_bf16_f32 v113, v18, v19
    v_mfma_f32_16x16x32_bf16 a[140:143], v[104:107], a[220:223], a[140:143]
    s_waitcnt lgkmcnt(4)
    ds_read_b64_tr_b16 a[252:253], v2 offset:17120
    v_mfma_f32_16x16x32_bf16 a[140:143], v[100:103], a[216:219], a[140:143]
    v_exp_f32 v20, v64
    v_mfma_f32_16x16x32_bf16 a[136:139], v[92:95], a[216:219], a[136:139]
    ds_read_b64_tr_b16 a[254:255], v2 offset:17632
    v_add_f32 v7, v7, v20
    v_mfma_f32_16x16x32_bf16 a[136:139], v[96:99], a[220:223], a[136:139]
    s_add_u32 m0, s23, 38048
    ds_read_b64_tr_b16 a[248:249], v2 offset:224
    v_mfma_f32_16x16x32_bf16 a[132:135], v[88:91], a[220:223], a[132:135]
    buffer_load_dwordx4 v4, s[4:7], s21 offen offset:1024 nt lds
    v_mfma_f32_16x16x32_bf16 a[132:135], v[84:87], a[216:219], a[132:135]
    v_exp_f32 v21, v65
    v_mfma_f32_16x16x32_bf16 a[144:147], v[84:87], a[224:227], a[144:147]
    ds_read_b64_tr_b16 a[250:251], v2 offset:736
    v_add_f32 v7, v7, v21
    v_mfma_f32_16x16x32_bf16 a[144:147], v[88:91], a[228:231], a[144:147]
    ds_read_b64_tr_b16 a[192:193], v2 offset:256
    v_cvt_pk_bf16_f32 v120, v20, v21
    v_mfma_f32_16x16x32_bf16 a[148:151], v[96:99], a[228:231], a[148:151]
    v_exp_f32 v22, v66
    v_mfma_f32_16x16x32_bf16 a[148:151], v[92:95], a[224:227], a[148:151]
    ds_read_b64_tr_b16 a[194:195], v2 offset:768
    v_add_f32 v7, v7, v22
    v_mfma_f32_16x16x32_bf16 a[152:155], v[100:103], a[224:227], a[152:155]
    ds_read_b64_tr_b16 a[196:197], v2 offset:17152
    v_mfma_f32_16x16x32_bf16 a[152:155], v[104:107], a[228:231], a[152:155]
    ds_read_b64_tr_b16 a[198:199], v2 offset:17664
    v_mfma_f32_16x16x32_bf16 v[132:135], v[104:107], a[236:239], v[132:135]
    v_exp_f32 v23, v67
    v_mfma_f32_16x16x32_bf16 v[132:135], v[100:103], a[232:235], v[132:135]
    s_add_u32 m0, s23, 38080
    ds_read_b64_tr_b16 a[204:205], v2 offset:17184
    v_add_f32 v7, v7, v23
    v_mfma_f32_16x16x32_bf16 a[160:163], v[92:95], a[232:235], a[160:163]
    buffer_load_dwordx4 v4, s[4:7], s21 offen offset:2048 nt lds
    v_mfma_f32_16x16x32_bf16 a[160:163], v[96:99], a[236:239], a[160:163]
    v_exp_f32 v16, v68
    v_mfma_f32_16x16x32_bf16 a[156:159], v[88:91], a[236:239], a[156:159]
    ds_read_b64_tr_b16 a[206:207], v2 offset:17696
    v_cvt_pk_bf16_f32 v121, v22, v23
    v_mfma_f32_16x16x32_bf16 a[156:159], v[84:87], a[232:235], a[156:159]
    s_waitcnt lgkmcnt(4)
    ds_read_b64_tr_b16 a[200:201], v2 offset:288
    v_add_f32 v8, v8, v16
    v_mfma_f32_16x16x32_bf16 v[136:139], v[84:87], a[240:243], v[136:139]
    ds_read_b64_tr_b16 a[202:203], v2 offset:800
    v_mfma_f32_16x16x32_bf16 v[136:139], v[88:91], a[244:247], v[136:139]
    v_exp_f32 v17, v69
    v_mfma_f32_16x16x32_bf16 v[140:143], v[96:99], a[244:247], v[140:143]
    ds_read_b64_tr_b16 a[208:209], v2 offset:320
    v_add_f32 v8, v8, v17
    v_mfma_f32_16x16x32_bf16 v[140:143], v[92:95], a[240:243], v[140:143]
    ds_read_b64_tr_b16 a[210:211], v2 offset:832
    v_cvt_pk_bf16_f32 v128, v16, v17
    v_mfma_f32_16x16x32_bf16 v[144:147], v[100:103], a[240:243], v[144:147]
    ds_read_b64_tr_b16 a[212:213], v2 offset:17216
    v_mfma_f32_16x16x32_bf16 v[144:147], v[104:107], a[244:247], v[144:147]
    s_add_u32 m0, s23, 38112
    v_exp_f32 v18, v70
    v_mfma_f32_16x16x32_bf16 v[156:159], v[104:107], a[252:255], v[156:159]
    buffer_load_dwordx4 v4, s[4:7], s21 offen offset:3072 nt lds
    v_mfma_f32_16x16x32_bf16 v[156:159], v[100:103], a[248:251], v[156:159]
    ds_read_b64_tr_b16 a[214:215], v2 offset:17728
    v_add_f32 v8, v8, v18
    v_mfma_f32_16x16x32_bf16 v[152:155], v[92:95], a[248:251], v[152:155]
    v_exp_f32 v19, v71
    v_mfma_f32_16x16x32_bf16 v[152:155], v[96:99], a[252:255], v[152:155]
    ds_read_b64_tr_b16 a[220:221], v2 offset:17248
    v_add_f32 v8, v8, v19
    v_mfma_f32_16x16x32_bf16 v[148:151], v[88:91], a[252:255], v[148:151]
    ds_read_b64_tr_b16 a[222:223], v2 offset:17760
    v_cvt_pk_bf16_f32 v129, v18, v19
    v_mfma_f32_16x16x32_bf16 v[148:151], v[84:87], a[248:251], v[148:151]
    ds_read_b64_tr_b16 a[216:217], v2 offset:352
    v_mfma_f32_16x16x32_bf16 v[160:163], v[84:87], a[192:195], v[160:163]
    s_waitcnt lgkmcnt(4)
    v_exp_f32 v20, v80
    v_mfma_f32_16x16x32_bf16 v[160:163], v[88:91], a[196:199], v[160:163]
    ds_read_b64_tr_b16 a[218:219], v2 offset:864
    v_add_f32 v8, v8, v20
    v_mfma_f32_16x16x32_bf16 v[164:167], v[96:99], a[196:199], v[164:167]
    ds_read_b64_tr_b16 a[224:225], v2 offset:384
    v_mfma_f32_16x16x32_bf16 v[164:167], v[92:95], a[192:195], v[164:167]
    ds_read_b64_tr_b16 a[226:227], v2 offset:896
    v_mfma_f32_16x16x32_bf16 v[168:171], v[100:103], a[192:195], v[168:171]
    s_add_u32 s21, s21, 32768
    v_exp_f32 v21, v81
    v_mfma_f32_16x16x32_bf16 v[168:171], v[104:107], a[196:199], v[168:171]
    ds_read_b64_tr_b16 a[228:229], v2 offset:17280
    v_add_f32 v8, v8, v21
    v_mfma_f32_16x16x32_bf16 v[180:183], v[104:107], a[204:207], v[180:183]
    ds_read_b64_tr_b16 a[230:231], v2 offset:17792
    v_cvt_pk_bf16_f32 v130, v20, v21
    v_mfma_f32_16x16x32_bf16 v[180:183], v[100:103], a[200:203], v[180:183]
    v_exp_f32 v22, v82
    v_mfma_f32_16x16x32_bf16 v[176:179], v[92:95], a[200:203], v[176:179]
    ds_read_b64_tr_b16 a[236:237], v2 offset:17312
    v_add_f32 v8, v8, v22
    v_mfma_f32_16x16x32_bf16 v[176:179], v[96:99], a[204:207], v[176:179]
    ds_read_b64_tr_b16 a[238:239], v2 offset:17824
    v_mfma_f32_16x16x32_bf16 v[172:175], v[88:91], a[204:207], v[172:175]
    ds_read_b64_tr_b16 a[232:233], v2 offset:416
    v_mfma_f32_16x16x32_bf16 v[172:175], v[84:87], a[200:203], v[172:175]
    v_exp_f32 v23, v83
    v_mfma_f32_16x16x32_bf16 v[184:187], v[84:87], a[208:211], v[184:187]
    s_waitcnt lgkmcnt(5)
    ds_read_b64_tr_b16 a[234:235], v2 offset:928
    v_add_f32 v8, v8, v23
    v_mfma_f32_16x16x32_bf16 v[184:187], v[88:91], a[212:215], v[184:187]
    ds_read_b64_tr_b16 a[240:241], v2 offset:448
    v_cvt_pk_bf16_f32 v131, v22, v23
    v_mfma_f32_16x16x32_bf16 v[188:191], v[96:99], a[212:215], v[188:191]
    ds_read_b64_tr_b16 a[242:243], v2 offset:960
    v_mfma_f32_16x16x32_bf16 v[188:191], v[92:95], a[208:211], v[188:191]
    v_exp_f32 v16, v76
    v_mfma_f32_16x16x32_bf16 v[192:195], v[100:103], a[208:211], v[192:195]
    ds_read_b64_tr_b16 a[244:245], v2 offset:17344
    v_add_f32 v7, v7, v16
    v_mfma_f32_16x16x32_bf16 v[192:195], v[104:107], a[212:215], v[192:195]
    ds_read_b64_tr_b16 a[246:247], v2 offset:17856
    v_mfma_f32_16x16x32_bf16 v[204:207], v[104:107], a[220:223], v[204:207]
    v_exp_f32 v17, v77
    v_mfma_f32_16x16x32_bf16 v[204:207], v[100:103], a[216:219], v[204:207]
    ds_read_b64_tr_b16 a[252:253], v2 offset:17376
    v_add_f32 v7, v7, v17
    v_mfma_f32_16x16x32_bf16 v[200:203], v[92:95], a[216:219], v[200:203]
    ds_read_b64_tr_b16 a[254:255], v2 offset:17888
    v_cvt_pk_bf16_f32 v122, v16, v17
    v_mfma_f32_16x16x32_bf16 v[200:203], v[96:99], a[220:223], v[200:203]
    s_sub_u32 s76, s76, 1024
    s_cselect_b32 s76, 0x18000, s76
    ds_read_b64_tr_b16 a[248:249], v2 offset:480
    v_mfma_f32_16x16x32_bf16 v[196:199], v[88:91], a[220:223], v[196:199]
    v_exp_f32 v18, v78
    v_mfma_f32_16x16x32_bf16 v[196:199], v[84:87], a[216:219], v[196:199]
    ds_read_b64_tr_b16 a[250:251], v2 offset:992
    v_add_f32 v7, v7, v18
    v_mfma_f32_16x16x32_bf16 v[208:211], v[84:87], a[224:227], v[208:211]
    s_waitcnt lgkmcnt(5)
    v_mfma_f32_16x16x32_bf16 v[208:211], v[88:91], a[228:231], v[208:211]
    v_mfma_f32_16x16x32_bf16 v[212:215], v[96:99], a[228:231], v[212:215]
    v_exp_f32 v19, v79
    v_mfma_f32_16x16x32_bf16 v[212:215], v[92:95], a[224:227], v[212:215]
    v_add_f32 v7, v7, v19
    v_cvt_pk_bf16_f32 v123, v18, v19
    v_mfma_f32_16x16x32_bf16 v[216:219], v[100:103], a[224:227], v[216:219]
    v_mfma_f32_16x16x32_bf16 v[216:219], v[104:107], a[228:231], v[216:219]
    v_exp_f32 v20, v72
    v_mfma_f32_16x16x32_bf16 v[228:231], v[104:107], a[236:239], v[228:231]
    v_add_f32 v6, v6, v20
    v_mfma_f32_16x16x32_bf16 v[228:231], v[100:103], a[232:235], v[228:231]
    v_mfma_f32_16x16x32_bf16 v[224:227], v[92:95], a[232:235], v[224:227]
    v_mfma_f32_16x16x32_bf16 v[224:227], v[96:99], a[236:239], v[224:227]
    s_waitcnt vmcnt(17) lgkmcnt(0)
    s_barrier
    v_mfma_f32_16x16x32_bf16 v[220:223], v[88:91], a[236:239], v[220:223]
    v_exp_f32 v21, v73
    v_mfma_f32_16x16x32_bf16 v[220:223], v[84:87], a[232:235], v[220:223]
    ds_read_b128 a[192:195], v1 offset:0
    v_add_f32 v6, v6, v21
    v_mfma_f32_16x16x32_bf16 v[232:235], v[84:87], a[240:243], v[232:235]
    ds_read_b128 a[196:199], v1 offset:64
    v_cvt_pk_bf16_f32 v114, v20, v21
    v_mfma_f32_16x16x32_bf16 v[232:235], v[88:91], a[244:247], v[232:235]
    v_exp_f32 v22, v74
    v_mfma_f32_16x16x32_bf16 v[236:239], v[96:99], a[244:247], v[236:239]
    ds_read_b128 a[200:203], v1 offset:128
    v_add_f32 v6, v6, v22
    v_mfma_f32_16x16x32_bf16 v[236:239], v[92:95], a[240:243], v[236:239]
    ds_read_b128 a[204:207], v1 offset:192
    v_mfma_f32_16x16x32_bf16 v[240:243], v[100:103], a[240:243], v[240:243]
    v_exp_f32 v23, v75
    v_mfma_f32_16x16x32_bf16 v[240:243], v[104:107], a[244:247], v[240:243]
    ds_read_b128 a[208:211], v1 offset:256
    v_add_f32 v6, v6, v23
    v_mfma_f32_16x16x32_bf16 v[252:255], v[104:107], a[252:255], v[252:255]
    ds_read_b128 a[212:215], v1 offset:320
    v_cvt_pk_bf16_f32 v115, v22, v23
    v_mfma_f32_16x16x32_bf16 v[252:255], v[100:103], a[248:251], v[252:255]
    ds_read_b128 a[216:219], v1 offset:384
    v_max3_f32 v5, v6, v7, v8
    v_mfma_f32_16x16x32_bf16 v[248:251], v[92:95], a[248:251], v[248:251]
    ds_read_b128 a[220:223], v1 offset:448
    v_cmp_nge_f32 vcc, s26, v5
    v_mfma_f32_16x16x32_bf16 v[248:251], v[96:99], a[252:255], v[248:251]
    v_mfma_f32_16x16x32_bf16 v[244:247], v[88:91], a[252:255], v[244:247]
    v_mfma_f32_16x16x32_bf16 v[244:247], v[84:87], a[248:251], v[244:247]
    s_cbranch_vccnz L_rare0_0
L_j0_0:
    s_waitcnt lgkmcnt(4)
    v_mfma_f32_16x16x32_bf16 v[36:39], a[192:195], a[0:3], v[24:27]
    s_add_u32 m0, s24, 0
    ds_read_b128 a[252:255], v1 offset:960
    v_add_f32 v9, v9, v6
    v_mfma_f32_16x16x32_bf16 v[36:39], a[196:199], a[4:7], v[36:39]
    buffer_load_dwordx4 v3, s[8:11], s22 offen offset:0 nt lds
    v_mfma_f32_16x16x32_bf16 v[36:39], a[200:203], a[8:11], v[36:39]
    ds_read_b128 a[248:251], v1 offset:896
    v_add_f32 v10, v10, v7
    v_mfma_f32_16x16x32_bf16 v[36:39], a[204:207], a[12:15], v[36:39]
    s_waitcnt lgkmcnt(3)
    ds_read_b128 a[244:247], v1 offset:832
    v_add_f32 v11, v11, v8
    v_mfma_f32_16x16x32_bf16 v[36:39], a[208:211], a[16:19], v[36:39]
    ds_read_b128 a[240:243], v1 offset:768
    v_mfma_f32_16x16x32_bf16 v[36:39], a[212:215], a[20:23], v[36:39]
    ds_read_b128 a[236:239], v1 offset:704
    v_mfma_f32_16x16x32_bf16 v[36:39], a[216:219], a[24:27], v[36:39]
    s_waitcnt lgkmcnt(5)
    ds_read_b128 a[232:235], v1 offset:640
    v_mfma_f32_16x16x32_bf16 v[36:39], a[220:223], a[28:31], v[36:39]
    s_add_u32 m0, s24, 32
    ds_read_b128 a[228:231], v1 offset:576
    v_mfma_f32_16x16x32_bf16 v[40:43], a[220:223], a[60:63], v[28:31]
    buffer_load_dwordx4 v3, s[8:11], s22 offen offset:1024 nt lds
    v_mfma_f32_16x16x32_bf16 v[40:43], a[216:219], a[56:59], v[40:43]
    ds_read_b128 a[224:227], v1 offset:512
    v_mfma_f32_16x16x32_bf16 v[40:43], a[212:215], a[52:55], v[40:43]
    v_mfma_f32_16x16x32_bf16 v[40:43], a[208:211], a[48:51], v[40:43]
    v_mfma_f32_16x16x32_bf16 v[40:43], a[204:207], a[44:47], v[40:43]
    v_mfma_f32_16x16x32_bf16 v[40:43], a[200:203], a[40:43], v[40:43]
    v_exp_f32 v16, v36
    v_mfma_f32_16x16x32_bf16 v[40:43], a[196:199], a[36:39], v[40:43]
    s_add_u32 m0, s24, 64
    v_mfma_f32_16x16x32_bf16 v[40:43], a[192:195], a[32:35], v[40:43]
    buffer_load_dwordx4 v3, s[8:11], s22 offen offset:2048 nt lds
    v_mfma_f32_16x16x32_bf16 v[44:47], a[192:195], a[64:67], v[32:35]
    ds_read_b128 a[192:195], v1 offset:16896
    v_mfma_f32_16x16x32_bf16 v[44:47], a[196:199], a[68:71], v[44:47]
    v_exp_f32 v17, v37
    v_mfma_f32_16x16x32_bf16 v[44:47], a[200:203], a[72:75], v[44:47]
    ds_read_b128 a[196:199], v1 offset:16960
    v_add_f32 v6, v16, v17
    v_mfma_f32_16x16x32_bf16 v[44:47], a[204:207], a[76:79], v[44:47]
    ds_read_b128 a[200:203], v1 offset:17024
    v_cvt_pk_bf16_f32 v84, v16, v17
    v_mfma_f32_16x16x32_bf16 v[44:47], a[208:211], a[80:83], v[44:47]
    ds_read_b128 a[204:207], v1 offset:17088
    v_mfma_f32_16x16x32_bf16 v[44:47], a[212:215], a[84:87], v[44:47]
    s_add_u32 m0, s24, 96
    v_exp_f32 v18, v38
    v_mfma_f32_16x16x32_bf16 v[44:47], a[216:219], a[88:91], v[44:47]
    buffer_load_dwordx4 v3, s[8:11], s22 offen offset:3072 nt lds
    v_mfma_f32_16x16x32_bf16 v[44:47], a[220:223], a[92:95], v[44:47]
    s_waitcnt lgkmcnt(4)
    ds_read_b128 a[208:211], v1 offset:17152
    v_add_f32 v6, v6, v18
    v_mfma_f32_16x16x32_bf16 v[56:59], a[252:255], a[92:95], v[32:35]
    v_exp_f32 v19, v39
    v_mfma_f32_16x16x32_bf16 v[56:59], a[248:251], a[88:91], v[56:59]
    ds_read_b128 a[212:215], v1 offset:17216
    v_add_f32 v6, v6, v19
    v_mfma_f32_16x16x32_bf16 v[56:59], a[244:247], a[84:87], v[56:59]
    ds_read_b128 a[216:219], v1 offset:17280
    v_cvt_pk_bf16_f32 v85, v18, v19
    v_mfma_f32_16x16x32_bf16 v[56:59], a[240:243], a[80:83], v[56:59]
    ds_read_b128 a[220:223], v1 offset:17344
    v_mfma_f32_16x16x32_bf16 v[56:59], a[236:239], a[76:79], v[56:59]
    s_add_u32 m0, s24, 4224
    v_exp_f32 v20, v40
    v_mfma_f32_16x16x32_bf16 v[56:59], a[232:235], a[72:75], v[56:59]
    buffer_load_dwordx4 v4, s[8:11], s22 offen offset:0 nt lds
    v_mfma_f32_16x16x32_bf16 v[56:59], a[228:231], a[68:71], v[56:59]
    v_mfma_f32_16x16x32_bf16 v[56:59], a[224:227], a[64:67], v[56:59]
    v_exp_f32 v21, v41
    v_mfma_f32_16x16x32_bf16 v[52:55], a[224:227], a[32:35], v[28:31]
    v_add_f32 v7, v20, v21
    v_cvt_pk_bf16_f32 v92, v20, v21
    v_mfma_f32_16x16x32_bf16 v[52:55], a[228:231], a[36:39], v[52:55]
    v_mfma_f32_16x16x32_bf16 v[52:55], a[232:235], a[40:43], v[52:55]
    v_mfma_f32_16x16x32_bf16 v[52:55], a[236:239], a[44:47], v[52:55]
    s_add_u32 m0, s24, 4256
    v_exp_f32 v22, v42
    v_mfma_f32_16x16x32_bf16 v[52:55], a[240:243], a[48:51], v[52:55]
    buffer_load_dwordx4 v4, s[8:11], s22 offen offset:1024 nt lds
    v_mfma_f32_16x16x32_bf16 v[52:55], a[244:247], a[52:55], v[52:55]
    v_add_f32 v7, v7, v22
    v_mfma_f32_16x16x32_bf16 v[52:55], a[248:251], a[56:59], v[52:55]
    v_mfma_f32_16x16x32_bf16 v[52:55], a[252:255], a[60:63], v[52:55]
    v_exp_f32 v23, v43
    v_mfma_f32_16x16x32_bf16 v[48:51], a[252:255], a[28:31], v[24:27]
    ds_read_b128 a[252:255], v1 offset:17856
    v_add_f32 v7, v7, v23
    v_mfma_f32_16x16x32_bf16 v[48:51], a[248:251], a[24:27], v[48:51]
    ds_read_b128 a[248:251], v1 offset:17792
    v_cvt_pk_bf16_f32 v93, v22, v23
    v_mfma_f32_16x16x32_bf16 v[48:51], a[244:247], a[20:23], v[48:51]
    s_add_u32 m0, s24, 4288
    v_exp_f32 v16, v44
    v_mfma_f32_16x16x32_bf16 v[48:51], a[240:243], a[16:19], v[48:51]
    buffer_load_dwordx4 v4, s[8:11], s22 offen offset:2048 nt lds
    v_mfma_f32_16x16x32_bf16 v[48:51], a[236:239], a[12:15], v[48:51]
    ds_read_b128 a[244:247], v1 offset:17728
    v_mfma_f32_16x16x32_bf16 v[48:51], a[232:235], a[8:11], v[48:51]
    ds_read_b128 a[240:243], v1 offset:17664
    v_mfma_f32_16x16x32_bf16 v[48:51], a[228:231], a[4:7], v[48:51]
    v_exp_f32 v17, v45
    v_mfma_f32_16x16x32_bf16 v[48:51], a[224:227], a[0:3], v[48:51]
    s_waitcnt lgkmcnt(4)
    ds_read_b128 a[236:239], v1 offset:17600
    v_add_f32 v8, v16, v17
    v_mfma_f32_16x16x32_bf16 v[60:63], a[192:195], a[0:3], v[24:27]
    ds_read_b128 a[232:235], v1 offset:17536
    v_cvt_pk_bf16_f32 v100, v16, v17
    v_mfma_f32_16x16x32_bf16 v[60:63], a[196:199], a[4:7], v[60:63]
    s_add_u32 m0, s24, 4320
    v_exp_f32 v18, v46
    v_mfma_f32_16x16x32_bf16 v[60:63], a[200:203], a[8:11], v[60:63]
    buffer_load_dwordx4 v4, s[8:11], s22 offen offset:3072 nt lds
    v_mfma_f32_16x16x32_bf16 v[60:63], a[204:207], a[12:15], v[60:63]
    ds_read_b128 a[228:231], v1 offset:17472
    v_add_f32 v8, v8, v18
    v_mfma_f32_16x16x32_bf16 v[60:63], a[208:211], a[16:19], v[60:63]
    ds_read_b128 a[224:227], v1 offset:17408
    v_mfma_f32_16x16x32_bf16 v[60:63], a[212:215], a[20:23], v[60:63]
    v_exp_f32 v19, v47
    v_mfma_f32_16x16x32_bf16 v[60:63], a[216:219], a[24:27], v[60:63]
    v_add_f32 v8, v8, v19
    v_cvt_pk_bf16_f32 v101, v18, v19
    v_mfma_f32_16x16x32_bf16 v[60:63], a[220:223], a[28:31], v[60:63]
    v_mfma_f32_16x16x32_bf16 v[64:67], a[220:223], a[60:63], v[28:31]
    v_mfma_f32_16x16x32_bf16 v[64:67], a[216:219], a[56:59], v[64:67]
    v_exp_f32 v20, v56
    v_mfma_f32_16x16x32_bf16 v[64:67], a[212:215], a[52:55], v[64:67]
    v_add_f32 v8, v8, v20
    v_mfma_f32_16x16x32_bf16 v[64:67], a[208:211], a[48:51], v[64:67]
    s_waitcnt vmcnt(17) lgkmcnt(0)
    s_barrier
    v_mfma_f32_16x16x32_bf16 v[64:67], a[204:207], a[44:47], v[64:67]
    s_add_u32 s22, s22, 32768
    v_exp_f32 v21, v57
    v_mfma_f32_16x16x32_bf16 v[64:67], a[200:203], a[40:43], v[64:67]
    v_add_f32 v8, v8, v21
    v_cvt_pk_bf16_f32 v102, v20, v21
    v_mfma_f32_16x16x32_bf16 v[64:67], a[196:199], a[36:39], v[64:67]
    buffer_load_dword a168, v15, s[72:75], s76 offen
    v_mfma_f32_16x16x32_bf16 v[64:67], a[192:195], a[32:35], v[64:67]
    v_mfma_f32_16x16x32_bf16 v[68:71], a[192:195], a[64:67], v[32:35]
    v_exp_f32 v22, v58
    v_mfma_f32_16x16x32_bf16 v[68:71], a[196:199], a[68:71], v[68:71]
    ds_read_b64_tr_b16 a[192:193], v2 offset:33792
    v_add_f32 v8, v8, v22
    v_mfma_f32_16x16x32_bf16 v[68:71], a[200:203], a[72:75], v[68:71]
    ds_read_b64_tr_b16 a[194:195], v2 offset:34304
    v_mfma_f32_16x16x32_bf16 v[68:71], a[204:207], a[76:79], v[68:71]
    s_add_u32 m0, s23, 0
    v_exp_f32 v23, v59
    v_mfma_f32_16x16x32_bf16 v[68:71], a[208:211], a[80:83], v[68:71]
    buffer_load_dwordx4 v3, s[4:7], s21 offen offset:0 nt lds
    v_mfma_f32_16x16x32_bf16 v[68:71], a[212:215], a[84:87], v[68:71]
    ds_read_b64_tr_b16 a[196:197], v2 offset:50688
    v_add_f32 v8, v8, v23
    v_mfma_f32_16x16x32_bf16 v[68:71], a[216:219], a[88:91], v[68:71]
    ds_read_b64_tr_b16 a[198:199], v2 offset:51200
    v_cvt_pk_bf16_f32 v103, v22, v23
    v_mfma_f32_16x16x32_bf16 v[68:71], a[220:223], a[92:95], v[68:71]
    v_exp_f32 v16, v52
    v_mfma_f32_16x16x32_bf16 v[80:83], a[252:255], a[92:95], v[32:35]
    ds_read_b64_tr_b16 a[204:205], v2 offset:50720
    v_add_f32 v7, v7, v16
    v_mfma_f32_16x16x32_bf16 v[80:83], a[248:251], a[88:91], v[80:83]
    ds_read_b64_tr_b16 a[206:207], v2 offset:51232
    v_mfma_f32_16x16x32_bf16 v[80:83], a[244:247], a[84:87], v[80:83]
    ds_read_b64_tr_b16 a[200:201], v2 offset:33824
    v_mfma_f32_16x16x32_bf16 v[80:83], a[240:243], a[80:83], v[80:83]
    v_exp_f32 v17, v53
    v_mfma_f32_16x16x32_bf16 v[80:83], a[236:239], a[76:79], v[80:83]
    ds_read_b64_tr_b16 a[202:203], v2 offset:34336
    v_add_f32 v7, v7, v17
    v_mfma_f32_16x16x32_bf16 v[80:83], a[232:235], a[72:75], v[80:83]
    s_add_u32 m0, s23, 32
    ds_read_b64_tr_b16 a[208:209], v2 offset:33856
    v_cvt_pk_bf16_f32 v94, v16, v17
    v_mfma_f32_16x16x32_bf16 v[80:83], a[228:231], a[68:71], v[80:83]
    buffer_load_dwordx4 v3, s[4:7], s21 offen offset:1024 nt lds
    v_mfma_f32_16x16x32_bf16 v[80:83], a[224:227], a[64:67], v[80:83]
    v_exp_f32 v18, v54
    v_mfma_f32_16x16x32_bf16 v[76:79], a[224:227], a[32:35], v[28:31]
    ds_read_b64_tr_b16 a[210:211], v2 offset:34368
    v_add_f32 v7, v7, v18
    v_mfma_f32_16x16x32_bf16 v[76:79], a[228:231], a[36:39], v[76:79]
    ds_read_b64_tr_b16 a[212:213], v2 offset:50752
    v_mfma_f32_16x16x32_bf16 v[76:79], a[232:235], a[40:43], v[76:79]
    v_exp_f32 v19, v55
    v_mfma_f32_16x16x32_bf16 v[76:79], a[236:239], a[44:47], v[76:79]
    ds_read_b64_tr_b16 a[214:215], v2 offset:51264
    v_add_f32 v7, v7, v19
    v_mfma_f32_16x16x32_bf16 v[76:79], a[240:243], a[48:51], v[76:79]
    ds_read_b64_tr_b16 a[220:221], v2 offset:50784
    v_cvt_pk_bf16_f32 v95, v18, v19
    v_mfma_f32_16x16x32_bf16 v[76:79], a[244:247], a[52:55], v[76:79]
    v_exp_f32 v20, v48
    v_mfma_f32_16x16x32_bf16 v[76:79], a[248:251], a[56:59], v[76:79]
    ds_read_b64_tr_b16 a[222:223], v2 offset:51296
    v_add_f32 v6, v6, v20
    v_mfma_f32_16x16x32_bf16 v[76:79], a[252:255], a[60:63], v[76:79]
    s_add_u32 m0, s23, 64
    ds_read_b64_tr_b16 a[216:217], v2 offset:33888
    v_mfma_f32_16x16x32_bf16 v[72:75], a[252:255], a[28:31], v[24:27]
    buffer_load_dwordx4 v3, s[4:7], s21 offen offset:2048 nt lds
    v_mfma_f32_16x16x32_bf16 v[72:75], a[248:251], a[24:27], v[72:75]
    v_exp_f32 v21, v49
    v_mfma_f32_16x16x32_bf16 v[72:75], a[244:247], a[20:23], v[72:75]
    ds_read_b64_tr_b16 a[218:219], v2 offset:34400
    v_add_f32 v6, v6, v21
    v_mfma_f32_16x16x32_bf16 v[72:75], a[240:243], a[16:19], v[72:75]
    v_cvt_pk_bf16_f32 v86, v20, v21
    v_mfma_f32_16x16x32_bf16 v[72:75], a[236:239], a[12:15], v[72:75]
    v_mfma_f32_16x16x32_bf16 v[72:75], a[232:235], a[8:11], v[72:75]
    v_exp_f32 v22, v50
    v_mfma_f32_16x16x32_bf16 v[72:75], a[228:231], a[4:7], v[72:75]
    v_add_f32 v6, v6, v22
    v_mfma_f32_16x16x32_bf16 v[72:75], a[224:227], a[0:3], v[72:75]
    s_waitcnt lgkmcnt(1)
    ds_read_b64_tr_b16 a[224:225], v2 offset:33920
    v_mfma_f32_16x16x32_bf16 a[96:99], v[108:111], a[192:195], a[96:99]
    v_exp_f32 v23, v51
    v_mfma_f32_16x16x32_bf16 a[96:99], v[112:115], a[196:199], a[96:99]
    s_add_u32 m0, s23, 96
    ds_read_b64_tr_b16 a[226:227], v2 offset:34432
    v_add_f32 v6, v6, v23
    v_mfma_f32_16x16x32_bf16 a[100:103], v[120:123], a[196:199], a[100:103]
    buffer_load_dwordx4 v3, s[4:7], s21 offen offset:3072 nt lds
    v_mfma_f32_16x16x32_bf16 a[100:103], v[116:119], a[192:195], a[100:103]
    ds_read_b64_tr_b16 a[228:229], v2 offset:50816
    v_cvt_pk_bf16_f32 v87, v22, v23
    v_mfma_f32_16x16x32_bf16 a[104:107], v[124:127], a[192:195], a[104:107]
    v_exp_f32 v16, v60
    v_mfma_f32_16x16x32_bf16 a[104:107], v[128:131], a[196:199], a[104:107]
    ds_read_b64_tr_b16 a[230:231], v2 offset:51328
    v_add_f32 v6, v6, v16
    v_mfma_f32_16x16x32_bf16 a[116:119], v[128:131], a[204:207], a[116:119]
    ds_read_b64_tr_b16 a[236:237], v2 offset:50848
    v_mfma_f32_16x16x32_bf16 a[116:119], v[124:127], a[200:203], a[116:119]
    ds_read_b64_tr_b16 a[238:239], v2 offset:51360
    v_mfma_f32_16x16x32_bf16 a[112:115], v[116:119], a[200:203], a[112:115]
    v_exp_f32 v17, v61
    v_mfma_f32_16x16x32_bf16 a[112:115], v[120:123], a[204:207], a[112:115]
    ds_read_b64_tr_b16 a[232:233], v2 offset:33952
    v_add_f32 v6, v6, v17
    v_mfma_f32_16x16x32_bf16 a[108:111], v[112:115], a[204:207], a[108:111]
    ds_read_b64_tr_b16 a[234:235], v2 offset:34464
    v_cvt_pk_bf16_f32 v88, v16, v17
    v_mfma_f32_16x16x32_bf16 a[108:111], v[108:111], a[200:203], a[108:111]
    s_add_u32 m0, s23, 4224
    v_exp_f32 v18, v62
    v_mfma_f32_16x16x32_bf16 a[120:123], v[108:111], a[208:211], a[120:123]
    buffer_load_dwordx4 v4, s[4:7], s21 offen offset:0 nt lds
    v_mfma_f32_16x16x32_bf16 a[120:123], v[112:115], a[212:215], a[120:123]
    ds_read_b64_tr_b16 a[240:241], v2 offset:33984
    v_add_f32 v6, v6, v18
    v_mfma_f32_16x16x32_bf16 a[124:127], v[120:123], a[212:215], a[124:127]
    ds_read_b64_tr_b16 a[242:243], v2 offset:34496
    v_mfma_f32_16x16x32_bf16 a[124:127], v[116:119], a[208:211], a[124:127]
    v_exp_f32 v19, v63
    v_mfma_f32_16x16x32_bf16 a[128:131], v[124:127], a[208:211], a[128:131]
    ds_read_b64_tr_b16 a[244:245], v2 offset:50880
    v_add_f32 v6, v6, v19
    v_mfma_f32_16x16x32_bf16 a[128:131], v[128:131], a[212:215], a[128:131]
    ds_read_b64_tr_b16 a[246:247], v2 offset:51392
    v_cvt_pk_bf16_f32 v89, v18, v19
    v_mfma_f32_16x16x32_bf16 a[140:143], v[128:131], a[220:223], a[140:143]
    s_waitcnt lgkmcnt(4)
    ds_read_b64_tr_b16 a[252:253], v2 offset:50912
    v_mfma_f32_16x16x32_bf16 a[140:143], v[124:127], a[216:219], a[140:143]
    v_exp_f32 v20, v64
    v_mfma_f32_16x16x32_bf16 a[136:139], v[116:119], a[216:219], a[136:139]
    ds_read_b64_tr_b16 a[254:255], v2 offset:51424
    v_add_f32 v7, v7, v20
    v_mfma_f32_16x16x32_bf16 a[136:139], v[120:123], a[220:223], a[136:139]
    s_add_u32 m0, s23, 4256
    ds_read_b64_tr_b16 a[248:249], v2 offset:34016
    v_mfma_f32_16x16x32_bf16 a[132:135], v[112:115], a[220:223], a[132:135]
    buffer_load_dwordx4 v4, s[4:7], s21 offen offset:1024 nt lds
    v_mfma_f32_16x16x32_bf16 a[132:135], v[108:111], a[216:219], a[132:135]
    v_exp_f32 v21, v65
    v_mfma_f32_16x16x32_bf16 a[144:147], v[108:111], a[224:227], a[144:147]
    ds_read_b64_tr_b16 a[250:251], v2 offset:34528
    v_add_f32 v7, v7, v21
    v_mfma_f32_16x16x32_bf16 a[144:147], v[112:115], a[228:231], a[144:147]
    ds_read_b64_tr_b16 a[192:193], v2 offset:34048
    v_cvt_pk_bf16_f32 v96, v20, v21
    v_mfma_f32_16x16x32_bf16 a[148:151], v[120:123], a[228:231], a[148:151]
    v_exp_f32 v22, v66
    v_mfma_f32_16x16x32_bf16 a[148:151], v[116:119], a[224:227], a[148:151]
    ds_read_b64_tr_b16 a[194:195], v2 offset:34560
    v_add_f32 v7, v7, v22
    v_mfma_f32_16x16x32_bf16 a[152:155], v[124:127], a[224:227], a[152:155]
    ds_read_b64_tr_b16 a[196:197], v2 offset:50944
    v_mfma_f32_16x16x32_bf16 a[152:155], v[128:131], a[228:231], a[152:155]
    ds_read_b64_tr_b16 a[198:199], v2 offset:51456
    v_mfma_f32_16x16x32_bf16 v[132:135], v[128:131], a[236:239], v[132:135]
    v_exp_f32 v23, v67
    v_mfma_f32_16x16x32_bf16 v[132:135], v[124:127], a[232:235], v[132:135]
    s_add_u32 m0, s23, 4288
    ds_read_b64_tr_b16 a[204:205], v2 offset:50976
    v_add_f32 v7, v7, v23
    v_mfma_f32_16x16x32_bf16 a[160:163], v[116:119], a[232:235], a[160:163]
    buffer_load_dwordx4 v4, s[4:7], s21 offen offset:2048 nt lds
    v_mfma_f32_16x16x32_bf16 a[160:163], v[120:123], a[236:239], a[160:163]
    v_exp_f32 v16, v68
    v_mfma_f32_16x16x32_bf16 a[156:159], v[112:115], a[236:239], a[156:159]
    ds_read_b64_tr_b16 a[206:207], v2 offset:51488
    v_cvt_pk_bf16_f32 v97, v22, v23
    v_mfma_f32_16x16x32_bf16 a[156:159], v[108:111], a[232:235], a[156:159]
    s_waitcnt lgkmcnt(4)
    ds_read_b64_tr_b16 a[200:201], v2 offset:34080
    v_add_f32 v8, v8, v16
    v_mfma_f32_16x16x32_bf16 v[136:139], v[108:111], a[240:243], v[136:139]
    ds_read_b64_tr_b16 a[202:203], v2 offset:34592
    v_mfma_f32_16x16x32_bf16 v[136:139], v[112:115], a[244:247], v[136:139]
    v_exp_f32 v17, v69
    v_mfma_f32_16x16x32_bf16 v[140:143], v[120:123], a[244:247], v[140:143]
    ds_read_b64_tr_b16 a[208:209], v2 offset:34112
    v_add_f32 v8, v8, v17
    v_mfma_f32_16x16x32_bf16 v[140:143], v[116:119], a[240:243], v[140:143]
    ds_read_b64_tr_b16 a[210:211], v2 offset:34624
    v_cvt_pk_bf16_f32 v104, v16, v17
    v_mfma_f32_16x16x32_bf16 v[144:147], v[124:127], a[240:243], v[144:147]
    ds_read_b64_tr_b16 a[212:213], v2 offset:51008
    v_mfma_f32_16x16x32_bf16 v[144:147], v[128:131], a[244:247], v[144:147]
    s_add_u32 m0, s23, 4320
    v_exp_f32 v18, v70
    v_mfma_f32_16x16x32_bf16 v[156:159], v[128:131], a[252:255], v[156:159]
    buffer_load_dwordx4 v4, s[4:7], s21 offen offset:3072 nt lds
    v_mfma_f32_16x16x32_bf16 v[156:159], v[124:127], a[248:251], v[156:159]
    ds_read_b64_tr_b16 a[214:215], v2 offset:51520
    v_add_f32 v8, v8, v18
    v_mfma_f32_16x16x32_bf16 v[152:155], v[116:119], a[248:251], v[152:155]
    v_exp_f32 v19, v71
    v_mfma_f32_16x16x32_bf16 v[152:155], v[120:123], a[252:255], v[152:155]
    ds_read_b64_tr_b16 a[220:221], v2 offset:51040
    v_add_f32 v8, v8, v19
    v_mfma_f32_16x16x32_bf16 v[148:151], v[112:115], a[252:255], v[148:151]
    ds_read_b64_tr_b16 a[222:223], v2 offset:51552
    v_cvt_pk_bf16_f32 v105, v18, v19
    v_mfma_f32_16x16x32_bf16 v[148:151], v[108:111], a[248:251], v[148:151]
    ds_read_b64_tr_b16 a[216:217], v2 offset:34144
    v_mfma_f32_16x16x32_bf16 v[160:163], v[108:111], a[192:195], v[160:163]
    s_waitcnt lgkmcnt(4)
    v_exp_f32 v20, v80
    v_mfma_f32_16x16x32_bf16 v[160:163], v[112:115], a[196:199], v[160:163]
    ds_read_b64_tr_b16 a[218:219], v2 offset:34656
    v_add_f32 v8, v8, v20
    v_mfma_f32_16x16x32_bf16 v[164:167], v[120:123], a[196:199], v[164:167]
    ds_read_b64_tr_b16 a[224:225], v2 offset:34176
    v_mfma_f32_16x16x32_bf16 v[164:167], v[116:119], a[192:195], v[164:167]
    ds_read_b64_tr_b16 a[226:227], v2 offset:34688
    v_mfma_f32_16x16x32_bf16 v[168:171], v[124:127], a[192:195], v[168:171]
    s_add_u32 s21, s21, 32768
    v_exp_f32 v21, v81
    v_mfma_f32_16x16x32_bf16 v[168:171], v[128:131], a[196:199], v[168:171]
    ds_read_b64_tr_b16 a[228:229], v2 offset:51072
    v_add_f32 v8, v8, v21
    v_mfma_f32_16x16x32_bf16 v[180:183], v[128:131], a[204:207], v[180:183]
    ds_read_b64_tr_b16 a[230:231], v2 offset:51584
    v_cvt_pk_bf16_f32 v106, v20, v21
    v_mfma_f32_16x16x32_bf16 v[180:183], v[124:127], a[200:203], v[180:183]
    v_exp_f32 v22, v82
    v_mfma_f32_16x16x32_bf16 v[176:179], v[116:119], a[200:203], v[176:179]
    ds_read_b64_tr_b16 a[236:237], v2 offset:51104
    v_add_f32 v8, v8, v22
    v_mfma_f32_16x16x32_bf16 v[176:179], v[120:123], a[204:207], v[176:179]
    ds_read_b64_tr_b16 a[238:239], v2 offset:51616
    v_mfma_f32_16x16x32_bf16 v[172:175], v[112:115], a[204:207], v[172:175]
    ds_read_b64_tr_b16 a[232:233], v2 offset:34208
    v_mfma_f32_16x16x32_bf16 v[172:175], v[108:111], a[200:203], v[172:175]
    v_exp_f32 v23, v83
    v_mfma_f32_16x16x32_bf16 v[184:187], v[108:111], a[208:211], v[184:187]
    s_waitcnt lgkmcnt(5)
    ds_read_b64_tr_b16 a[234:235], v2 offset:34720
    v_add_f32 v8, v8, v23
    v_mfma_f32_16x16x32_bf16 v[184:187], v[112:115], a[212:215], v[184:187]
    ds_read_b64_tr_b16 a[240:241], v2 offset:34240
    v_cvt_pk_bf16_f32 v107, v22, v23
    v_mfma_f32_16x16x32_bf16 v[188:191], v[120:123], a[212:215], v[188:191]
    ds_read_b64_tr_b16 a[242:243], v2 offset:34752
    v_mfma_f32_16x16x32_bf16 v[188:191], v[116:119], a[208:211], v[188:191]
    v_exp_f32 v16, v76
    v_mfma_f32_16x16x32_bf16 v[192:195], v[124:127], a[208:211], v[192:195]
    s_sub_u32 s25, s25, 1
    ds_read_b64_tr_b16 a[244:245], v2 offset:51136
    v_add_f32 v7, v7, v16
    v_mfma_f32_16x16x32_bf16 v[192:195], v[128:131], a[212:215], v[192:195]
    ds_read_b64_tr_b16 a[246:247], v2 offset:51648
    v_mfma_f32_16x16x32_bf16 v[204:207], v[128:131], a[220:223], v[204:207]
    v_exp_f32 v17, v77
    v_mfma_f32_16x16x32_bf16 v[204:207], v[124:127], a[216:219], v[204:207]
    ds_read_b64_tr_b16 a[252:253], v2 offset:51168
    v_add_f32 v7, v7, v17
    v_mfma_f32_16x16x32_bf16 v[200:203], v[116:119], a[216:219], v[200:203]
    ds_read_b64_tr_b16 a[254:255], v2 offset:51680
    v_cvt_pk_bf16_f32 v98, v16, v17
    v_mfma_f32_16x16x32_bf16 v[200:203], v[120:123], a[220:223], v[200:203]
    s_sub_u32 s76, s76, 1024
    s_cselect_b32 s76, 0x18000, s76
    ds_read_b64_tr_b16 a[248:249], v2 offset:34272
    v_mfma_f32_16x16x32_bf16 v[196:199], v[112:115], a[220:223], v[196:199]
    v_exp_f32 v18, v78
    v_mfma_f32_16x16x32_bf16 v[196:199], v[108:111], a[216:219], v[196:199]
    ds_read_b64_tr_b16 a[250:251], v2 offset:34784
    v_add_f32 v7, v7, v18
    v_mfma_f32_16x16x32_bf16 v[208:211], v[108:111], a[224:227], v[208:211]
    s_waitcnt lgkmcnt(5)
    v_mfma_f32_16x16x32_bf16 v[208:211], v[112:115], a[228:231], v[208:211]
    v_mfma_f32_16x16x32_bf16 v[212:215], v[120:123], a[228:231], v[212:215]
    v_exp_f32 v19, v79
    v_mfma_f32_16x16x32_bf16 v[212:215], v[116:119], a[224:227], v[212:215]
    v_add_f32 v7, v7, v19
    v_cvt_pk_bf16_f32 v99, v18, v19
    v_mfma_f32_16x16x32_bf16 v[216:219], v[124:127], a[224:227], v[216:219]
    v_mfma_f32_16x16x32_bf16 v[216:219], v[128:131], a[228:231], v[216:219]
    v_exp_f32 v20, v72
    v_mfma_f32_16x16x32_bf16 v[228:231], v[128:131], a[236:239], v[228:231]
    v_add_f32 v6, v6, v20
    v_mfma_f32_16x16x32_bf16 v[228:231], v[124:127], a[232:235], v[228:231]
    v_mfma_f32_16x16x32_bf16 v[224:227], v[116:119], a[232:235], v[224:227]
    v_mfma_f32_16x16x32_bf16 v[224:227], v[120:123], a[236:239], v[224:227]
    s_waitcnt vmcnt(17) lgkmcnt(0)
    s_barrier
    v_mfma_f32_16x16x32_bf16 v[220:223], v[112:115], a[236:239], v[220:223]
    v_exp_f32 v21, v73
    v_mfma_f32_16x16x32_bf16 v[220:223], v[108:111], a[232:235], v[220:223]
    ds_read_b128 a[192:195], v1 offset:33792
    v_add_f32 v6, v6, v21
    v_mfma_f32_16x16x32_bf16 v[232:235], v[108:111], a[240:243], v[232:235]
    ds_read_b128 a[196:199], v1 offset:33856
    v_cvt_pk_bf16_f32 v90, v20, v21
    v_mfma_f32_16x16x32_bf16 v[232:235], v[112:115], a[244:247], v[232:235]
    v_exp_f32 v22, v74
    v_mfma_f32_16x16x32_bf16 v[236:239], v[120:123], a[244:247], v[236:239]
    ds_read_b128 a[200:203], v1 offset:33920
    v_add_f32 v6, v6, v22
    v_mfma_f32_16x16x32_bf16 v[236:239], v[116:119], a[240:243], v[236:239]
    ds_read_b128 a[204:207], v1 offset:33984
    v_mfma_f32_16x16x32_bf16 v[240:243], v[124:127], a[240:243], v[240:243]
    v_exp_f32 v23, v75
    v_mfma_f32_16x16x32_bf16 v[240:243], v[128:131], a[244:247], v[240:243]
    ds_read_b128 a[208:211], v1 offset:34048
    v_add_f32 v6, v6, v23
    v_mfma_f32_16x16x32_bf16 v[252:255], v[128:131], a[252:255], v[252:255]
    ds_read_b128 a[212:215], v1 offset:34112
    v_cvt_pk_bf16_f32 v91, v22, v23
    v_mfma_f32_16x16x32_bf16 v[252:255], v[124:127], a[248:251], v[252:255]
    ds_read_b128 a[216:219], v1 offset:34176
    v_max3_f32 v5, v6, v7, v8
    v_mfma_f32_16x16x32_bf16 v[248:251], v[116:119], a[248:251], v[248:251]
    ds_read_b128 a[220:223], v1 offset:34240
    v_cmp_nge_f32 vcc, s26, v5
    v_mfma_f32_16x16x32_bf16 v[248:251], v[120:123], a[252:255], v[248:251]
    v_mfma_f32_16x16x32_bf16 v[244:247], v[112:115], a[252:255], v[244:247]
    s_cmp_eq_u32 s25, 0
    v_mfma_f32_16x16x32_bf16 v[244:247], v[108:111], a[248:251], v[244:247]
    s_cbranch_vccnz L_rare1_0
L_j1_0:
    s_cbranch_scc0 L_loop0
    s_branch L_tail
.p2align 6
L_loop1:
    s_waitcnt lgkmcnt(4)
    v_mfma_f32_16x16x32_bf16 v[36:39], a[192:195], a[0:3], v[24:27]
    ds_read_b128 a[252:255], v1 offset:34752
    v_add_f32 v9, v9, v6
    v_mfma_f32_16x16x32_bf16 v[36:39], a[196:199], a[4:7], v[36:39]
    ds_read_b128 a[248:251], v1 offset:34688
    v_add_f32 v10, v10, v7
    v_mfma_f32_16x16x32_bf16 v[36:39], a[200:203], a[8:11], v[36:39]
    s_add_u32 m0, s24, 33792
    ds_read_b128 a[244:247], v1 offset:34624
    v_add_f32 v11, v11, v8
    v_mfma_f32_16x16x32_bf16 v[36:39], a[204:207], a[12:15], v[36:39]
    s_waitcnt lgkmcnt(4)
    buffer_load_dwordx4 v3, s[8:11], s22 offen offset:0 nt lds
    v_mfma_f32_16x16x32_bf16 v[36:39], a[208:211], a[16:19], v[36:39]
    ds_read_b128 a[240:243], v1 offset:34560
    v_mfma_f32_16x16x32_bf16 v[36:39], a[212:215], a[20:23], v[36:39]
    ds_read_b128 a[236:239], v1 offset:34496
    v_mfma_f32_16x16x32_bf16 v[36:39], a[216:219], a[24:27], v[36:39]
    s_waitcnt lgkmcnt(5)
    ds_read_b128 a[232:235], v1 offset:34432
    v_mfma_f32_16x16x32_bf16 v[36:39], a[220:223], a[28:31], v[36:39]
    ds_read_b128 a[228:231], v1 offset:34368
    v_mfma_f32_16x16x32_bf16 v[40:43], a[220:223], a[60:63], v[28:31]
    ds_read_b128 a[224:227], v1 offset:34304
    v_mfma_f32_16x16x32_bf16 v[40:43], a[216:219], a[56:59], v[40:43]
    s_add_u32 m0, s24, 33824
    v_mfma_f32_16x16x32_bf16 v[40:43], a[212:215], a[52:55], v[40:43]
    buffer_load_dwordx4 v3, s[8:11], s22 offen offset:1024 nt lds
    v_mfma_f32_16x16x32_bf16 v[40:43], a[208:211], a[48:51], v[40:43]
    v_mfma_f32_16x16x32_bf16 v[40:43], a[204:207], a[44:47], v[40:43]
    v_mfma_f32_16x16x32_bf16 v[40:43], a[200:203], a[40:43], v[40:43]
    v_exp_f32 v16, v36
    v_mfma_f32_16x16x32_bf16 v[40:43], a[196:199], a[36:39], v[40:43]
    v_mfma_f32_16x16x32_bf16 v[40:43], a[192:195], a[32:35], v[40:43]
    v_mfma_f32_16x16x32_bf16 v[44:47], a[192:195], a[64:67], v[32:35]
    s_add_u32 m0, s24, 33856
    ds_read_b128 a[192:195], v1 offset:50688
    v_mfma_f32_16x16x32_bf16 v[44:47], a[196:199], a[68:71], v[44:47]
    buffer_load_dwordx4 v3, s[8:11], s22 offen offset:2048 nt lds
    v_mfma_f32_16x16x32_bf16 v[44:47], a[200:203], a[72:75], v[44:47]
    v_exp_f32 v17, v37
    v_mfma_f32_16x16x32_bf16 v[44:47], a[204:207], a[76:79], v[44:47]
    ds_read_b128 a[196:199], v1 offset:50752
    v_add_f32 v6, v16, v17
    v_mfma_f32_16x16x32_bf16 v[44:47], a[208:211], a[80:83], v[44:47]
    ds_read_b128 a[200:203], v1 offset:50816
    v_cvt_pk_bf16_f32 v108, v16, v17
    v_mfma_f32_16x16x32_bf16 v[44:47], a[212:215], a[84:87], v[44:47]
    v_exp_f32 v18, v38
    v_mfma_f32_16x16x32_bf16 v[44:47], a[216:219], a[88:91], v[44:47]
    s_add_u32 m0, s24, 33888
    ds_read_b128 a[204:207], v1 offset:50880
    v_add_f32 v6, v6, v18
    v_mfma_f32_16x16x32_bf16 v[44:47], a[220:223], a[92:95], v[44:47]
    s_waitcnt lgkmcnt(4)
    ds_read_b128 a[208:211], v1 offset:50944
    v_mfma_f32_16x16x32_bf16 v[56:59], a[252:255], a[92:95], v[32:35]
    buffer_load_dwordx4 v3, s[8:11], s22 offen offset:3072 nt lds
    v_mfma_f32_16x16x32_bf16 v[56:59], a[248:251], a[88:91], v[56:59]
    v_exp_f32 v19, v39
    v_mfma_f32_16x16x32_bf16 v[56:59], a[244:247], a[84:87], v[56:59]
    ds_read_b128 a[212:215], v1 offset:51008
    v_add_f32 v6, v6, v19
    v_mfma_f32_16x16x32_bf16 v[56:59], a[240:243], a[80:83], v[56:59]
    ds_read_b128 a[216:219], v1 offset:51072
    v_cvt_pk_bf16_f32 v109, v18, v19
    v_mfma_f32_16x16x32_bf16 v[56:59], a[236:239], a[76:79], v[56:59]
    v_exp_f32 v20, v40
    v_mfma_f32_16x16x32_bf16 v[56:59], a[232:235], a[72:75], v[56:59]
    ds_read_b128 a[220:223], v1 offset:51136
    v_mfma_f32_16x16x32_bf16 v[56:59], a[228:231], a[68:71], v[56:59]
    s_add_u32 m0, s24, 38016
    v_mfma_f32_16x16x32_bf16 v[56:59], a[224:227], a[64:67], v[56:59]
    buffer_load_dwordx4 v4, s[8:11], s22 offen offset:0 nt lds
    v_mfma_f32_16x16x32_bf16 v[52:55], a[224:227], a[32:35], v[28:31]
    v_exp_f32 v21, v41
    v_mfma_f32_16x16x32_bf16 v[52:55], a[228:231], a[36:39], v[52:55]
    v_add_f32 v7, v20, v21
    v_cvt_pk_bf16_f32 v116, v20, v21
    v_mfma_f32_16x16x32_bf16 v[52:55], a[232:235], a[40:43], v[52:55]
    v_mfma_f32_16x16x32_bf16 v[52:55], a[236:239], a[44:47], v[52:55]
    v_exp_f32 v22, v42
    v_mfma_f32_16x16x32_bf16 v[52:55], a[240:243], a[48:51], v[52:55]
    v_add_f32 v7, v7, v22
    v_mfma_f32_16x16x32_bf16 v[52:55], a[244:247], a[52:55], v[52:55]
    s_add_u32 m0, s24, 38048
    v_mfma_f32_16x16x32_bf16 v[52:55], a[248:251], a[56:59], v[52:55]
    buffer_load_dwordx4 v4, s[8:11], s22 offen offset:1024 nt lds
    v_mfma_f32_16x16x32_bf16 v[52:55], a[252:255], a[60:63], v[52:55]
    v_exp_f32 v23, v43
    v_mfma_f32_16x16x32_bf16 v[48:51], a[252:255], a[28:31], v[24:27]
    ds_read_b128 a[252:255], v1 offset:51648
    v_add_f32 v7, v7, v23
    v_mfma_f32_16x16x32_bf16 v[48:51], a[248:251], a[24:27], v[48:51]
    ds_read_b128 a[248:251], v1 offset:51584
    v_cvt_pk_bf16_f32 v117, v22, v23
    v_mfma_f32_16x16x32_bf16 v[48:51], a[244:247], a[20:23], v[48:51]
    v_exp_f32 v16, v44
    v_mfma_f32_16x16x32_bf16 v[48:51], a[240:243], a[16:19], v[48:51]
    ds_read_b128 a[244:247], v1 offset:51520
    v_mfma_f32_16x16x32_bf16 v[48:51], a[236:239], a[12:15], v[48:51]
    s_add_u32 m0, s24, 38080
    ds_read_b128 a[240:243], v1 offset:51456
    v_mfma_f32_16x16x32_bf16 v[48:51], a[232:235], a[8:11], v[48:51]
    buffer_load_dwordx4 v4, s[8:11], s22 offen offset:2048 nt lds
    v_mfma_f32_16x16x32_bf16 v[48:51], a[228:231], a[4:7], v[48:51]
    v_exp_f32 v17, v45
    v_mfma_f32_16x16x32_bf16 v[48:51], a[224:227], a[0:3], v[48:51]
    s_waitcnt lgkmcnt(4)
    ds_read_b128 a[236:239], v1 offset:51392
    v_add_f32 v8, v16, v17
    v_mfma_f32_16x16x32_bf16 v[60:63], a[192:195], a[0:3], v[24:27]
    ds_read_b128 a[232:235], v1 offset:51328
    v_cvt_pk_bf16_f32 v124, v16, v17
    v_mfma_f32_16x16x32_bf16 v[60:63], a[196:199], a[4:7], v[60:63]
    v_exp_f32 v18, v46
    v_mfma_f32_16x16x32_bf16 v[60:63], a[200:203], a[8:11], v[60:63]
    ds_read_b128 a[228:231], v1 offset:51264
    v_add_f32 v8, v8, v18
    v_mfma_f32_16x16x32_bf16 v[60:63], a[204:207], a[12:15], v[60:63]
    s_add_u32 m0, s24, 38112
    ds_read_b128 a[224:227], v1 offset:51200
    v_mfma_f32_16x16x32_bf16 v[60:63], a[208:211], a[16:19], v[60:63]
    buffer_load_dwordx4 v4, s[8:11], s22 offen offset:3072 nt lds
    v_mfma_f32_16x16x32_bf16 v[60:63], a[212:215], a[20:23], v[60:63]
    v_exp_f32 v19, v47
    v_mfma_f32_16x16x32_bf16 v[60:63], a[216:219], a[24:27], v[60:63]
    v_add_f32 v8, v8, v19
    v_cvt_pk_bf16_f32 v125, v18, v19
    v_mfma_f32_16x16x32_bf16 v[60:63], a[220:223], a[28:31], v[60:63]
    v_mfma_f32_16x16x32_bf16 v[64:67], a[220:223], a[60:63], v[28:31]
    v_mfma_f32_16x16x32_bf16 v[64:67], a[216:219], a[56:59], v[64:67]
    v_exp_f32 v20, v56
    v_mfma_f32_16x16x32_bf16 v[64:67], a[212:215], a[52:55], v[64:67]
    v_add_f32 v8, v8, v20
    v_mfma_f32_16x16x32_bf16 v[64:67], a[208:211], a[48:51], v[64:67]
    s_waitcnt vmcnt(17) lgkmcnt(0)
    s_barrier
    v_mfma_f32_16x16x32_bf16 v[64:67], a[204:207], a[44:47], v[64:67]
    v_exp_f32 v21, v57
    v_mfma_f32_16x16x32_bf16 v[64:67], a[200:203], a[40:43], v[64:67]
    v_add_f32 v8, v8, v21
    v_cvt_pk_bf16_f32 v126, v20, v21
    v_mfma_f32_16x16x32_bf16 v[64:67], a[196:199], a[36:39], v[64:67]
    s_add_u32 s22, s22, 32768
    v_mfma_f32_16x16x32_bf16 v[64:67], a[192:195], a[32:35], v[64:67]
    v_mfma_f32_16x16x32_bf16 v[68:71], a[192:195], a[64:67], v[32:35]
    buffer_load_dword a168, v15, s[72:75], s76 offen
    v_mfma_f32_16x16x32_bf16 v[68:71], a[196:199], a[68:71], v[68:71]
    v_exp_f32 v22, v58
    v_mfma_f32_16x16x32_bf16 v[68:71], a[200:203], a[72:75], v[68:71]
    ds_read_b64_tr_b16 a[192:193], v2 offset:0
    v_add_f32 v8, v8, v22
    v_mfma_f32_16x16x32_bf16 v[68:71], a[204:207], a[76:79], v[68:71]
    v_exp_f32 v23, v59
    v_mfma_f32_16x16x32_bf16 v[68:71], a[208:211], a[80:83], v[68:71]
    ds_read_b64_tr_b16 a[194:195], v2 offset:512
    v_add_f32 v8, v8, v23
    v_mfma_f32_16x16x32_bf16 v[68:71], a[212:215], a[84:87], v[68:71]
    s_add_u32 m0, s23, 33792
    ds_read_b64_tr_b16 a[196:197], v2 offset:16896
    v_cvt_pk_bf16_f32 v127, v22, v23
    v_mfma_f32_16x16x32_bf16 v[68:71], a[216:219], a[88:91], v[68:71]
    buffer_load_dwordx4 v3, s[4:7], s21 offen offset:0 nt lds
    v_mfma_f32_16x16x32_bf16 v[68:71], a[220:223], a[92:95], v[68:71]
    v_exp_f32 v16, v52
    v_mfma_f32_16x16x32_bf16 v[80:83], a[252:255], a[92:95], v[32:35]
    ds_read_b64_tr_b16 a[198:199], v2 offset:17408
    v_add_f32 v7, v7, v16
    v_mfma_f32_16x16x32_bf16 v[80:83], a[248:251], a[88:91], v[80:83]
    ds_read_b64_tr_b16 a[204:205], v2 offset:16928
    v_mfma_f32_16x16x32_bf16 v[80:83], a[244:247], a[84:87], v[80:83]
    ds_read_b64_tr_b16 a[206:207], v2 offset:17440
    v_mfma_f32_16x16x32_bf16 v[80:83], a[240:243], a[80:83], v[80:83]
    v_exp_f32 v17, v53
    v_mfma_f32_16x16x32_bf16 v[80:83], a[236:239], a[76:79], v[80:83]
    ds_read_b64_tr_b16 a[200:201], v2 offset:32
    v_add_f32 v7, v7, v17
    v_mfma_f32_16x16x32_bf16 v[80:83], a[232:235], a[72:75], v[80:83]
    ds_read_b64_tr_b16 a[202:203], v2 offset:544
    v_cvt_pk_bf16_f32 v118, v16, v17
    v_mfma_f32_16x16x32_bf16 v[80:83], a[228:231], a[68:71], v[80:83]
    v_exp_f32 v18, v54
    v_mfma_f32_16x16x32_bf16 v[80:83], a[224:227], a[64:67], v[80:83]
    s_add_u32 m0, s23, 33824
    ds_read_b64_tr_b16 a[208:209], v2 offset:64
    v_add_f32 v7, v7, v18
    v_mfma_f32_16x16x32_bf16 v[76:79], a[224:227], a[32:35], v[28:31]
    buffer_load_dwordx4 v3, s[4:7], s21 offen offset:1024 nt lds
    v_mfma_f32_16x16x32_bf16 v[76:79], a[228:231], a[36:39], v[76:79]
    ds_read_b64_tr_b16 a[210:211], v2 offset:576
    v_mfma_f32_16x16x32_bf16 v[76:79], a[232:235], a[40:43], v[76:79]
    v_exp_f32 v19, v55
    v_mfma_f32_16x16x32_bf16 v[76:79], a[236:239], a[44:47], v[76:79]
    ds_read_b64_tr_b16 a[212:213], v2 offset:16960
    v_add_f32 v7, v7, v19
    v_mfma_f32_16x16x32_bf16 v[76:79], a[240:243], a[48:51], v[76:79]
    ds_read_b64_tr_b16 a[214:215], v2 offset:17472
    v_cvt_pk_bf16_f32 v119, v18, v19
    v_mfma_f32_16x16x32_bf16 v[76:79], a[244:247], a[52:55], v[76:79]
    v_exp_f32 v20, v48
    v_mfma_f32_16x16x32_bf16 v[76:79], a[248:251], a[56:59], v[76:79]
    ds_read_b64_tr_b16 a[220:221], v2 offset:16992
    v_add_f32 v6, v6, v20
    v_mfma_f32_16x16x32_bf16 v[76:79], a[252:255], a[60:63], v[76:79]
    ds_read_b64_tr_b16 a[222:223], v2 offset:17504
    v_mfma_f32_16x16x32_bf16 v[72:75], a[252:255], a[28:31], v[24:27]
    ds_read_b64_tr_b16 a[216:217], v2 offset:96
    v_mfma_f32_16x16x32_bf16 v[72:75], a[248:251], a[24:27], v[72:75]
    s_add_u32 m0, s23, 33856
    v_exp_f32 v21, v49
    v_mfma_f32_16x16x32_bf16 v[72:75], a[244:247], a[20:23], v[72:75]
    buffer_load_dwordx4 v3, s[4:7], s21 offen offset:2048 nt lds
    v_mfma_f32_16x16x32_bf16 v[72:75], a[240:243], a[16:19], v[72:75]
    ds_read_b64_tr_b16 a[218:219], v2 offset:608
    v_add_f32 v6, v6, v21
    v_mfma_f32_16x16x32_bf16 v[72:75], a[236:239], a[12:15], v[72:75]
    v_cvt_pk_bf16_f32 v110, v20, v21
    v_mfma_f32_16x16x32_bf16 v[72:75], a[232:235], a[8:11], v[72:75]
    v_exp_f32 v22, v50
    v_mfma_f32_16x16x32_bf16 v[72:75], a[228:231], a[4:7], v[72:75]
    v_add_f32 v6, v6, v22
    v_mfma_f32_16x16x32_bf16 v[72:75], a[224:227], a[0:3], v[72:75]
    s_waitcnt lgkmcnt(2)
    ds_read_b64_tr_b16 a[224:225], v2 offset:128
    v_mfma_f32_16x16x32_bf16 a[96:99], v[84:87], a[192:195], a[96:99]
    v_exp_f32 v23, v51
    v_mfma_f32_16x16x32_bf16 a[96:99], v[88:91], a[196:199], a[96:99]
    ds_read_b64_tr_b16 a[226:227], v2 offset:640
    v_add_f32 v6, v6, v23
    v_mfma_f32_16x16x32_bf16 a[100:103], v[96:99], a[196:199], a[100:103]
    ds_read_b64_tr_b16 a[228:229], v2 offset:17024
    v_cvt_pk_bf16_f32 v111, v22, v23
    v_mfma_f32_16x16x32_bf16 a[100:103], v[92:95], a[192:195], a[100:103]
    s_add_u32 m0, s23, 33888
    ds_read_b64_tr_b16 a[230:231], v2 offset:17536
    v_mfma_f32_16x16x32_bf16 a[104:107], v[100:103], a[192:195], a[104:107]
    buffer_load_dwordx4 v3, s[4:7], s21 offen offset:3072 nt lds
    v_mfma_f32_16x16x32_bf16 a[104:107], v[104:107], a[196:199], a[104:107]
    v_exp_f32 v16, v60
    v_mfma_f32_16x16x32_bf16 a[116:119], v[104:107], a[204:207], a[116:119]
    ds_read_b64_tr_b16 a[236:237], v2 offset:17056
    v_add_f32 v6, v6, v16
    v_mfma_f32_16x16x32_bf16 a[116:119], v[100:103], a[200:203], a[116:119]
    ds_read_b64_tr_b16 a[238:239], v2 offset:17568
    v_mfma_f32_16x16x32_bf16 a[112:115], v[92:95], a[200:203], a[112:115]
    v_exp_f32 v17, v61
    v_mfma_f32_16x16x32_bf16 a[112:115], v[96:99], a[204:207], a[112:115]
    ds_read_b64_tr_b16 a[232:233], v2 offset:160
    v_add_f32 v6, v6, v17
    v_mfma_f32_16x16x32_bf16 a[108:111], v[88:91], a[204:207], a[108:111]
    ds_read_b64_tr_b16 a[234:235], v2 offset:672
    v_cvt_pk_bf16_f32 v112, v16, v17
    v_mfma_f32_16x16x32_bf16 a[108:111], v[84:87], a[200:203], a[108:111]
    v_exp_f32 v18, v62
    v_mfma_f32_16x16x32_bf16 a[120:123], v[84:87], a[208:211], a[120:123]
    ds_read_b64_tr_b16 a[240:241], v2 offset:192
    v_add_f32 v6, v6, v18
    v_mfma_f32_16x16x32_bf16 a[120:123], v[88:91], a[212:215], a[120:123]
    s_add_u32 m0, s23, 38016
    ds_read_b64_tr_b16 a[242:243], v2 offset:704
    v_mfma_f32_16x16x32_bf16 a[124:127], v[96:99], a[212:215], a[124:127]
    buffer_load_dwordx4 v4, s[4:7], s21 offen offset:0 nt lds
    v_mfma_f32_16x16x32_bf16 a[124:127], v[92:95], a[208:211], a[124:127]
    v_exp_f32 v19, v63
    v_mfma_f32_16x16x32_bf16 a[128:131], v[100:103], a[208:211], a[128:131]
    ds_read_b64_tr_b16 a[244:245], v2 offset:17088
    v_add_f32 v6, v6, v19
    v_mfma_f32_16x16x32_bf16 a[128:131], v[104:107], a[212:215], a[128:131]
    ds_read_b64_tr_b16 a[246:247], v2 offset:17600
    v_cvt_pk_bf16_f32 v113, v18, v19
    v_mfma_f32_16x16x32_bf16 a[140:143], v[104:107], a[220:223], a[140:143]
    s_waitcnt lgkmcnt(4)
    ds_read_b64_tr_b16 a[252:253], v2 offset:17120
    v_mfma_f32_16x16x32_bf16 a[140:143], v[100:103], a[216:219], a[140:143]
    v_exp_f32 v20, v64
    v_mfma_f32_16x16x32_bf16 a[136:139], v[92:95], a[216:219], a[136:139]
    ds_read_b64_tr_b16 a[254:255], v2 offset:17632
    v_add_f32 v7, v7, v20
    v_mfma_f32_16x16x32_bf16 a[136:139], v[96:99], a[220:223], a[136:139]
    ds_read_b64_tr_b16 a[248:249], v2 offset:224
    v_mfma_f32_16x16x32_bf16 a[132:135], v[88:91], a[220:223], a[132:135]
    v_exp_f32 v21, v65
    v_mfma_f32_16x16x32_bf16 a[132:135], v[84:87], a[216:219], a[132:135]
    s_add_u32 m0, s23, 38048
    ds_read_b64_tr_b16 a[250:251], v2 offset:736
    v_add_f32 v7, v7, v21
    v_mfma_f32_16x16x32_bf16 a[144:147], v[84:87], a[224:227], a[144:147]
    buffer_load_dwordx4 v4, s[4:7], s21 offen offset:1024 nt lds
    v_mfma_f32_16x16x32_bf16 a[144:147], v[88:91], a[228:231], a[144:147]
    ds_read_b64_tr_b16 a[192:193], v2 offset:256
    v_cvt_pk_bf16_f32 v120, v20, v21
    v_mfma_f32_16x16x32_bf16 a[148:151], v[96:99], a[228:231], a[148:151]
    v_exp_f32 v22, v66
    v_mfma_f32_16x16x32_bf16 a[148:151], v[92:95], a[224:227], a[148:151]
    ds_read_b64_tr_b16 a[194:195], v2 offset:768
    v_add_f32 v7, v7, v22
    v_mfma_f32_16x16x32_bf16 a[152:155], v[100:103], a[224:227], a[152:155]
    ds_read_b64_tr_b16 a[196:197], v2 offset:17152
    v_mfma_f32_16x16x32_bf16 a[152:155], v[104:107], a[228:231], a[152:155]
    ds_read_b64_tr_b16 a[198:199], v2 offset:17664
    v_mfma_f32_16x16x32_bf16 v[132:135], v[104:107], a[236:239], v[132:135]
    v_exp_f32 v23, v67
    v_mfma_f32_16x16x32_bf16 v[132:135], v[100:103], a[232:235], v[132:135]
    ds_read_b64_tr_b16 a[204:205], v2 offset:17184
    v_add_f32 v7, v7, v23
    v_mfma_f32_16x16x32_bf16 a[160:163], v[92:95], a[232:235], a[160:163]
    ds_read_b64_tr_b16 a[206:207], v2 offset:17696
    v_cvt_pk_bf16_f32 v121, v22, v23
    v_mfma_f32_16x16x32_bf16 a[160:163], v[96:99], a[236:239], a[160:163]
    s_add_u32 m0, s23, 38080
    v_exp_f32 v16, v68
    v_mfma_f32_16x16x32_bf16 a[156:159], v[88:91], a[236:239], a[156:159]
    buffer_load_dwordx4 v4, s[4:7], s21 offen offset:2048 nt lds
    v_mfma_f32_16x16x32_bf16 a[156:159], v[84:87], a[232:235], a[156:159]
    s_waitcnt lgkmcnt(4)
    ds_read_b64_tr_b16 a[200:201], v2 offset:288
    v_add_f32 v8, v8, v16
    v_mfma_f32_16x16x32_bf16 v[136:139], v[84:87], a[240:243], v[136:139]
    ds_read_b64_tr_b16 a[202:203], v2 offset:800
    v_mfma_f32_16x16x32_bf16 v[136:139], v[88:91], a[244:247], v[136:139]
    v_exp_f32 v17, v69
    v_mfma_f32_16x16x32_bf16 v[140:143], v[96:99], a[244:247], v[140:143]
    ds_read_b64_tr_b16 a[208:209], v2 offset:320
    v_add_f32 v8, v8, v17
    v_mfma_f32_16x16x32_bf16 v[140:143], v[92:95], a[240:243], v[140:143]
    ds_read_b64_tr_b16 a[210:211], v2 offset:832
    v_cvt_pk_bf16_f32 v128, v16, v17
    v_mfma_f32_16x16x32_bf16 v[144:147], v[100:103], a[240:243], v[144:147]
    ds_read_b64_tr_b16 a[212:213], v2 offset:17216
    v_mfma_f32_16x16x32_bf16 v[144:147], v[104:107], a[244:247], v[144:147]
    v_exp_f32 v18, v70
    v_mfma_f32_16x16x32_bf16 v[156:159], v[104:107], a[252:255], v[156:159]
    ds_read_b64_tr_b16 a[214:215], v2 offset:17728
    v_add_f32 v8, v8, v18
    v_mfma_f32_16x16x32_bf16 v[156:159], v[100:103], a[248:251], v[156:159]
    s_add_u32 m0, s23, 38112
    ds_read_b64_tr_b16 a[220:221], v2 offset:17248
    v_mfma_f32_16x16x32_bf16 v[152:155], v[92:95], a[248:251], v[152:155]
    buffer_load_dwordx4 v4, s[4:7], s21 offen offset:3072 nt lds
    v_mfma_f32_16x16x32_bf16 v[152:155], v[96:99], a[252:255], v[152:155]
    v_exp_f32 v19, v71
    v_mfma_f32_16x16x32_bf16 v[148:151], v[88:91], a[252:255], v[148:151]
    ds_read_b64_tr_b16 a[222:223], v2 offset:17760
    v_add_f32 v8, v8, v19
    v_mfma_f32_16x16x32_bf16 v[148:151], v[84:87], a[248:251], v[148:151]
    ds_read_b64_tr_b16 a[216:217], v2 offset:352
    v_cvt_pk_bf16_f32 v129, v18, v19
    v_mfma_f32_16x16x32_bf16 v[160:163], v[84:87], a[192:195], v[160:163]
    s_waitcnt lgkmcnt(4)
    v_exp_f32 v20, v80
    v_mfma_f32_16x16x32_bf16 v[160:163], v[88:91], a[196:199], v[160:163]
    ds_read_b64_tr_b16 a[218:219], v2 offset:864
    v_add_f32 v8, v8, v20
    v_mfma_f32_16x16x32_bf16 v[164:167], v[96:99], a[196:199], v[164:167]
    ds_read_b64_tr_b16 a[224:225], v2 offset:384
    v_mfma_f32_16x16x32_bf16 v[164:167], v[92:95], a[192:195], v[164:167]
    ds_read_b64_tr_b16 a[226:227], v2 offset:896
    v_mfma_f32_16x16x32_bf16 v[168:171], v[100:103], a[192:195], v[168:171]
    v_exp_f32 v21, v81
    v_mfma_f32_16x16x32_bf16 v[168:171], v[104:107], a[196:199], v[168:171]
    ds_read_b64_tr_b16 a[228:229], v2 offset:17280
    v_add_f32 v8, v8, v21
    v_mfma_f32_16x16x32_bf16 v[180:183], v[104:107], a[204:207], v[180:183]
    s_add_u32 s21, s21, 32768
    ds_read_b64_tr_b16 a[230:231], v2 offset:17792
    v_cvt_pk_bf16_f32 v130, v20, v21
    v_mfma_f32_16x16x32_bf16 v[180:183], v[100:103], a[200:203], v[180:183]
    v_exp_f32 v22, v82
    v_mfma_f32_16x16x32_bf16 v[176:179], v[92:95], a[200:203], v[176:179]
    ds_read_b64_tr_b16 a[236:237], v2 offset:17312
    v_add_f32 v8, v8, v22
    v_mfma_f32_16x16x32_bf16 v[176:179], v[96:99], a[204:207], v[176:179]
    ds_read_b64_tr_b16 a[238:239], v2 offset:17824
    v_mfma_f32_16x16x32_bf16 v[172:175], v[88:91], a[204:207], v[172:175]
    ds_read_b64_tr_b16 a[232:233], v2 offset:416
    v_mfma_f32_16x16x32_bf16 v[172:175], v[84:87], a[200:203], v[172:175]
    v_exp_f32 v23, v83
    v_mfma_f32_16x16x32_bf16 v[184:187], v[84:87], a[208:211], v[184:187]
    s_waitcnt lgkmcnt(5)
    ds_read_b64_tr_b16 a[234:235], v2 offset:928
    v_add_f32 v8, v8, v23
    v_mfma_f32_16x16x32_bf16 v[184:187], v[88:91], a[212:215], v[184:187]
    ds_read_b64_tr_b16 a[240:241], v2 offset:448
    v_cvt_pk_bf16_f32 v131, v22, v23
    v_mfma_f32_16x16x32_bf16 v[188:191], v[96:99], a[212:215], v[188:191]
    ds_read_b64_tr_b16 a[242:243], v2 offset:960
    v_mfma_f32_16x16x32_bf16 v[188:191], v[92:95], a[208:211], v[188:191]
    v_exp_f32 v16, v76
    v_mfma_f32_16x16x32_bf16 v[192:195], v[100:103], a[208:211], v[192:195]
    ds_read_b64_tr_b16 a[244:245], v2 offset:17344
    v_add_f32 v7, v7, v16
    v_mfma_f32_16x16x32_bf16 v[192:195], v[104:107], a[212:215], v[192:195]
    ds_read_b64_tr_b16 a[246:247], v2 offset:17856
    v_mfma_f32_16x16x32_bf16 v[204:207], v[104:107], a[220:223], v[204:207]
    v_exp_f32 v17, v77
    v_mfma_f32_16x16x32_bf16 v[204:207], v[100:103], a[216:219], v[204:207]
    ds_read_b64_tr_b16 a[252:253], v2 offset:17376
    v_add_f32 v7, v7, v17
    v_mfma_f32_16x16x32_bf16 v[200:203], v[92:95], a[216:219], v[200:203]
    ds_read_b64_tr_b16 a[254:255], v2 offset:17888
    v_cvt_pk_bf16_f32 v122, v16, v17
    v_mfma_f32_16x16x32_bf16 v[200:203], v[96:99], a[220:223], v[200:203]
    s_sub_u32 s76, s76, 1024
    s_cselect_b32 s76, 0x18000, s76
    ds_read_b64_tr_b16 a[248:249], v2 offset:480
    v_mfma_f32_16x16x32_bf16 v[196:199], v[88:91], a[220:223], v[196:199]
    v_exp_f32 v18, v78
    v_mfma_f32_16x16x32_bf16 v[196:199], v[84:87], a[216:219], v[196:199]
    ds_read_b64_tr_b16 a[250:251], v2 offset:992
    v_add_f32 v7, v7, v18
    v_mfma_f32_16x16x32_bf16 v[208:211], v[84:87], a[224:227], v[208:211]
    s_waitcnt lgkmcnt(5)
    v_mfma_f32_16x16x32_bf16 v[208:211], v[88:91], a[228:231], v[208:211]
    v_mfma_f32_16x16x32_bf16 v[212:215], v[96:99], a[228:231], v[212:215]
    v_exp_f32 v19, v79
    v_mfma_f32_16x16x32_bf16 v[212:215], v[92:95], a[224:227], v[212:215]
    v_add_f32 v7, v7, v19
    v_cvt_pk_bf16_f32 v123, v18, v19
    v_mfma_f32_16x16x32_bf16 v[216:219], v[100:103], a[224:227], v[216:219]
    v_mfma_f32_16x16x32_bf16 v[216:219], v[104:107], a[228:231], v[216:219]
    v_exp_f32 v20, v72
    v_mfma_f32_16x16x32_bf16 v[228:231], v[104:107], a[236:239], v[228:231]
    v_add_f32 v6, v6, v20
    v_mfma_f32_16x16x32_bf16 v[228:231], v[100:103], a[232:235], v[228:231]
    v_mfma_f32_16x16x32_bf16 v[224:227], v[92:95], a[232:235], v[224:227]
    v_mfma_f32_16x16x32_bf16 v[224:227], v[96:99], a[236:239], v[224:227]
    s_waitcnt vmcnt(17) lgkmcnt(0)
    s_barrier
    v_mfma_f32_16x16x32_bf16 v[220:223], v[88:91], a[236:239], v[220:223]
    v_exp_f32 v21, v73
    v_mfma_f32_16x16x32_bf16 v[220:223], v[84:87], a[232:235], v[220:223]
    ds_read_b128 a[192:195], v1 offset:0
    v_add_f32 v6, v6, v21
    v_mfma_f32_16x16x32_bf16 v[232:235], v[84:87], a[240:243], v[232:235]
    ds_read_b128 a[196:199], v1 offset:64
    v_cvt_pk_bf16_f32 v114, v20, v21
    v_mfma_f32_16x16x32_bf16 v[232:235], v[88:91], a[244:247], v[232:235]
    v_exp_f32 v22, v74
    v_mfma_f32_16x16x32_bf16 v[236:239], v[96:99], a[244:247], v[236:239]
    ds_read_b128 a[200:203], v1 offset:128
    v_add_f32 v6, v6, v22
    v_mfma_f32_16x16x32_bf16 v[236:239], v[92:95], a[240:243], v[236:239]
    ds_read_b128 a[204:207], v1 offset:192
    v_mfma_f32_16x16x32_bf16 v[240:243], v[100:103], a[240:243], v[240:243]
    v_exp_f32 v23, v75
    v_mfma_f32_16x16x32_bf16 v[240:243], v[104:107], a[244:247], v[240:243]
    ds_read_b128 a[208:211], v1 offset:256
    v_add_f32 v6, v6, v23
    v_mfma_f32_16x16x32_bf16 v[252:255], v[104:107], a[252:255], v[252:255]
    ds_read_b128 a[212:215], v1 offset:320
    v_cvt_pk_bf16_f32 v115, v22, v23
    v_mfma_f32_16x16x32_bf16 v[252:255], v[100:103], a[248:251], v[252:255]
    ds_read_b128 a[216:219], v1 offset:384
    v_max3_f32 v5, v6, v7, v8
    v_mfma_f32_16x16x32_bf16 v[248:251], v[92:95], a[248:251], v[248:251]
    ds_read_b128 a[220:223], v1 offset:448
    v_cmp_nge_f32 vcc, s26, v5
    v_mfma_f32_16x16x32_bf16 v[248:251], v[96:99], a[252:255], v[248:251]
    v_mfma_f32_16x16x32_bf16 v[244:247], v[88:91], a[252:255], v[244:247]
    v_mfma_f32_16x16x32_bf16 v[244:247], v[84:87], a[248:251], v[244:247]
    s_cbranch_vccnz L_rare0_1
L_j0_1:
    s_waitcnt lgkmcnt(4)
    v_mfma_f32_16x16x32_bf16 v[36:39], a[192:195], a[0:3], v[24:27]
    ds_read_b128 a[252:255], v1 offset:960
    v_add_f32 v9, v9, v6
    v_mfma_f32_16x16x32_bf16 v[36:39], a[196:199], a[4:7], v[36:39]
    ds_read_b128 a[248:251], v1 offset:896
    v_add_f32 v10, v10, v7
    v_mfma_f32_16x16x32_bf16 v[36:39], a[200:203], a[8:11], v[36:39]
    s_add_u32 m0, s24, 0
    ds_read_b128 a[244:247], v1 offset:832
    v_add_f32 v11, v11, v8
    v_mfma_f32_16x16x32_bf16 v[36:39], a[204:207], a[12:15], v[36:39]
    s_waitcnt lgkmcnt(4)
    buffer_load_dwordx4 v3, s[8:11], s22 offen offset:0 nt lds
    v_mfma_f32_16x16x32_bf16 v[36:39], a[208:211], a[16:19], v[36:39]
    ds_read_b128 a[240:243], v1 offset:768
    v_mfma_f32_16x16x32_bf16 v[36:39], a[212:215], a[20:23], v[36:39]
    ds_read_b128 a[236:239], v1 offset:704
    v_mfma_f32_16x16x32_bf16 v[36:39], a[216:219], a[24:27], v[36:39]
    s_waitcnt lgkmcnt(5)
    ds_read_b128 a[232:235], v1 offset:640
    v_mfma_f32_16x16x32_bf16 v[36:39], a[220:223], a[28:31], v[36:39]
    ds_read_b128 a[228:231], v1 offset:576
    v_mfma_f32_16x16x32_bf16 v[40:43], a[220:223], a[60:63], v[28:31]
    ds_read_b128 a[224:227], v1 offset:512
    v_mfma_f32_16x16x32_bf16 v[40:43], a[216:219], a[56:59], v[40:43]
    s_add_u32 m0, s24, 32
    v_mfma_f32_16x16x32_bf16 v[40:43], a[212:215], a[52:55], v[40:43]
    buffer_load_dwordx4 v3, s[8:11], s22 offen offset:1024 nt lds
    v_mfma_f32_16x16x32_bf16 v[40:43], a[208:211], a[48:51], v[40:43]
    v_mfma_f32_16x16x32_bf16 v[40:43], a[204:207], a[44:47], v[40:43]
    v_mfma_f32_16x16x32_bf16 v[40:43], a[200:203], a[40:43], v[40:43]
    v_exp_f32 v16, v36
    v_mfma_f32_16x16x32_bf16 v[40:43], a[196:199], a[36:39], v[40:43]
    v_mfma_f32_16x16x32_bf16 v[40:43], a[192:195], a[32:35], v[40:43]
    v_mfma_f32_16x16x32_bf16 v[44:47], a[192:195], a[64:67], v[32:35]
    s_add_u32 m0, s24, 64
    ds_read_b128 a[192:195], v1 offset:16896
    v_mfma_f32_16x16x32_bf16 v[44:47], a[196:199], a[68:71], v[44:47]
    buffer_load_dwordx4 v3, s[8:11], s22 offen offset:2048 nt lds
    v_mfma_f32_16x16x32_bf16 v[44:47], a[200:203], a[72:75], v[44:47]
    v_exp_f32 v17, v37
    v_mfma_f32_16x16x32_bf16 v[44:47], a[204:207], a[76:79], v[44:47]
    ds_read_b128 a[196:199], v1 offset:16960
    v_add_f32 v6, v16, v17
    v_mfma_f32_16x16x32_bf16 v[44:47], a[208:211], a[80:83], v[44:47]
    ds_read_b128 a[200:203], v1 offset:17024
    v_cvt_pk_bf16_f32 v84, v16, v17
    v_mfma_f32_16x16x32_bf16 v[44:47], a[212:215], a[84:87], v[44:47]
    v_exp_f32 v18, v38
    v_mfma_f32_16x16x32_bf16 v[44:47], a[216:219], a[88:91], v[44:47]
    s_add_u32 m0, s24, 96
    ds_read_b128 a[204:207], v1 offset:17088
    v_add_f32 v6, v6, v18
    v_mfma_f32_16x16x32_bf16 v[44:47], a[220:223], a[92:95], v[44:47]
    s_waitcnt lgkmcnt(4)
    ds_read_b128 a[208:211], v1 offset:17152
    v_mfma_f32_16x16x32_bf16 v[56:59], a[252:255], a[92:95], v[32:35]
    buffer_load_dwordx4 v3, s[8:11], s22 offen offset:3072 nt lds
    v_mfma_f32_16x16x32_bf16 v[56:59], a[248:251], a[88:91], v[56:59]
    v_exp_f32 v19, v39
    v_mfma_f32_16x16x32_bf16 v[56:59], a[244:247], a[84:87], v[56:59]
    ds_read_b128 a[212:215], v1 offset:17216
    v_add_f32 v6, v6, v19
    v_mfma_f32_16x16x32_bf16 v[56:59], a[240:243], a[80:83], v[56:59]
    ds_read_b128 a[216:219], v1 offset:17280
    v_cvt_pk_bf16_f32 v85, v18, v19
    v_mfma_f32_16x16x32_bf16 v[56:59], a[236:239], a[76:79], v[56:59]
    v_exp_f32 v20, v40
    v_mfma_f32_16x16x32_bf16 v[56:59], a[232:235], a[72:75], v[56:59]
    ds_read_b128 a[220:223], v1 offset:17344
    v_mfma_f32_16x16x32_bf16 v[56:59], a[228:231], a[68:71], v[56:59]
    s_add_u32 m0, s24, 4224
    v_mfma_f32_16x16x32_bf16 v[56:59], a[224:227], a[64:67], v[56:59]
    buffer_load_dwordx4 v4, s[8:11], s22 offen offset:0 nt lds
    v_mfma_f32_16x16x32_bf16 v[52:55], a[224:227], a[32:35], v[28:31]
    v_exp_f32 v21, v41
    v_mfma_f32_16x16x32_bf16 v[52:55], a[228:231], a[36:39], v[52:55]
    v_add_f32 v7, v20, v21
    v_cvt_pk_bf16_f32 v92, v20, v21
    v_mfma_f32_16x16x32_bf16 v[52:55], a[232:235], a[40:43], v[52:55]
    v_mfma_f32_16x16x32_bf16 v[52:55], a[236:239], a[44:47], v[52:55]
    v_exp_f32 v22, v42
    v_mfma_f32_16x16x32_bf16 v[52:55], a[240:243], a[48:51], v[52:55]
    v_add_f32 v7, v7, v22
    v_mfma_f32_16x16x32_bf16 v[52:55], a[244:247], a[52:55], v[52:55]
    s_add_u32 m0, s24, 4256
    v_mfma_f32_16x16x32_bf16 v[52:55], a[248:251], a[56:59], v[52:55]
    buffer_load_dwordx4 v4, s[8:11], s22 offen offset:1024 nt lds
    v_mfma_f32_16x16x32_bf16 v[52:55], a[252:255], a[60:63], v[52:55]
    v_exp_f32 v23, v43
    v_mfma_f32_16x16x32_bf16 v[48:51], a[252:255], a[28:31], v[24:27]
    ds_read_b128 a[252:255], v1 offset:17856
    v_add_f32 v7, v7, v23
    v_mfma_f32_16x16x32_bf16 v[48:51], a[248:251], a[24:27], v[48:51]
    ds_read_b128 a[248:251], v1 offset:17792
    v_cvt_pk_bf16_f32 v93, v22, v23
    v_mfma_f32_16x16x32_bf16 v[48:51], a[244:247], a[20:23], v[48:51]
    v_exp_f32 v16, v44
    v_mfma_f32_16x16x32_bf16 v[48:51], a[240:243], a[16:19], v[48:51]
    ds_read_b128 a[244:247], v1 offset:17728
    v_mfma_f32_16x16x32_bf16 v[48:51], a[236:239], a[12:15], v[48:51]
    s_add_u32 m0, s24, 4288
    ds_read_b128 a[240:243], v1 offset:17664
    v_mfma_f32_16x16x32_bf16 v[48:51], a[232:235], a[8:11], v[48:51]
    buffer_load_dwordx4 v4, s[8:11], s22 offen offset:2048 nt lds
    v_mfma_f32_16x16x32_bf16 v[48:51], a[228:231], a[4:7], v[48:51]
    v_exp_f32 v17, v45
    v_mfma_f32_16x16x32_bf16 v[48:51], a[224:227], a[0:3], v[48:51]
    s_waitcnt lgkmcnt(4)
    ds_read_b128 a[236:239], v1 offset:17600
    v_add_f32 v8, v16, v17
    v_mfma_f32_16x16x32_bf16 v[60:63], a[192:195], a[0:3], v[24:27]
    ds_read_b128 a[232:235], v1 offset:17536
    v_cvt_pk_bf16_f32 v100, v16, v17
    v_mfma_f32_16x16x32_bf16 v[60:63], a[196:199], a[4:7], v[60:63]
    v_exp_f32 v18, v46
    v_mfma_f32_16x16x32_bf16 v[60:63], a[200:203], a[8:11], v[60:63]
    ds_read_b128 a[228:231], v1 offset:17472
    v_add_f32 v8, v8, v18
    v_mfma_f32_16x16x32_bf16 v[60:63], a[204:207], a[12:15], v[60:63]
    s_add_u32 m0, s24, 4320
    ds_read_b128 a[224:227], v1 offset:17408
    v_mfma_f32_16x16x32_bf16 v[60:63], a[208:211], a[16:19], v[60:63]
    buffer_load_dwordx4 v4, s[8:11], s22 offen offset:3072 nt lds
    v_mfma_f32_16x16x32_bf16 v[60:63], a[212:215], a[20:23], v[60:63]
    v_exp_f32 v19, v47
    v_mfma_f32_16x16x32_bf16 v[60:63], a[216:219], a[24:27], v[60:63]
    v_add_f32 v8, v8, v19
    v_cvt_pk_bf16_f32 v101, v18, v19
    v_mfma_f32_16x16x32_bf16 v[60:63], a[220:223], a[28:31], v[60:63]
    v_mfma_f32_16x16x32_bf16 v[64:67], a[220:223], a[60:63], v[28:31]
    v_mfma_f32_16x16x32_bf16 v[64:67], a[216:219], a[56:59], v[64:67]
    v_exp_f32 v20, v56
    v_mfma_f32_16x16x32_bf16 v[64:67], a[212:215], a[52:55], v[64:67]
    v_add_f32 v8, v8, v20
    v_mfma_f32_16x16x32_bf16 v[64:67], a[208:211], a[48:51], v[64:67]
    s_waitcnt vmcnt(17) lgkmcnt(0)
    s_barrier
    v_mfma_f32_16x16x32_bf16 v[64:67], a[204:207], a[44:47], v[64:67]
    v_exp_f32 v21, v57
    v_mfma_f32_16x16x32_bf16 v[64:67], a[200:203], a[40:43], v[64:67]
    v_add_f32 v8, v8, v21
    v_cvt_pk_bf16_f32 v102, v20, v21
    v_mfma_f32_16x16x32_bf16 v[64:67], a[196:199], a[36:39], v[64:67]
    s_add_u32 s22, s22, 32768
    v_mfma_f32_16x16x32_bf16 v[64:67], a[192:195], a[32:35], v[64:67]
    v_mfma_f32_16x16x32_bf16 v[68:71], a[192:195], a[64:67], v[32:35]
    buffer_load_dword a168, v15, s[72:75], s76 offen
    v_mfma_f32_16x16x32_bf16 v[68:71], a[196:199], a[68:71], v[68:71]
    v_exp_f32 v22, v58
    v_mfma_f32_16x16x32_bf16 v[68:71], a[200:203], a[72:75], v[68:71]
    ds_read_b64_tr_b16 a[192:193], v2 offset:33792
    v_add_f32 v8, v8, v22
    v_mfma_f32_16x16x32_bf16 v[68:71], a[204:207], a[76:79], v[68:71]
    v_exp_f32 v23, v59
    v_mfma_f32_16x16x32_bf16 v[68:71], a[208:211], a[80:83], v[68:71]
    ds_read_b64_tr_b16 a[194:195], v2 offset:34304
    v_add_f32 v8, v8, v23
    v_mfma_f32_16x16x32_bf16 v[68:71], a[212:215], a[84:87], v[68:71]
    s_add_u32 m0, s23, 0
    ds_read_b64_tr_b16 a[196:197], v2 offset:50688
    v_cvt_pk_bf16_f32 v103, v22, v23
    v_mfma_f32_16x16x32_bf16 v[68:71], a[216:219], a[88:91], v[68:71]
    buffer_load_dwordx4 v3, s[4:7], s21 offen offset:0 nt lds
    v_mfma_f32_16x16x32_bf16 v[68:71], a[220:223], a[92:95], v[68:71]
    v_exp_f32 v16, v52
    v_mfma_f32_16x16x32_bf16 v[80:83], a[252:255], a[92:95], v[32:35]
    ds_read_b64_tr_b16 a[198:199], v2 offset:51200
    v_add_f32 v7, v7, v16
    v_mfma_f32_16x16x32_bf16 v[80:83], a[248:251], a[88:91], v[80:83]
    ds_read_b64_tr_b16 a[204:205], v2 offset:50720
    v_mfma_f32_16x16x32_bf16 v[80:83], a[244:247], a[84:87], v[80:83]
    ds_read_b64_tr_b16 a[206:207], v2 offset:51232
    v_mfma_f32_16x16x32_bf16 v[80:83], a[240:243], a[80:83], v[80:83]
    v_exp_f32 v17, v53
    v_mfma_f32_16x16x32_bf16 v[80:83], a[236:239], a[76:79], v[80:83]
    ds_read_b64_tr_b16 a[200:201], v2 offset:33824
    v_add_f32 v7, v7, v17
    v_mfma_f32_16x16x32_bf16 v[80:83], a[232:235], a[72:75], v[80:83]
    ds_read_b64_tr_b16 a[202:203], v2 offset:34336
    v_cvt_pk_bf16_f32 v94, v16, v17
    v_mfma_f32_16x16x32_bf16 v[80:83], a[228:231], a[68:71], v[80:83]
    v_exp_f32 v18, v54
    v_mfma_f32_16x16x32_bf16 v[80:83], a[224:227], a[64:67], v[80:83]
    s_add_u32 m0, s23, 32
    ds_read_b64_tr_b16 a[208:209], v2 offset:33856
    v_add_f32 v7, v7, v18
    v_mfma_f32_16x16x32_bf16 v[76:79], a[224:227], a[32:35], v[28:31]
    buffer_load_dwordx4 v3, s[4:7], s21 offen offset:1024 nt lds
    v_mfma_f32_16x16x32_bf16 v[76:79], a[228:231], a[36:39], v[76:79]
    ds_read_b64_tr_b16 a[210:211], v2 offset:34368
    v_mfma_f32_16x16x32_bf16 v[76:79], a[232:235], a[40:43], v[76:79]
    v_exp_f32 v19, v55
    v_mfma_f32_16x16x32_bf16 v[76:79], a[236:239], a[44:47], v[76:79]
    ds_read_b64_tr_b16 a[212:213], v2 offset:50752
    v_add_f32 v7, v7, v19
    v_mfma_f32_16x16x32_bf16 v[76:79], a[240:243], a[48:51], v[76:79]
    ds_read_b64_tr_b16 a[214:215], v2 offset:51264
    v_cvt_pk_bf16_f32 v95, v18, v19
    v_mfma_f32_16x16x32_bf16 v[76:79], a[244:247], a[52:55], v[76:79]
    v_exp_f32 v20, v48
    v_mfma_f32_16x16x32_bf16 v[76:79], a[248:251], a[56:59], v[76:79]
    ds_read_b64_tr_b16 a[220:221], v2 offset:50784
    v_add_f32 v6, v6, v20
    v_mfma_f32_16x16x32_bf16 v[76:79], a[252:255], a[60:63], v[76:79]
    ds_read_b64_tr_b16 a[222:223], v2 offset:51296
    v_mfma_f32_16x16x32_bf16 v[72:75], a[252:255], a[28:31], v[24:27]
    ds_read_b64_tr_b16 a[216:217], v2 offset:33888
    v_mfma_f32_16x16x32_bf16 v[72:75], a[248:251], a[24:27], v[72:75]
    s_add_u32 m0, s23, 64
    v_exp_f32 v21, v49
    v_mfma_f32_16x16x32_bf16 v[72:75], a[244:247], a[20:23], v[72:75]
    buffer_load_dwordx4 v3, s[4:7], s21 offen offset:2048 nt lds
    v_mfma_f32_16x16x32_bf16 v[72:75], a[240:243], a[16:19], v[72:75]
    ds_read_b64_tr_b16 a[218:219], v2 offset:34400
    v_add_f32 v6, v6, v21
    v_mfma_f32_16x16x32_bf16 v[72:75], a[236:239], a[12:15], v[72:75]
    v_cvt_pk_bf16_f32 v86, v20, v21
    v_mfma_f32_16x16x32_bf16 v[72:75], a[232:235], a[8:11], v[72:75]
    v_exp_f32 v22, v50
    v_mfma_f32_16x16x32_bf16 v[72:75], a[228:231], a[4:7], v[72:75]
    v_add_f32 v6, v6, v22
    v_mfma_f32_16x16x32_bf16 v[72:75], a[224:227], a[0:3], v[72:75]
    s_waitcnt lgkmcnt(2)
    ds_read_b64_tr_b16 a[224:225], v2 offset:33920
    v_mfma_f32_16x16x32_bf16 a[96:99], v[108:111], a[192:195], a[96:99]
    v_exp_f32 v23, v51
    v_mfma_f32_16x16x32_bf16 a[96:99], v[112:115], a[196:199], a[96:99]
    ds_read_b64_tr_b16 a[226:227], v2 offset:34432
    v_add_f32 v6, v6, v23
    v_mfma_f32_16x16x32_bf16 a[100:103], v[120:123], a[196:199], a[100:103]
    ds_read_b64_tr_b16 a[228:229], v2 offset:50816
    v_cvt_pk_bf16_f32 v87, v22, v23
    v_mfma_f32_16x16x32_bf16 a[100:103], v[116:119], a[192:195], a[100:103]
    s_add_u32 m0, s23, 96
    ds_read_b64_tr_b16 a[230:231], v2 offset:51328
    v_mfma_f32_16x16x32_bf16 a[104:107], v[124:127], a[192:195], a[104:107]
    buffer_load_dwordx4 v3, s[4:7], s21 offen offset:3072 nt lds
    v_mfma_f32_16x16x32_bf16 a[104:107], v[128:131], a[196:199], a[104:107]
    v_exp_f32 v16, v60
    v_mfma_f32_16x16x32_bf16 a[116:119], v[128:131], a[204:207], a[116:119]
    ds_read_b64_tr_b16 a[236:237], v2 offset:50848
    v_add_f32 v6, v6, v16
    v_mfma_f32_16x16x32_bf16 a[116:119], v[124:127], a[200:203], a[116:119]
    ds_read_b64_tr_b16 a[238:239], v2 offset:51360
    v_mfma_f32_16x16x32_bf16 a[112:115], v[116:119], a[200:203], a[112:115]
    v_exp_f32 v17, v61
    v_mfma_f32_16x16x32_bf16 a[112:115], v[120:123], a[204:207], a[112:115]
    ds_read_b64_tr_b16 a[232:233], v2 offset:33952
    v_add_f32 v6, v6, v17
    v_mfma_f32_16x16x32_bf16 a[108:111], v[112:115], a[204:207], a[108:111]
    ds_read_b64_tr_b16 a[234:235], v2 offset:34464
    v_cvt_pk_bf16_f32 v88, v16, v17
    v_mfma_f32_16x16x32_bf16 a[108:111], v[108:111], a[200:203], a[108:111]
    v_exp_f32 v18, v62
    v_mfma_f32_16x16x32_bf16 a[120:123], v[108:111], a[208:211], a[120:123]
    ds_read_b64_tr_b16 a[240:241], v2 offset:33984
    v_add_f32 v6, v6, v18
    v_mfma_f32_16x16x32_bf16 a[120:123], v[112:115], a[212:215], a[120:123]
    s_add_u32 m0, s23, 4224
    ds_read_b64_tr_b16 a[242:243], v2 offset:34496
    v_mfma_f32_16x16x32_bf16 a[124:127], v[120:123], a[212:215], a[124:127]
    buffer_load_dwordx4 v4, s[4:7], s21 offen offset:0 nt lds
    v_mfma_f32_16x16x32_bf16 a[124:127], v[116:119], a[208:211], a[124:127]
    v_exp_f32 v19, v63
    v_mfma_f32_16x16x32_bf16 a[128:131], v[124:127], a[208:211], a[128:131]
    ds_read_b64_tr_b16 a[244:245], v2 offset:50880
    v_add_f32 v6, v6, v19
    v_mfma_f32_16x16x32_bf16 a[128:131], v[128:131], a[212:215], a[128:131]
    ds_read_b64_tr_b16 a[246:247], v2 offset:51392
    v_cvt_pk_bf16_f32 v89, v18, v19
    v_mfma_f32_16x16x32_bf16 a[140:143], v[128:131], a[220:223], a[140:143]
    s_waitcnt lgkmcnt(4)
    ds_read_b64_tr_b16 a[252:253], v2 offset:50912
    v_mfma_f32_16x16x32_bf16 a[140:143], v[124:127], a[216:219], a[140:143]
    v_exp_f32 v20, v64
    v_mfma_f32_16x16x32_bf16 a[136:139], v[116:119], a[216:219], a[136:139]
    ds_read_b64_tr_b16 a[254:255], v2 offset:51424
    v_add_f32 v7, v7, v20
    v_mfma_f32_16x16x32_bf16 a[136:139], v[120:123], a[220:223], a[136:139]
    ds_read_b64_tr_b16 a[248:249], v2 offset:34016
    v_mfma_f32_16x16x32_bf16 a[132:135], v[112:115], a[220:223], a[132:135]
    v_exp_f32 v21, v65
    v_mfma_f32_16x16x32_bf16 a[132:135], v[108:111], a[216:219], a[132:135]
    s_add_u32 m0, s23, 4256
    ds_read_b64_tr_b16 a[250:251], v2 offset:34528
    v_add_f32 v7, v7, v21
    v_mfma_f32_16x16x32_bf16 a[144:147], v[108:111], a[224:227], a[144:147]
    buffer_load_dwordx4 v4, s[4:7], s21 offen offset:1024 nt lds
    v_mfma_f32_16x16x32_bf16 a[144:147], v[112:115], a[228:231], a[144:147]
    ds_read_b64_tr_b16 a[192:193], v2 offset:34048
    v_cvt_pk_bf16_f32 v96, v20, v21
    v_mfma_f32_16x16x32_bf16 a[148:151], v[120:123], a[228:231], a[148:151]
    v_exp_f32 v22, v66
    v_mfma_f32_16x16x32_bf16 a[148:151], v[116:119], a[224:227], a[148:151]
    ds_read_b64_tr_b16 a[194:195], v2 offset:34560
    v_add_f32 v7, v7, v22
    v_mfma_f32_16x16x32_bf16 a[152:155], v[124:127], a[224:227], a[152:155]
    ds_read_b64_tr_b16 a[196:197], v2 offset:50944
    v_mfma_f32_16x16x32_bf16 a[152:155], v[128:131], a[228:231], a[152:155]
    ds_read_b64_tr_b16 a[198:199], v2 offset:51456
    v_mfma_f32_16x16x32_bf16 v[132:135], v[128:131], a[236:239], v[132:135]
    v_exp_f32 v23, v67
    v_mfma_f32_16x16x32_bf16 v[132:135], v[124:127], a[232:235], v[132:135]
    ds_read_b64_tr_b16 a[204:205], v2 offset:50976
    v_add_f32 v7, v7, v23
    v_mfma_f32_16x16x32_bf16 a[160:163], v[116:119], a[232:235], a[160:163]
    ds_read_b64_tr_b16 a[206:207], v2 offset:51488
    v_cvt_pk_bf16_f32 v97, v22, v23
    v_mfma_f32_16x16x32_bf16 a[160:163], v[120:123], a[236:239], a[160:163]
    s_add_u32 m0, s23, 4288
    v_exp_f32 v16, v68
    v_mfma_f32_16x16x32_bf16 a[156:159], v[112:115], a[236:239], a[156:159]
    buffer_load_dwordx4 v4, s[4:7], s21 offen offset:2048 nt lds
    v_mfma_f32_16x16x32_bf16 a[156:159], v[108:111], a[232:235], a[156:159]
    s_waitcnt lgkmcnt(4)
    ds_read_b64_tr_b16 a[200:201], v2 offset:34080
    v_add_f32 v8, v8, v16
    v_mfma_f32_16x16x32_bf16 v[136:139], v[108:111], a[240:243], v[136:139]
    ds_read_b64_tr_b16 a[202:203], v2 offset:34592
    v_mfma_f32_16x16x32_bf16 v[136:139], v[112:115], a[244:247], v[136:139]
    v_exp_f32 v17, v69
    v_mfma_f32_16x16x32_bf16 v[140:143], v[120:123], a[244:247], v[140:143]
    ds_read_b64_tr_b16 a[208:209], v2 offset:34112
    v_add_f32 v8, v8, v17
    v_mfma_f32_16x16x32_bf16 v[140:143], v[116:119], a[240:243], v[140:143]
    ds_read_b64_tr_b16 a[210:211], v2 offset:34624
    v_cvt_pk_bf16_f32 v104, v16, v17
    v_mfma_f32_16x16x32_bf16 v[144:147], v[124:127], a[240:243], v[144:147]
    ds_read_b64_tr_b16 a[212:213], v2 offset:51008
    v_mfma_f32_16x16x32_bf16 v[144:147], v[128:131], a[244:247], v[144:147]
    v_exp_f32 v18, v70
    v_mfma_f32_16x16x32_bf16 v[156:159], v[128:131], a[252:255], v[156:159]
    ds_read_b64_tr_b16 a[214:215], v2 offset:51520
    v_add_f32 v8, v8, v18
    v_mfma_f32_16x16x32_bf16 v[156:159], v[124:127], a[248:251], v[156:159]
    s_add_u32 m0, s23, 4320
    ds_read_b64_tr_b16 a[220:221], v2 offset:51040
    v_mfma_f32_16x16x32_bf16 v[152:155], v[116:119], a[248:251], v[152:155]
    buffer_load_dwordx4 v4, s[4:7], s21 offen offset:3072 nt lds
    v_mfma_f32_16x16x32_bf16 v[152:155], v[120:123], a[252:255], v[152:155]
    v_exp_f32 v19, v71
    v_mfma_f32_16x16x32_bf16 v[148:151], v[112:115], a[252:255], v[148:151]
    ds_read_b64_tr_b16 a[222:223], v2 offset:51552
    v_add_f32 v8, v8, v19
    v_mfma_f32_16x16x32_bf16 v[148:151], v[108:111], a[248:251], v[148:151]
    ds_read_b64_tr_b16 a[216:217], v2 offset:34144
    v_cvt_pk_bf16_f32 v105, v18, v19
    v_mfma_f32_16x16x32_bf16 v[160:163], v[108:111], a[192:195], v[160:163]
    s_waitcnt lgkmcnt(4)
    v_exp_f32 v20, v80
    v_mfma_f32_16x16x32_bf16 v[160:163], v[112:115], a[196:199], v[160:163]
    ds_read_b64_tr_b16 a[218:219], v2 offset:34656
    v_add_f32 v8, v8, v20
    v_mfma_f32_16x16x32_bf16 v[164:167], v[120:123], a[196:199], v[164:167]
    ds_read_b64_tr_b16 a[224:225], v2 offset:34176
    v_mfma_f32_16x16x32_bf16 v[164:167], v[116:119], a[192:195], v[164:167]
    ds_read_b64_tr_b16 a[226:227], v2 offset:34688
    v_mfma_f32_16x16x32_bf16 v[168:171], v[124:127], a[192:195], v[168:171]
    v_exp_f32 v21, v81
    v_mfma_f32_16x16x32_bf16 v[168:171], v[128:131], a[196:199], v[168:171]
    ds_read_b64_tr_b16 a[228:229], v2 offset:51072
    v_add_f32 v8, v8, v21
    v_mfma_f32_16x16x32_bf16 v[180:183], v[128:131], a[204:207], v[180:183]
    s_add_u32 s21, s21, 32768
    ds_read_b64_tr_b16 a[230:231], v2 offset:51584
    v_cvt_pk_bf16_f32 v106, v20, v21
    v_mfma_f32_16x16x32_bf16 v[180:183], v[124:127], a[200:203], v[180:183]
    v_exp_f32 v22, v82
    v_mfma_f32_16x16x32_bf16 v[176:179], v[116:119], a[200:203], v[176:179]
    ds_read_b64_tr_b16 a[236:237], v2 offset:51104
    v_add_f32 v8, v8, v22
    v_mfma_f32_16x16x32_bf16 v[176:179], v[120:123], a[204:207], v[176:179]
    ds_read_b64_tr_b16 a[238:239], v2 offset:51616
    v_mfma_f32_16x16x32_bf16 v[172:175], v[112:115], a[204:207], v[172:175]
    ds_read_b64_tr_b16 a[232:233], v2 offset:34208
    v_mfma_f32_16x16x32_bf16 v[172:175], v[108:111], a[200:203], v[172:175]
    v_exp_f32 v23, v83
    v_mfma_f32_16x16x32_bf16 v[184:187], v[108:111], a[208:211], v[184:187]
    s_waitcnt lgkmcnt(5)
    ds_read_b64_tr_b16 a[234:235], v2 offset:34720
    v_add_f32 v8, v8, v23
    v_mfma_f32_16x16x32_bf16 v[184:187], v[112:115], a[212:215], v[184:187]
    ds_read_b64_tr_b16 a[240:241], v2 offset:34240
    v_cvt_pk_bf16_f32 v107, v22, v23
    v_mfma_f32_16x16x32_bf16 v[188:191], v[120:123], a[212:215], v[188:191]
    ds_read_b64_tr_b16 a[242:243], v2 offset:34752
    v_mfma_f32_16x16x32_bf16 v[188:191], v[116:119], a[208:211], v[188:191]
    v_exp_f32 v16, v76
    v_mfma_f32_16x16x32_bf16 v[192:195], v[124:127], a[208:211], v[192:195]
    s_sub_u32 s25, s25, 1
    ds_read_b64_tr_b16 a[244:245], v2 offset:51136
    v_add_f32 v7, v7, v16
    v_mfma_f32_16x16x32_bf16 v[192:195], v[128:131], a[212:215], v[192:195]
    ds_read_b64_tr_b16 a[246:247], v2 offset:51648
    v_mfma_f32_16x16x32_bf16 v[204:207], v[128:131], a[220:223], v[204:207]
    v_exp_f32 v17, v77
    v_mfma_f32_16x16x32_bf16 v[204:207], v[124:127], a[216:219], v[204:207]
    ds_read_b64_tr_b16 a[252:253], v2 offset:51168
    v_add_f32 v7, v7, v17
    v_mfma_f32_16x16x32_bf16 v[200:203], v[116:119], a[216:219], v[200:203]
    ds_read_b64_tr_b16 a[254:255], v2 offset:51680
    v_cvt_pk_bf16_f32 v98, v16, v17
    v_mfma_f32_16x16x32_bf16 v[200:203], v[120:123], a[220:223], v[200:203]
    s_sub_u32 s76, s76, 1024
    s_cselect_b32 s76, 0x18000, s76
    ds_read_b64_tr_b16 a[248:249], v2 offset:34272
    v_mfma_f32_16x16x32_bf16 v[196:199], v[112:115], a[220:223], v[196:199]
    v_exp_f32 v18, v78
    v_mfma_f32_16x16x32_bf16 v[196:199], v[108:111], a[216:219], v[196:199]
    ds_read_b64_tr_b16 a[250:251], v2 offset:34784
    v_add_f32 v7, v7, v18
    v_mfma_f32_16x16x32_bf16 v[208:211], v[108:111], a[224:227], v[208:211]
    s_waitcnt lgkmcnt(5)
    v_mfma_f32_16x16x32_bf16 v[208:211], v[112:115], a[228:231], v[208:211]
    v_mfma_f32_16x16x32_bf16 v[212:215], v[120:123], a[228:231], v[212:215]
    v_exp_f32 v19, v79
    v_mfma_f32_16x16x32_bf16 v[212:215], v[116:119], a[224:227], v[212:215]
    v_add_f32 v7, v7, v19
    v_cvt_pk_bf16_f32 v99, v18, v19
    v_mfma_f32_16x16x32_bf16 v[216:219], v[124:127], a[224:227], v[216:219]
    v_mfma_f32_16x16x32_bf16 v[216:219], v[128:131], a[228:231], v[216:219]
    v_exp_f32 v20, v72
    v_mfma_f32_16x16x32_bf16 v[228:231], v[128:131], a[236:239], v[228:231]
    v_add_f32 v6, v6, v20
    v_mfma_f32_16x16x32_bf16 v[228:231], v[124:127], a[232:235], v[228:231]
    v_mfma_f32_16x16x32_bf16 v[224:227], v[116:119], a[232:235], v[224:227]
    v_mfma_f32_16x16x32_bf16 v[224:227], v[120:123], a[236:239], v[224:227]
    s_waitcnt vmcnt(17) lgkmcnt(0)
    s_barrier
    v_mfma_f32_16x16x32_bf16 v[220:223], v[112:115], a[236:239], v[220:223]
    v_exp_f32 v21, v73
    v_mfma_f32_16x16x32_bf16 v[220:223], v[108:111], a[232:235], v[220:223]
    ds_read_b128 a[192:195], v1 offset:33792
    v_add_f32 v6, v6, v21
    v_mfma_f32_16x16x32_bf16 v[232:235], v[108:111], a[240:243], v[232:235]
    ds_read_b128 a[196:199], v1 offset:33856
    v_cvt_pk_bf16_f32 v90, v20, v21
    v_mfma_f32_16x16x32_bf16 v[232:235], v[112:115], a[244:247], v[232:235]
    v_exp_f32 v22, v74
    v_mfma_f32_16x16x32_bf16 v[236:239], v[120:123], a[244:247], v[236:239]
    ds_read_b128 a[200:203], v1 offset:33920
    v_add_f32 v6, v6, v22
    v_mfma_f32_16x16x32_bf16 v[236:239], v[116:119], a[240:243], v[236:239]
    ds_read_b128 a[204:207], v1 offset:33984
    v_mfma_f32_16x16x32_bf16 v[240:243], v[124:127], a[240:243], v[240:243]
    v_exp_f32 v23, v75
    v_mfma_f32_16x16x32_bf16 v[240:243], v[128:131], a[244:247], v[240:243]
    ds_read_b128 a[208:211], v1 offset:34048
    v_add_f32 v6, v6, v23
    v_mfma_f32_16x16x32_bf16 v[252:255], v[128:131], a[252:255], v[252:255]
    ds_read_b128 a[212:215], v1 offset:34112
    v_cvt_pk_bf16_f32 v91, v22, v23
    v_mfma_f32_16x16x32_bf16 v[252:255], v[124:127], a[248:251], v[252:255]
    ds_read_b128 a[216:219], v1 offset:34176
    v_max3_f32 v5, v6, v7, v8
    v_mfma_f32_16x16x32_bf16 v[248:251], v[116:119], a[248:251], v[248:251]
    ds_read_b128 a[220:223], v1 offset:34240
    v_cmp_nge_f32 vcc, s26, v5
    v_mfma_f32_16x16x32_bf16 v[248:251], v[120:123], a[252:255], v[248:251]
    v_mfma_f32_16x16x32_bf16 v[244:247], v[112:115], a[252:255], v[244:247]
    s_cmp_eq_u32 s25, 0
    v_mfma_f32_16x16x32_bf16 v[244:247], v[108:111], a[248:251], v[244:247]
    s_cbranch_vccnz L_rare1_1
L_j1_1:
    s_cbranch_scc0 L_loop1
L_tail:
    s_waitcnt lgkmcnt(4)
    v_mfma_f32_16x16x32_bf16 v[36:39], a[192:195], a[0:3], v[24:27]
    s_add_u32 m0, s24, 33792
    ds_read_b128 a[252:255], v1 offset:34752
    v_add_f32 v9, v9, v6
    v_mfma_f32_16x16x32_bf16 v[36:39], a[196:199], a[4:7], v[36:39]
    buffer_load_dwordx4 v3, s[8:11], s22 offen offset:0 nt lds
    v_mfma_f32_16x16x32_bf16 v[36:39], a[200:203], a[8:11], v[36:39]
    ds_read_b128 a[248:251], v1 offset:34688
    v_add_f32 v10, v10, v7
    v_mfma_f32_16x16x32_bf16 v[36:39], a[204:207], a[12:15], v[36:39]
    s_waitcnt lgkmcnt(3)
    ds_read_b128 a[244:247], v1 offset:34624
    v_add_f32 v11, v11, v8
    v_mfma_f32_16x16x32_bf16 v[36:39], a[208:211], a[16:19], v[36:39]
    ds_read_b128 a[240:243], v1 offset:34560
    v_mfma_f32_16x16x32_bf16 v[36:39], a[212:215], a[20:23], v[36:39]
    s_add_u32 m0, s24, 33824
    ds_read_b128 a[236:239], v1 offset:34496
    v_mfma_f32_16x16x32_bf16 v[36:39], a[216:219], a[24:27], v[36:39]
    s_waitcnt lgkmcnt(5)
    buffer_load_dwordx4 v3, s[8:11], s22 offen offset:1024 nt lds
    v_mfma_f32_16x16x32_bf16 v[36:39], a[220:223], a[28:31], v[36:39]
    ds_read_b128 a[232:235], v1 offset:34432
    v_mfma_f32_16x16x32_bf16 v[40:43], a[220:223], a[60:63], v[28:31]
    ds_read_b128 a[228:231], v1 offset:34368
    v_mfma_f32_16x16x32_bf16 v[40:43], a[216:219], a[56:59], v[40:43]
    ds_read_b128 a[224:227], v1 offset:34304
    v_mfma_f32_16x16x32_bf16 v[40:43], a[212:215], a[52:55], v[40:43]
    s_add_u32 m0, s24, 33856
    v_mfma_f32_16x16x32_bf16 v[40:43], a[208:211], a[48:51], v[40:43]
    buffer_load_dwordx4 v3, s[8:11], s22 offen offset:2048 nt lds
    v_mfma_f32_16x16x32_bf16 v[40:43], a[204:207], a[44:47], v[40:43]
    v_mfma_f32_16x16x32_bf16 v[40:43], a[200:203], a[40:43], v[40:43]
    v_exp_f32 v16, v36
    v_mfma_f32_16x16x32_bf16 v[40:43], a[196:199], a[36:39], v[40:43]
    v_exp_f32 v17, v37
    v_mfma_f32_16x16x32_bf16 v[40:43], a[192:195], a[32:35], v[40:43]
    s_add_u32 m0, s24, 33888
    v_exp_f32 v18, v38
    v_mfma_f32_16x16x32_bf16 v[44:47], a[192:195], a[64:67], v[32:35]
    buffer_load_dwordx4 v3, s[8:11], s22 offen offset:3072 nt lds
    v_mfma_f32_16x16x32_bf16 v[44:47], a[196:199], a[68:71], v[44:47]
    ds_read_b128 a[192:195], v1 offset:50688
    v_add_f32 v6, v16, v17
    v_mfma_f32_16x16x32_bf16 v[44:47], a[200:203], a[72:75], v[44:47]
    ds_read_b128 a[196:199], v1 offset:50752
    v_cvt_pk_bf16_f32 v108, v16, v17
    v_mfma_f32_16x16x32_bf16 v[44:47], a[204:207], a[76:79], v[44:47]
    v_exp_f32 v19, v39
    v_mfma_f32_16x16x32_bf16 v[44:47], a[208:211], a[80:83], v[44:47]
    s_add_u32 m0, s24, 38016
    ds_read_b128 a[200:203], v1 offset:50816
    v_add_f32 v6, v6, v18
    v_mfma_f32_16x16x32_bf16 v[44:47], a[212:215], a[84:87], v[44:47]
    buffer_load_dwordx4 v4, s[8:11], s22 offen offset:0 nt lds
    v_mfma_f32_16x16x32_bf16 v[44:47], a[216:219], a[88:91], v[44:47]
    ds_read_b128 a[204:207], v1 offset:50880
    v_add_f32 v6, v6, v19
    v_mfma_f32_16x16x32_bf16 v[44:47], a[220:223], a[92:95], v[44:47]
    s_waitcnt lgkmcnt(4)
    v_exp_f32 v20, v40
    v_mfma_f32_16x16x32_bf16 v[56:59], a[252:255], a[92:95], v[32:35]
    v_exp_f32 v21, v41
    v_mfma_f32_16x16x32_bf16 v[56:59], a[248:251], a[88:91], v[56:59]
    s_add_u32 m0, s24, 38048
    ds_read_b128 a[208:211], v1 offset:50944
    v_cvt_pk_bf16_f32 v109, v18, v19
    v_mfma_f32_16x16x32_bf16 v[56:59], a[244:247], a[84:87], v[56:59]
    buffer_load_dwordx4 v4, s[8:11], s22 offen offset:1024 nt lds
    v_mfma_f32_16x16x32_bf16 v[56:59], a[240:243], a[80:83], v[56:59]
    ds_read_b128 a[212:215], v1 offset:51008
    v_add_f32 v7, v20, v21
    v_mfma_f32_16x16x32_bf16 v[56:59], a[236:239], a[76:79], v[56:59]
    v_exp_f32 v22, v42
    v_mfma_f32_16x16x32_bf16 v[56:59], a[232:235], a[72:75], v[56:59]
    ds_read_b128 a[216:219], v1 offset:51072
    v_cvt_pk_bf16_f32 v116, v20, v21
    v_mfma_f32_16x16x32_bf16 v[56:59], a[228:231], a[68:71], v[56:59]
    s_add_u32 m0, s24, 38080
    v_exp_f32 v23, v43
    v_mfma_f32_16x16x32_bf16 v[56:59], a[224:227], a[64:67], v[56:59]
    buffer_load_dwordx4 v4, s[8:11], s22 offen offset:2048 nt lds
    v_mfma_f32_16x16x32_bf16 v[52:55], a[224:227], a[32:35], v[28:31]
    ds_read_b128 a[220:223], v1 offset:51136
    v_add_f32 v7, v7, v22
    v_mfma_f32_16x16x32_bf16 v[52:55], a[228:231], a[36:39], v[52:55]
    v_exp_f32 v16, v44
    v_mfma_f32_16x16x32_bf16 v[52:55], a[232:235], a[40:43], v[52:55]
    v_exp_f32 v17, v45
    v_mfma_f32_16x16x32_bf16 v[52:55], a[236:239], a[44:47], v[52:55]
    s_add_u32 m0, s24, 38112
    v_add_f32 v7, v7, v23
    v_cvt_pk_bf16_f32 v117, v22, v23
    v_mfma_f32_16x16x32_bf16 v[52:55], a[240:243], a[48:51], v[52:55]
    buffer_load_dwordx4 v4, s[8:11], s22 offen offset:3072 nt lds
    v_mfma_f32_16x16x32_bf16 v[52:55], a[244:247], a[52:55], v[52:55]
    v_exp_f32 v18, v46
    v_mfma_f32_16x16x32_bf16 v[52:55], a[248:251], a[56:59], v[52:55]
    v_exp_f32 v19, v47
    v_mfma_f32_16x16x32_bf16 v[52:55], a[252:255], a[60:63], v[52:55]
    v_add_f32 v8, v16, v17
    v_cvt_pk_bf16_f32 v124, v16, v17
    v_mfma_f32_16x16x32_bf16 v[48:51], a[252:255], a[28:31], v[24:27]
    ds_read_b128 a[252:255], v1 offset:51648
    v_add_f32 v8, v8, v18
    v_mfma_f32_16x16x32_bf16 v[48:51], a[248:251], a[24:27], v[48:51]
    ds_read_b128 a[248:251], v1 offset:51584
    v_add_f32 v8, v8, v19
    v_mfma_f32_16x16x32_bf16 v[48:51], a[244:247], a[20:23], v[48:51]
    v_exp_f32 v20, v56
    v_mfma_f32_16x16x32_bf16 v[48:51], a[240:243], a[16:19], v[48:51]
    ds_read_b128 a[244:247], v1 offset:51520
    v_cvt_pk_bf16_f32 v125, v18, v19
    v_mfma_f32_16x16x32_bf16 v[48:51], a[236:239], a[12:15], v[48:51]
    v_exp_f32 v21, v57
    v_mfma_f32_16x16x32_bf16 v[48:51], a[232:235], a[8:11], v[48:51]
    ds_read_b128 a[240:243], v1 offset:51456
    v_add_f32 v8, v8, v20
    v_mfma_f32_16x16x32_bf16 v[48:51], a[228:231], a[4:7], v[48:51]
    ds_read_b128 a[236:239], v1 offset:51392
    v_add_f32 v8, v8, v21
    v_mfma_f32_16x16x32_bf16 v[48:51], a[224:227], a[0:3], v[48:51]
    s_waitcnt lgkmcnt(5)
    v_exp_f32 v22, v58
    v_mfma_f32_16x16x32_bf16 v[60:63], a[192:195], a[0:3], v[24:27]
    ds_read_b128 a[232:235], v1 offset:51328
    v_cvt_pk_bf16_f32 v126, v20, v21
    v_mfma_f32_16x16x32_bf16 v[60:63], a[196:199], a[4:7], v[60:63]
    v_exp_f32 v23, v59
    v_mfma_f32_16x16x32_bf16 v[60:63], a[200:203], a[8:11], v[60:63]
    ds_read_b128 a[228:231], v1 offset:51264
    v_add_f32 v8, v8, v22
    v_mfma_f32_16x16x32_bf16 v[60:63], a[204:207], a[12:15], v[60:63]
    ds_read_b128 a[224:227], v1 offset:51200
    v_add_f32 v8, v8, v23
    v_mfma_f32_16x16x32_bf16 v[60:63], a[208:211], a[16:19], v[60:63]
    v_exp_f32 v16, v52
    v_mfma_f32_16x16x32_bf16 v[60:63], a[212:215], a[20:23], v[60:63]
    v_exp_f32 v17, v53
    v_mfma_f32_16x16x32_bf16 v[60:63], a[216:219], a[24:27], v[60:63]
    v_cvt_pk_bf16_f32 v127, v22, v23
    v_add_f32 v7, v7, v16
    v_mfma_f32_16x16x32_bf16 v[60:63], a[220:223], a[28:31], v[60:63]
    v_exp_f32 v18, v54
    v_mfma_f32_16x16x32_bf16 v[64:67], a[220:223], a[60:63], v[28:31]
    v_exp_f32 v19, v55
    v_mfma_f32_16x16x32_bf16 v[64:67], a[216:219], a[56:59], v[64:67]
    v_add_f32 v7, v7, v17
    v_cvt_pk_bf16_f32 v118, v16, v17
    v_mfma_f32_16x16x32_bf16 v[64:67], a[212:215], a[52:55], v[64:67]
    v_exp_f32 v20, v48
    v_mfma_f32_16x16x32_bf16 v[64:67], a[208:211], a[48:51], v[64:67]
    v_add_f32 v7, v7, v18
    v_add_f32 v7, v7, v19
    v_mfma_f32_16x16x32_bf16 v[64:67], a[204:207], a[44:47], v[64:67]
    v_exp_f32 v21, v49
    v_mfma_f32_16x16x32_bf16 v[64:67], a[200:203], a[40:43], v[64:67]
    v_cvt_pk_bf16_f32 v119, v18, v19
    v_add_f32 v6, v6, v20
    v_mfma_f32_16x16x32_bf16 v[64:67], a[196:199], a[36:39], v[64:67]
    v_exp_f32 v22, v50
    v_mfma_f32_16x16x32_bf16 v[64:67], a[192:195], a[32:35], v[64:67]
    v_exp_f32 v23, v51
    v_mfma_f32_16x16x32_bf16 v[68:71], a[192:195], a[64:67], v[32:35]
    v_add_f32 v6, v6, v21
    v_cvt_pk_bf16_f32 v110, v20, v21
    v_mfma_f32_16x16x32_bf16 v[68:71], a[196:199], a[68:71], v[68:71]
    v_exp_f32 v16, v60
    v_mfma_f32_16x16x32_bf16 v[68:71], a[200:203], a[72:75], v[68:71]
    v_add_f32 v6, v6, v22
    v_add_f32 v6, v6, v23
    v_mfma_f32_16x16x32_bf16 v[68:71], a[204:207], a[76:79], v[68:71]
    v_exp_f32 v17, v61
    v_mfma_f32_16x16x32_bf16 v[68:71], a[208:211], a[80:83], v[68:71]
    v_cvt_pk_bf16_f32 v111, v22, v23
    v_add_f32 v6, v6, v16
    v_mfma_f32_16x16x32_bf16 v[68:71], a[212:215], a[84:87], v[68:71]
    v_exp_f32 v18, v62
    v_mfma_f32_16x16x32_bf16 v[68:71], a[216:219], a[88:91], v[68:71]
    v_exp_f32 v19, v63
    v_mfma_f32_16x16x32_bf16 v[68:71], a[220:223], a[92:95], v[68:71]
    s_waitcnt lgkmcnt(0)
    v_add_f32 v6, v6, v17
    v_cvt_pk_bf16_f32 v112, v16, v17
    v_mfma_f32_16x16x32_bf16 v[80:83], a[252:255], a[92:95], v[32:35]
    v_exp_f32 v20, v64
    v_mfma_f32_16x16x32_bf16 v[80:83], a[248:251], a[88:91], v[80:83]
    v_add_f32 v6, v6, v18
    v_add_f32 v6, v6, v19
    v_mfma_f32_16x16x32_bf16 v[80:83], a[244:247], a[84:87], v[80:83]
    v_exp_f32 v21, v65
    v_mfma_f32_16x16x32_bf16 v[80:83], a[240:243], a[80:83], v[80:83]
    v_cvt_pk_bf16_f32 v113, v18, v19
    v_add_f32 v7, v7, v20
    v_mfma_f32_16x16x32_bf16 v[80:83], a[236:239], a[76:79], v[80:83]
    v_exp_f32 v22, v66
    v_mfma_f32_16x16x32_bf16 v[80:83], a[232:235], a[72:75], v[80:83]
    v_exp_f32 v23, v67
    v_mfma_f32_16x16x32_bf16 v[80:83], a[228:231], a[68:71], v[80:83]
    v_add_f32 v7, v7, v21
    v_cvt_pk_bf16_f32 v120, v20, v21
    v_mfma_f32_16x16x32_bf16 v[80:83], a[224:227], a[64:67], v[80:83]
    v_exp_f32 v16, v68
    v_mfma_f32_16x16x32_bf16 v[76:79], a[224:227], a[32:35], v[28:31]
    v_add_f32 v7, v7, v22
    v_add_f32 v7, v7, v23
    v_mfma_f32_16x16x32_bf16 v[76:79], a[228:231], a[36:39], v[76:79]
    v_exp_f32 v17, v69
    v_mfma_f32_16x16x32_bf16 v[76:79], a[232:235], a[40:43], v[76:79]
    v_cvt_pk_bf16_f32 v121, v22, v23
    v_add_f32 v8, v8, v16
    v_mfma_f32_16x16x32_bf16 v[76:79], a[236:239], a[44:47], v[76:79]
    v_exp_f32 v18, v70
    v_mfma_f32_16x16x32_bf16 v[76:79], a[240:243], a[48:51], v[76:79]
    v_exp_f32 v19, v71
    v_mfma_f32_16x16x32_bf16 v[76:79], a[244:247], a[52:55], v[76:79]
    v_add_f32 v8, v8, v17
    v_cvt_pk_bf16_f32 v128, v16, v17
    v_mfma_f32_16x16x32_bf16 v[76:79], a[248:251], a[56:59], v[76:79]
    v_exp_f32 v20, v80
    v_mfma_f32_16x16x32_bf16 v[76:79], a[252:255], a[60:63], v[76:79]
    v_add_f32 v8, v8, v18
    v_add_f32 v8, v8, v19
    v_mfma_f32_16x16x32_bf16 v[72:75], a[252:255], a[28:31], v[24:27]
    v_exp_f32 v21, v81
    v_mfma_f32_16x16x32_bf16 v[72:75], a[248:251], a[24:27], v[72:75]
    v_cvt_pk_bf16_f32 v129, v18, v19
    v_add_f32 v8, v8, v20
    v_mfma_f32_16x16x32_bf16 v[72:75], a[244:247], a[20:23], v[72:75]
    v_exp_f32 v22, v82
    v_mfma_f32_16x16x32_bf16 v[72:75], a[240:243], a[16:19], v[72:75]
    v_exp_f32 v23, v83
    v_mfma_f32_16x16x32_bf16 v[72:75], a[236:239], a[12:15], v[72:75]
    v_add_f32 v8, v8, v21
    v_cvt_pk_bf16_f32 v130, v20, v21
    v_mfma_f32_16x16x32_bf16 v[72:75], a[232:235], a[8:11], v[72:75]
    v_exp_f32 v16, v76
    v_mfma_f32_16x16x32_bf16 v[72:75], a[228:231], a[4:7], v[72:75]
    v_add_f32 v8, v8, v22
    v_add_f32 v8, v8, v23
    v_mfma_f32_16x16x32_bf16 v[72:75], a[224:227], a[0:3], v[72:75]
    v_exp_f32 v17, v77
    s_waitcnt vmcnt(0)
    s_barrier
    ds_read_b64_tr_b16 a[192:193], v2 offset:384
    ds_read_b64_tr_b16 a[194:195], v2 offset:896
    ds_read_b64_tr_b16 a[196:197], v2 offset:17280
    ds_read_b64_tr_b16 a[198:199], v2 offset:17792
    ds_read_b64_tr_b16 a[200:201], v2 offset:34176
    ds_read_b64_tr_b16 a[202:203], v2 offset:34688
    ds_read_b64_tr_b16 a[204:205], v2 offset:51072
    ds_read_b64_tr_b16 a[206:207], v2 offset:51584
    ds_read_b64_tr_b16 a[220:221], v2 offset:51104
    ds_read_b64_tr_b16 a[222:223], v2 offset:51616
    ds_read_b64_tr_b16 a[216:217], v2 offset:34208
    ds_read_b64_tr_b16 a[218:219], v2 offset:34720
    ds_read_b64_tr_b16 a[212:213], v2 offset:17312
    ds_read_b64_tr_b16 a[214:215], v2 offset:17824
    v_exp_f32 v18, v78
    v_cvt_pk_bf16_f32 v131, v22, v23
    v_add_f32 v7, v7, v16
    v_exp_f32 v19, v79
    v_add_f32 v7, v7, v17
    v_cvt_pk_bf16_f32 v122, v16, v17
    v_exp_f32 v20, v72
    v_add_f32 v7, v7, v18
    v_add_f32 v7, v7, v19
    v_exp_f32 v21, v73
    v_cvt_pk_bf16_f32 v123, v18, v19
    v_add_f32 v6, v6, v20
    v_exp_f32 v22, v74
    v_add_f32 v6, v6, v21
    v_cvt_pk_bf16_f32 v114, v20, v21
    v_exp_f32 v23, v75
    v_add_f32 v6, v6, v22
    v_add_f32 v6, v6, v23
    v_cvt_pk_bf16_f32 v115, v22, v23
    v_max3_f32 v5, v6, v7, v8
    v_cmp_nge_f32 vcc, s26, v5
    s_cbranch_vccnz L_rareA
L_jA:
    s_waitcnt lgkmcnt(0)
    v_mfma_f32_16x16x32_bf16 v[208:211], v[84:87], a[192:195], v[208:211]
    ds_read_b64_tr_b16 a[208:209], v2 offset:416
    ds_read_b64_tr_b16 a[210:211], v2 offset:928
    v_add_f32 v9, v9, v6
    v_add_f32 v10, v10, v7
    v_mfma_f32_16x16x32_bf16 v[208:211], v[88:91], a[196:199], v[208:211]
    ds_read_b64_tr_b16 a[224:225], v2 offset:448
    ds_read_b64_tr_b16 a[226:227], v2 offset:960
    v_add_f32 v11, v11, v8
    v_mov_b32 v12, v9
    v_mfma_f32_16x16x32_bf16 v[208:211], v[108:111], a[200:203], v[208:211]
    ds_read_b64_tr_b16 a[228:229], v2 offset:17344
    ds_read_b64_tr_b16 a[230:231], v2 offset:17856
    v_mov_b32 v13, v10
    v_mov_b32 v14, v11
    v_mfma_f32_16x16x32_bf16 v[208:211], v[112:115], a[204:207], v[208:211]
    ds_read_b64_tr_b16 a[232:233], v2 offset:34240
    ds_read_b64_tr_b16 a[234:235], v2 offset:34752
    v_permlane16_swap_b32 v12, v9
    v_permlane16_swap_b32 v13, v10
    v_mfma_f32_16x16x32_bf16 v[220:223], v[112:115], a[220:223], v[220:223]
    ds_read_b64_tr_b16 a[236:237], v2 offset:51136
    ds_read_b64_tr_b16 a[238:239], v2 offset:51648
    v_permlane16_swap_b32 v14, v11
    v_add_f32 v9, v12, v9
    v_mfma_f32_16x16x32_bf16 v[220:223], v[108:111], a[216:219], v[220:223]
    ds_read_b64_tr_b16 a[252:253], v2 offset:51168
    ds_read_b64_tr_b16 a[254:255], v2 offset:51680
    v_add_f32 v10, v13, v10
    v_add_f32 v11, v14, v11
    v_mfma_f32_16x16x32_bf16 v[220:223], v[88:91], a[212:215], v[220:223]
    s_waitcnt lgkmcnt(10)
    ds_read_b64_tr_b16 a[248:249], v2 offset:34272
    ds_read_b64_tr_b16 a[250:251], v2 offset:34784
    v_mov_b32 v12, v9
    v_mov_b32 v13, v10
    v_mfma_f32_16x16x32_bf16 v[220:223], v[84:87], a[208:211], v[220:223]
    s_waitcnt lgkmcnt(10)
    ds_read_b64_tr_b16 a[244:245], v2 offset:17376
    ds_read_b64_tr_b16 a[246:247], v2 offset:17888
    v_mov_b32 v14, v11
    v_permlane32_swap_b32 v12, v9
    v_mfma_f32_16x16x32_bf16 v[232:235], v[84:87], a[224:227], v[232:235]
    s_waitcnt lgkmcnt(10)
    ds_read_b64_tr_b16 a[240:241], v2 offset:480
    ds_read_b64_tr_b16 a[242:243], v2 offset:992
    v_permlane32_swap_b32 v13, v10
    v_permlane32_swap_b32 v14, v11
    v_mfma_f32_16x16x32_bf16 v[232:235], v[88:91], a[228:231], v[232:235]
    s_waitcnt lgkmcnt(10)
    ds_read_b64_tr_b16 a[0:1], v2 offset:256
    v_add_f32 v9, v12, v9
    v_add_f32 v10, v13, v10
    v_add_f32 v11, v14, v11
    v_mfma_f32_16x16x32_bf16 v[232:235], v[108:111], a[232:235], v[232:235]
    s_waitcnt lgkmcnt(9)
    ds_read_b64_tr_b16 a[2:3], v2 offset:768
    v_rcp_f32 v9, v9
    v_rcp_f32 v10, v10
    v_mfma_f32_16x16x32_bf16 v[232:235], v[112:115], a[236:239], v[232:235]
    s_waitcnt lgkmcnt(8)
    ds_read_b64_tr_b16 a[4:5], v2 offset:17152
    v_rcp_f32 v11, v11
    v_mfma_f32_16x16x32_bf16 v[244:247], v[112:115], a[252:255], v[244:247]
    s_waitcnt lgkmcnt(7)
    ds_read_b64_tr_b16 a[6:7], v2 offset:17664
    v_and_b32 v6, 48, v0
    v_accvgpr_read_b32 v1, a164
    v_accvgpr_read_b32 v5, a165
    v_mfma_f32_16x16x32_bf16 v[244:247], v[108:111], a[248:251], v[244:247]
    s_waitcnt lgkmcnt(6)
    ds_bpermute_b32 v24, v6, v9 offset:0
    v_accvgpr_read_b32 v3, a166
    v_accvgpr_read_b32 v4, a167
    v_mfma_f32_16x16x32_bf16 v[244:247], v[88:91], a[244:247], v[244:247]
    s_waitcnt lgkmcnt(5)
    ds_bpermute_b32 v25, v6, v9 offset:4
    v_accvgpr_read_b32 v76, a172
    v_accvgpr_read_b32 v77, a173
    v_mfma_f32_16x16x32_bf16 v[244:247], v[84:87], a[240:243], v[244:247]
    ds_bpermute_b32 v26, v6, v9 offset:8
    v_accvgpr_read_b32 v78, a174
    v_accvgpr_read_b32 v79, a175
    v_mfma_f32_16x16x32_bf16 v[212:215], v[92:95], a[192:195], v[212:215]
    ds_bpermute_b32 v27, v6, v9 offset:12
    v_mfma_f32_16x16x32_bf16 v[212:215], v[96:99], a[196:199], v[212:215]
    ds_bpermute_b32 v28, v6, v10 offset:0
    v_mfma_f32_16x16x32_bf16 v[212:215], v[116:119], a[200:203], v[212:215]
    ds_bpermute_b32 v29, v6, v10 offset:4
    v_mfma_f32_16x16x32_bf16 v[212:215], v[120:123], a[204:207], v[212:215]
    s_waitcnt lgkmcnt(5)
    ds_bpermute_b32 v30, v6, v10 offset:8
    v_mul_f32_e64 v76, -v76, v24
    v_mfma_f32_16x16x32_bf16 v[224:227], v[120:123], a[220:223], v[224:227]
    s_waitcnt lgkmcnt(5)
    ds_bpermute_b32 v31, v6, v10 offset:12
    v_mul_f32_e64 v77, -v77, v25
    v_mfma_f32_16x16x32_bf16 v[224:227], v[116:119], a[216:219], v[224:227]
    s_waitcnt lgkmcnt(5)
    ds_bpermute_b32 v32, v6, v11 offset:0
    v_mul_f32_e64 v78, -v78, v26
    v_mfma_f32_16x16x32_bf16 v[224:227], v[96:99], a[212:215], v[224:227]
    s_waitcnt lgkmcnt(5)
    ds_bpermute_b32 v33, v6, v11 offset:4
    v_mul_f32_e64 v79, -v79, v27
    v_mfma_f32_16x16x32_bf16 v[224:227], v[92:95], a[208:211], v[224:227]
    ds_bpermute_b32 v34, v6, v11 offset:8
    ds_bpermute_b32 v35, v6, v11 offset:12
    ds_read_b64_tr_b16 a[8:9], v2 offset:34048
    v_pk_fma_f32 v[208:209], v[208:209], v[24:25], v[76:77]
    v_pk_fma_f32 v[210:211], v[210:211], v[26:27], v[78:79]
    v_pk_fma_f32 v[220:221], v[220:221], v[24:25], v[76:77]
    v_pk_fma_f32 v[222:223], v[222:223], v[26:27], v[78:79]
    v_pk_fma_f32 v[232:233], v[232:233], v[24:25], v[76:77]
    v_pk_fma_f32 v[234:235], v[234:235], v[26:27], v[78:79]
    v_pk_fma_f32 v[244:245], v[244:245], v[24:25], v[76:77]
    v_pk_fma_f32 v[246:247], v[246:247], v[26:27], v[78:79]
    v_mfma_f32_16x16x32_bf16 v[236:239], v[92:95], a[224:227], v[236:239]
    ds_read_b64_tr_b16 a[10:11], v2 offset:34560
    v_cvt_pk_bf16_f32 v16, v208, v220
    v_mfma_f32_16x16x32_bf16 v[236:239], v[96:99], a[228:231], v[236:239]
    ds_read_b64_tr_b16 a[12:13], v2 offset:50944
    v_cvt_pk_bf16_f32 v18, v209, v221
    v_mfma_f32_16x16x32_bf16 v[236:239], v[116:119], a[232:235], v[236:239]
    ds_read_b64_tr_b16 a[14:15], v2 offset:51456
    v_cvt_pk_bf16_f32 v20, v210, v222
    v_mfma_f32_16x16x32_bf16 v[236:239], v[120:123], a[236:239], v[236:239]
    ds_read_b64_tr_b16 a[28:29], v2 offset:50976
    v_cvt_pk_bf16_f32 v22, v211, v223
    v_mfma_f32_16x16x32_bf16 v[248:251], v[120:123], a[252:255], v[248:251]
    ds_read_b64_tr_b16 a[30:31], v2 offset:51488
    v_cvt_pk_bf16_f32 v17, v232, v244
    v_cvt_pk_bf16_f32 v19, v233, v245
    v_cvt_pk_bf16_f32 v21, v234, v246
    v_mfma_f32_16x16x32_bf16 v[248:251], v[116:119], a[248:251], v[248:251]
    ds_write_b64 v1, v[16:17] offset:0
    v_cvt_pk_bf16_f32 v23, v235, v247
    v_mfma_f32_16x16x32_bf16 v[248:251], v[96:99], a[244:247], v[248:251]
    s_waitcnt lgkmcnt(5)
    ds_read_b64_tr_b16 a[24:25], v2 offset:34080
    v_accvgpr_read_b32 v80, a176
    v_accvgpr_read_b32 v81, a177
    v_accvgpr_read_b32 v82, a178
    v_mfma_f32_16x16x32_bf16 v[248:251], v[92:95], a[240:243], v[248:251]
    ds_write_b64 v1, v[18:19] offset:128
    v_accvgpr_read_b32 v83, a179
    v_mfma_f32_16x16x32_bf16 v[216:219], v[100:103], a[192:195], v[216:219]
    ds_read_b64_tr_b16 a[26:27], v2 offset:34592
    v_mul_f32_e64 v80, -v80, v28
    v_mul_f32_e64 v81, -v81, v29
    v_mul_f32_e64 v82, -v82, v30
    v_mfma_f32_16x16x32_bf16 v[216:219], v[104:107], a[196:199], v[216:219]
    ds_write_b64 v1, v[20:21] offset:288
    v_mul_f32_e64 v83, -v83, v31
    v_mfma_f32_16x16x32_bf16 v[216:219], v[124:127], a[200:203], v[216:219]
    ds_read_b64_tr_b16 a[20:21], v2 offset:17184
    v_mfma_f32_16x16x32_bf16 v[216:219], v[128:131], a[204:207], v[216:219]
    ds_write_b64 v1, v[22:23] offset:416
    ds_read_b64_tr_b16 v[208:209], v5 offset:0
    ds_read_b64_tr_b16 v[210:211], v5 offset:32
    v_pk_fma_f32 v[212:213], v[212:213], v[28:29], v[80:81]
    v_pk_fma_f32 v[214:215], v[214:215], v[30:31], v[82:83]
    v_pk_fma_f32 v[224:225], v[224:225], v[28:29], v[80:81]
    v_pk_fma_f32 v[226:227], v[226:227], v[30:31], v[82:83]
    v_pk_fma_f32 v[236:237], v[236:237], v[28:29], v[80:81]
    v_pk_fma_f32 v[238:239], v[238:239], v[30:31], v[82:83]
    v_pk_fma_f32 v[248:249], v[248:249], v[28:29], v[80:81]
    v_pk_fma_f32 v[250:251], v[250:251], v[30:31], v[82:83]
    v_mfma_f32_16x16x32_bf16 v[228:231], v[128:131], a[220:223], v[228:231]
    ds_read_b64_tr_b16 a[22:23], v2 offset:17696
    v_cvt_pk_bf16_f32 v68, v212, v224
    v_mfma_f32_16x16x32_bf16 v[228:231], v[124:127], a[216:219], v[228:231]
    ds_read_b64_tr_b16 a[16:17], v2 offset:288
    v_cvt_pk_bf16_f32 v70, v213, v225
    v_mfma_f32_16x16x32_bf16 v[228:231], v[104:107], a[212:215], v[228:231]
    s_waitcnt lgkmcnt(7)
    ds_read_b64_tr_b16 a[18:19], v2 offset:800
    v_cvt_pk_bf16_f32 v72, v214, v226
    v_mfma_f32_16x16x32_bf16 v[228:231], v[100:103], a[208:211], v[228:231]
    ds_read_b64_tr_b16 v[220:221], v5 offset:1152
    v_cvt_pk_bf16_f32 v74, v215, v227
    v_mfma_f32_16x16x32_bf16 v[240:243], v[100:103], a[224:227], v[240:243]
    ds_read_b64_tr_b16 v[222:223], v5 offset:1184
    v_cvt_pk_bf16_f32 v69, v236, v248
    v_cvt_pk_bf16_f32 v71, v237, v249
    v_cvt_pk_bf16_f32 v73, v238, v250
    v_mfma_f32_16x16x32_bf16 v[240:243], v[104:107], a[228:231], v[240:243]
    ds_write_b64 v1, v[68:69] offset:2304
    v_cvt_pk_bf16_f32 v75, v239, v251
    v_mfma_f32_16x16x32_bf16 v[240:243], v[124:127], a[232:235], v[240:243]
    s_waitcnt lgkmcnt(5)
    buffer_store_dwordx4 v[208:211], v3, s[16:19], 0 offen offset:384 nt
    v_mfma_f32_16x16x32_bf16 v[240:243], v[128:131], a[236:239], v[240:243]
    ds_write_b64 v1, v[70:71] offset:2432
    ds_read_b64_tr_b16 a[32:33], v2 offset:320
    v_mfma_f32_16x16x32_bf16 v[252:255], v[128:131], a[252:255], v[252:255]
    ds_read_b64_tr_b16 a[34:35], v2 offset:832
    v_accvgpr_read_b32 v12, a180
    v_accvgpr_read_b32 v13, a181
    v_mfma_f32_16x16x32_bf16 v[252:255], v[124:127], a[248:251], v[252:255]
    ds_write_b64 v1, v[72:73] offset:2592
    ds_read_b64_tr_b16 a[36:37], v2 offset:17216
    v_mfma_f32_16x16x32_bf16 v[252:255], v[104:107], a[244:247], v[252:255]
    s_waitcnt lgkmcnt(6)
    buffer_store_dwordx4 v[220:223], v4, s[16:19], 0 offen offset:384 nt
    ds_read_b64_tr_b16 a[38:39], v2 offset:17728
    v_mfma_f32_16x16x32_bf16 v[252:255], v[100:103], a[240:243], v[252:255]
    ds_write_b64 v1, v[74:75] offset:2720
    ds_read_b64_tr_b16 a[40:41], v2 offset:34112
    ds_read_b64_tr_b16 a[42:43], v2 offset:34624
    v_mfma_f32_16x16x32_bf16 v[160:163], v[84:87], a[0:3], v[160:163]
    ds_read_b64_tr_b16 v[212:213], v5 offset:2304
    ds_read_b64_tr_b16 a[44:45], v2 offset:51008
    v_mfma_f32_16x16x32_bf16 v[160:163], v[88:91], a[4:7], v[160:163]
    ds_read_b64_tr_b16 v[214:215], v5 offset:2336
    ds_read_b64_tr_b16 a[46:47], v2 offset:51520
    v_accvgpr_read_b32 v14, a182
    v_mfma_f32_16x16x32_bf16 v[160:163], v[108:111], a[8:11], v[160:163]
    s_waitcnt lgkmcnt(10)
    ds_read_b64_tr_b16 v[224:225], v5 offset:3456
    ds_read_b64_tr_b16 a[60:61], v2 offset:51040
    v_accvgpr_read_b32 v15, a183
    v_mul_f32_e64 v12, -v12, v32
    v_mfma_f32_16x16x32_bf16 v[160:163], v[112:115], a[12:15], v[160:163]
    ds_read_b64_tr_b16 v[226:227], v5 offset:3488
    ds_read_b64_tr_b16 a[62:63], v2 offset:51552
    ds_read_b64_tr_b16 a[56:57], v2 offset:34144
    v_mul_f32_e64 v13, -v13, v33
    v_mfma_f32_16x16x32_bf16 v[172:175], v[112:115], a[28:31], v[172:175]
    s_waitcnt lgkmcnt(12)
    ds_read_b64_tr_b16 a[58:59], v2 offset:34656
    v_mul_f32_e64 v14, -v14, v34
    v_mul_f32_e64 v15, -v15, v35
    v_mfma_f32_16x16x32_bf16 v[172:175], v[108:111], a[24:27], v[172:175]
    s_waitcnt lgkmcnt(10)
    ds_read_b64_tr_b16 a[52:53], v2 offset:17248
    ds_read_b64_tr_b16 a[54:55], v2 offset:17760
    ds_read_b64_tr_b16 a[48:49], v2 offset:352
    ds_read_b64_tr_b16 a[50:51], v2 offset:864
    ds_read_b64_tr_b16 a[192:193], v2 offset:128
    v_pk_fma_f32 v[216:217], v[216:217], v[32:33], v[12:13]
    v_pk_fma_f32 v[218:219], v[218:219], v[34:35], v[14:15]
    v_pk_fma_f32 v[228:229], v[228:229], v[32:33], v[12:13]
    v_pk_fma_f32 v[230:231], v[230:231], v[34:35], v[14:15]
    v_pk_fma_f32 v[240:241], v[240:241], v[32:33], v[12:13]
    v_pk_fma_f32 v[242:243], v[242:243], v[34:35], v[14:15]
    v_pk_fma_f32 v[252:253], v[252:253], v[32:33], v[12:13]
    v_pk_fma_f32 v[254:255], v[254:255], v[34:35], v[14:15]
    v_mfma_f32_16x16x32_bf16 v[172:175], v[88:91], a[20:23], v[172:175]
    s_waitcnt lgkmcnt(13)
    ds_read_b64_tr_b16 a[194:195], v2 offset:640
    v_cvt_pk_bf16_f32 v16, v216, v228
    v_mfma_f32_16x16x32_bf16 v[172:175], v[84:87], a[16:19], v[172:175]
    ds_read_b64_tr_b16 a[196:197], v2 offset:17024
    v_cvt_pk_bf16_f32 v18, v217, v229
    v_mfma_f32_16x16x32_bf16 v[184:187], v[84:87], a[32:35], v[184:187]
    s_waitcnt lgkmcnt(11)
    ds_read_b64_tr_b16 a[198:199], v2 offset:17536
    v_cvt_pk_bf16_f32 v20, v218, v230
    v_mfma_f32_16x16x32_bf16 v[184:187], v[88:91], a[36:39], v[184:187]
    buffer_store_dwordx4 v[212:215], v3, s[16:19], s27 offen offset:384 nt
    v_mfma_f32_16x16x32_bf16 v[184:187], v[108:111], a[40:43], v[184:187]
    ds_read_b64_tr_b16 a[200:201], v2 offset:33920
    v_cvt_pk_bf16_f32 v22, v219, v231
    v_mfma_f32_16x16x32_bf16 v[184:187], v[112:115], a[44:47], v[184:187]
    s_waitcnt lgkmcnt(4)
    ds_read_b64_tr_b16 a[202:203], v2 offset:34432
    v_cvt_pk_bf16_f32 v17, v240, v252
    v_cvt_pk_bf16_f32 v19, v241, v253
    v_mfma_f32_16x16x32_bf16 v[196:199], v[112:115], a[60:63], v[196:199]
    ds_write_b64 v1, v[16:17] offset:4608
    v_cvt_pk_bf16_f32 v21, v242, v254
    v_mfma_f32_16x16x32_bf16 v[196:199], v[108:111], a[56:59], v[196:199]
    ds_read_b64_tr_b16 a[204:205], v2 offset:50816
    v_cvt_pk_bf16_f32 v23, v243, v255
    v_mfma_f32_16x16x32_bf16 v[196:199], v[88:91], a[52:55], v[196:199]
    ds_write_b64 v1, v[18:19] offset:4736
    v_mfma_f32_16x16x32_bf16 v[196:199], v[84:87], a[48:51], v[196:199]
    ds_read_b64_tr_b16 a[206:207], v2 offset:51328
    v_mfma_f32_16x16x32_bf16 v[164:167], v[92:95], a[0:3], v[164:167]
    ds_write_b64 v1, v[20:21] offset:4896
    v_mfma_f32_16x16x32_bf16 v[164:167], v[96:99], a[4:7], v[164:167]
    ds_read_b64_tr_b16 a[220:221], v2 offset:50848
    v_mfma_f32_16x16x32_bf16 v[164:167], v[116:119], a[8:11], v[164:167]
    ds_write_b64 v1, v[22:23] offset:5024
    v_mfma_f32_16x16x32_bf16 v[164:167], v[120:123], a[12:15], v[164:167]
    buffer_store_dwordx4 v[224:227], v4, s[16:19], s27 offen offset:384 nt
    v_pk_fma_f32 v[160:161], v[160:161], v[24:25], v[76:77]
    v_pk_fma_f32 v[162:163], v[162:163], v[26:27], v[78:79]
    v_pk_fma_f32 v[172:173], v[172:173], v[24:25], v[76:77]
    v_pk_fma_f32 v[174:175], v[174:175], v[26:27], v[78:79]
    v_pk_fma_f32 v[184:185], v[184:185], v[24:25], v[76:77]
    v_pk_fma_f32 v[186:187], v[186:187], v[26:27], v[78:79]
    v_pk_fma_f32 v[196:197], v[196:197], v[24:25], v[76:77]
    v_pk_fma_f32 v[198:199], v[198:199], v[26:27], v[78:79]
    v_mfma_f32_16x16x32_bf16 v[176:179], v[120:123], a[28:31], v[176:179]
    ds_read_b64_tr_b16 a[222:223], v2 offset:51360
    v_cvt_pk_bf16_f32 v68, v160, v172
    v_mfma_f32_16x16x32_bf16 v[176:179], v[116:119], a[24:27], v[176:179]
    ds_read_b64_tr_b16 a[216:217], v2 offset:33952
    v_cvt_pk_bf16_f32 v70, v161, v173
    v_mfma_f32_16x16x32_bf16 v[176:179], v[96:99], a[20:23], v[176:179]
    ds_read_b64_tr_b16 a[218:219], v2 offset:34464
    v_cvt_pk_bf16_f32 v72, v162, v174
    v_mfma_f32_16x16x32_bf16 v[176:179], v[92:95], a[16:19], v[176:179]
    s_waitcnt lgkmcnt(4)
    ds_read_b64_tr_b16 v[216:217], v5 offset:4608
    v_cvt_pk_bf16_f32 v74, v163, v175
    v_mfma_f32_16x16x32_bf16 v[188:191], v[92:95], a[32:35], v[188:191]
    ds_read_b64_tr_b16 v[218:219], v5 offset:4640
    v_cvt_pk_bf16_f32 v69, v184, v196
    v_cvt_pk_bf16_f32 v71, v185, v197
    v_cvt_pk_bf16_f32 v73, v186, v198
    v_mfma_f32_16x16x32_bf16 v[188:191], v[96:99], a[36:39], v[188:191]
    ds_read_b64_tr_b16 v[228:229], v5 offset:5760
    v_cvt_pk_bf16_f32 v75, v187, v199
    v_mfma_f32_16x16x32_bf16 v[188:191], v[116:119], a[40:43], v[188:191]
    ds_read_b64_tr_b16 v[230:231], v5 offset:5792
    v_mfma_f32_16x16x32_bf16 v[188:191], v[120:123], a[44:47], v[188:191]
    ds_write_b64 v1, v[68:69] offset:6912
    v_mfma_f32_16x16x32_bf16 v[200:203], v[120:123], a[60:63], v[200:203]
    ds_read_b64_tr_b16 a[212:213], v2 offset:17056
    v_mfma_f32_16x16x32_bf16 v[200:203], v[116:119], a[56:59], v[200:203]
    ds_write_b64 v1, v[70:71] offset:7040
    v_mfma_f32_16x16x32_bf16 v[200:203], v[96:99], a[52:55], v[200:203]
    s_waitcnt lgkmcnt(5)
    buffer_store_dwordx4 v[216:219], v3, s[16:19], s28 offen offset:384 nt
    v_mfma_f32_16x16x32_bf16 v[200:203], v[92:95], a[48:51], v[200:203]
    ds_write_b64 v1, v[72:73] offset:7200
    v_mfma_f32_16x16x32_bf16 v[168:171], v[100:103], a[0:3], v[168:171]
    ds_read_b64_tr_b16 a[214:215], v2 offset:17568
    v_mfma_f32_16x16x32_bf16 v[168:171], v[104:107], a[4:7], v[168:171]
    ds_write_b64 v1, v[74:75] offset:7328
    v_mfma_f32_16x16x32_bf16 v[168:171], v[124:127], a[8:11], v[168:171]
    ds_read_b64_tr_b16 v[160:161], v5 offset:6912
    v_mfma_f32_16x16x32_bf16 v[168:171], v[128:131], a[12:15], v[168:171]
    s_waitcnt lgkmcnt(4)
    buffer_store_dwordx4 v[228:231], v4, s[16:19], s28 offen offset:384 nt
    v_pk_fma_f32 v[164:165], v[164:165], v[28:29], v[80:81]
    v_pk_fma_f32 v[166:167], v[166:167], v[30:31], v[82:83]
    v_pk_fma_f32 v[176:177], v[176:177], v[28:29], v[80:81]
    v_pk_fma_f32 v[178:179], v[178:179], v[30:31], v[82:83]
    v_pk_fma_f32 v[188:189], v[188:189], v[28:29], v[80:81]
    v_pk_fma_f32 v[190:191], v[190:191], v[30:31], v[82:83]
    v_pk_fma_f32 v[200:201], v[200:201], v[28:29], v[80:81]
    v_pk_fma_f32 v[202:203], v[202:203], v[30:31], v[82:83]
    v_mfma_f32_16x16x32_bf16 v[180:183], v[128:131], a[28:31], v[180:183]
    ds_read_b64_tr_b16 a[208:209], v2 offset:160
    v_cvt_pk_bf16_f32 v16, v164, v176
    v_mfma_f32_16x16x32_bf16 v[180:183], v[124:127], a[24:27], v[180:183]
    ds_read_b64_tr_b16 a[210:211], v2 offset:672
    v_cvt_pk_bf16_f32 v18, v165, v177
    v_mfma_f32_16x16x32_bf16 v[180:183], v[104:107], a[20:23], v[180:183]
    ds_read_b64_tr_b16 a[224:225], v2 offset:192
    v_cvt_pk_bf16_f32 v20, v166, v178
    v_mfma_f32_16x16x32_bf16 v[180:183], v[100:103], a[16:19], v[180:183]
    ds_read_b64_tr_b16 v[162:163], v5 offset:6944
    v_cvt_pk_bf16_f32 v22, v167, v179
    v_mfma_f32_16x16x32_bf16 v[192:195], v[100:103], a[32:35], v[192:195]
    ds_read_b64_tr_b16 v[172:173], v5 offset:8064
    v_cvt_pk_bf16_f32 v17, v188, v200
    v_cvt_pk_bf16_f32 v19, v189, v201
    v_cvt_pk_bf16_f32 v21, v190, v202
    v_mfma_f32_16x16x32_bf16 v[192:195], v[104:107], a[36:39], v[192:195]
    ds_read_b64_tr_b16 v[174:175], v5 offset:8096
    v_cvt_pk_bf16_f32 v23, v191, v203
    v_mfma_f32_16x16x32_bf16 v[192:195], v[124:127], a[40:43], v[192:195]
    ds_write_b64 v1, v[16:17] offset:9216
    v_mfma_f32_16x16x32_bf16 v[192:195], v[128:131], a[44:47], v[192:195]
    ds_read_b64_tr_b16 a[226:227], v2 offset:704
    v_mfma_f32_16x16x32_bf16 v[204:207], v[128:131], a[60:63], v[204:207]
    ds_write_b64 v1, v[18:19] offset:9344
    v_mfma_f32_16x16x32_bf16 v[204:207], v[124:127], a[56:59], v[204:207]
    s_waitcnt lgkmcnt(5)
    buffer_store_dwordx4 v[160:163], v3, s[16:19], 0 offen offset:256 nt
    ds_read_b64_tr_b16 a[228:229], v2 offset:17088
    v_mfma_f32_16x16x32_bf16 v[204:207], v[104:107], a[52:55], v[204:207]
    ds_write_b64 v1, v[20:21] offset:9504
    ds_read_b64_tr_b16 a[230:231], v2 offset:17600
    v_mfma_f32_16x16x32_bf16 v[204:207], v[100:103], a[48:51], v[204:207]
    ds_read_b64_tr_b16 a[232:233], v2 offset:33984
    ds_read_b64_tr_b16 a[234:235], v2 offset:34496
    v_mfma_f32_16x16x32_bf16 a[144:147], v[84:87], a[192:195], a[144:147]
    ds_write_b64 v1, v[22:23] offset:9632
    ds_read_b64_tr_b16 a[236:237], v2 offset:50880
    v_mfma_f32_16x16x32_bf16 a[144:147], v[88:91], a[196:199], a[144:147]
    ds_read_b64_tr_b16 v[164:165], v5 offset:9216
    ds_read_b64_tr_b16 a[238:239], v2 offset:51392
    v_mfma_f32_16x16x32_bf16 a[144:147], v[108:111], a[200:203], a[144:147]
    s_waitcnt lgkmcnt(9)
    ds_read_b64_tr_b16 v[166:167], v5 offset:9248
    ds_read_b64_tr_b16 a[252:253], v2 offset:50912
    v_mfma_f32_16x16x32_bf16 a[144:147], v[112:115], a[204:207], a[144:147]
    buffer_store_dwordx4 v[172:175], v4, s[16:19], 0 offen offset:256 nt
    v_pk_fma_f32 v[168:169], v[168:169], v[32:33], v[12:13]
    v_pk_fma_f32 v[170:171], v[170:171], v[34:35], v[14:15]
    v_pk_fma_f32 v[180:181], v[180:181], v[32:33], v[12:13]
    v_pk_fma_f32 v[182:183], v[182:183], v[34:35], v[14:15]
    v_pk_fma_f32 v[192:193], v[192:193], v[32:33], v[12:13]
    v_pk_fma_f32 v[194:195], v[194:195], v[34:35], v[14:15]
    v_pk_fma_f32 v[204:205], v[204:205], v[32:33], v[12:13]
    v_pk_fma_f32 v[206:207], v[206:207], v[34:35], v[14:15]
    v_mfma_f32_16x16x32_bf16 a[156:159], v[112:115], a[220:223], a[156:159]
    ds_read_b64_tr_b16 a[254:255], v2 offset:51424
    ds_read_b64_tr_b16 a[248:249], v2 offset:34016
    v_mfma_f32_16x16x32_bf16 a[156:159], v[108:111], a[216:219], a[156:159]
    ds_read_b64_tr_b16 a[250:251], v2 offset:34528
    ds_read_b64_tr_b16 a[244:245], v2 offset:17120
    v_mfma_f32_16x16x32_bf16 a[156:159], v[88:91], a[212:215], a[156:159]
    s_waitcnt lgkmcnt(8)
    ds_read_b64_tr_b16 a[246:247], v2 offset:17632
    v_cvt_pk_bf16_f32 v68, v168, v180
    v_mfma_f32_16x16x32_bf16 a[156:159], v[84:87], a[208:211], a[156:159]
    ds_read_b64_tr_b16 v[176:177], v5 offset:10368
    ds_read_b64_tr_b16 a[240:241], v2 offset:224
    ds_read_b64_tr_b16 a[242:243], v2 offset:736
    v_mfma_f32_16x16x32_bf16 v[136:139], v[84:87], a[224:227], v[136:139]
    s_waitcnt lgkmcnt(8)
    ds_read_b64_tr_b16 v[178:179], v5 offset:10400
    buffer_store_dwordx4 v[164:167], v3, s[16:19], s27 offen offset:256 nt
    v_mfma_f32_16x16x32_bf16 v[136:139], v[88:91], a[228:231], v[136:139]
    ds_read_b64_tr_b16 a[0:1], v2 offset:0
    v_cvt_pk_bf16_f32 v70, v169, v181
    v_mfma_f32_16x16x32_bf16 v[136:139], v[108:111], a[232:235], v[136:139]
    ds_read_b64_tr_b16 a[2:3], v2 offset:512
    v_cvt_pk_bf16_f32 v72, v170, v182
    v_cvt_pk_bf16_f32 v74, v171, v183
    v_mfma_f32_16x16x32_bf16 v[136:139], v[112:115], a[236:239], v[136:139]
    s_waitcnt lgkmcnt(7)
    ds_read_b64_tr_b16 a[4:5], v2 offset:16896
    v_cvt_pk_bf16_f32 v69, v192, v204
    v_cvt_pk_bf16_f32 v71, v193, v205
    v_cvt_pk_bf16_f32 v73, v194, v206
    v_mfma_f32_16x16x32_bf16 v[148:151], v[112:115], a[252:255], v[148:151]
    ds_write_b64 v1, v[68:69] offset:11520
    v_cvt_pk_bf16_f32 v75, v195, v207
    v_mfma_f32_16x16x32_bf16 v[148:151], v[108:111], a[248:251], v[148:151]
    s_waitcnt lgkmcnt(5)
    ds_read_b64_tr_b16 a[6:7], v2 offset:17408
    v_accvgpr_read_b32 v36, a144
    v_accvgpr_read_b32 v37, a145
    v_accvgpr_read_b32 v38, a146
    v_mfma_f32_16x16x32_bf16 v[148:151], v[88:91], a[244:247], v[148:151]
    ds_write_b64 v1, v[70:71] offset:11648
    v_accvgpr_read_b32 v39, a147
    v_mfma_f32_16x16x32_bf16 v[148:151], v[84:87], a[240:243], v[148:151]
    ds_read_b64_tr_b16 a[8:9], v2 offset:33792
    v_accvgpr_read_b32 v40, a156
    v_accvgpr_read_b32 v41, a157
    v_accvgpr_read_b32 v42, a158
    v_mfma_f32_16x16x32_bf16 a[148:151], v[92:95], a[192:195], a[148:151]
    ds_write_b64 v1, v[72:73] offset:11808
    v_accvgpr_read_b32 v43, a159
    v_mfma_f32_16x16x32_bf16 a[148:151], v[96:99], a[196:199], a[148:151]
    ds_read_b64_tr_b16 a[10:11], v2 offset:34304
    v_mfma_f32_16x16x32_bf16 a[148:151], v[116:119], a[200:203], a[148:151]
    ds_write_b64 v1, v[74:75] offset:11936
    v_mfma_f32_16x16x32_bf16 a[148:151], v[120:123], a[204:207], a[148:151]
    s_waitcnt lgkmcnt(5)
    buffer_store_dwordx4 v[176:179], v4, s[16:19], s27 offen offset:256 nt
    v_pk_fma_f32 v[36:37], v[36:37], v[24:25], v[76:77]
    v_pk_fma_f32 v[38:39], v[38:39], v[26:27], v[78:79]
    v_pk_fma_f32 v[40:41], v[40:41], v[24:25], v[76:77]
    v_pk_fma_f32 v[42:43], v[42:43], v[26:27], v[78:79]
    v_pk_fma_f32 v[136:137], v[136:137], v[24:25], v[76:77]
    v_pk_fma_f32 v[138:139], v[138:139], v[26:27], v[78:79]
    v_pk_fma_f32 v[148:149], v[148:149], v[24:25], v[76:77]
    v_pk_fma_f32 v[150:151], v[150:151], v[26:27], v[78:79]
    v_mfma_f32_16x16x32_bf16 a[160:163], v[120:123], a[220:223], a[160:163]
    ds_read_b64_tr_b16 a[12:13], v2 offset:50688
    v_cvt_pk_bf16_f32 v16, v36, v40
    v_mfma_f32_16x16x32_bf16 a[160:163], v[116:119], a[216:219], a[160:163]
    ds_read_b64_tr_b16 a[14:15], v2 offset:51200
    v_cvt_pk_bf16_f32 v18, v37, v41
    v_mfma_f32_16x16x32_bf16 a[160:163], v[96:99], a[212:215], a[160:163]
    ds_read_b64_tr_b16 a[28:29], v2 offset:50720
    v_cvt_pk_bf16_f32 v20, v38, v42
    v_mfma_f32_16x16x32_bf16 a[160:163], v[92:95], a[208:211], a[160:163]
    ds_read_b64_tr_b16 v[168:169], v5 offset:11520
    v_cvt_pk_bf16_f32 v22, v39, v43
    v_mfma_f32_16x16x32_bf16 v[140:143], v[92:95], a[224:227], v[140:143]
    ds_read_b64_tr_b16 v[170:171], v5 offset:11552
    v_cvt_pk_bf16_f32 v17, v136, v148
    v_cvt_pk_bf16_f32 v19, v137, v149
    v_cvt_pk_bf16_f32 v21, v138, v150
    v_mfma_f32_16x16x32_bf16 v[140:143], v[96:99], a[228:231], v[140:143]
    ds_read_b64_tr_b16 v[180:181], v5 offset:12672
    v_cvt_pk_bf16_f32 v23, v139, v151
    v_accvgpr_read_b32 v52, a148
    v_accvgpr_read_b32 v53, a149
    v_mfma_f32_16x16x32_bf16 v[140:143], v[116:119], a[232:235], v[140:143]
    ds_read_b64_tr_b16 v[182:183], v5 offset:12704
    v_accvgpr_read_b32 v54, a150
    v_accvgpr_read_b32 v55, a151
    v_mfma_f32_16x16x32_bf16 v[140:143], v[120:123], a[236:239], v[140:143]
    ds_write_b64 v1, v[16:17] offset:0
    v_accvgpr_read_b32 v56, a160
    v_accvgpr_read_b32 v57, a161
    v_mfma_f32_16x16x32_bf16 v[152:155], v[120:123], a[252:255], v[152:155]
    ds_read_b64_tr_b16 a[30:31], v2 offset:51232
    v_accvgpr_read_b32 v58, a162
    v_accvgpr_read_b32 v59, a163
    v_mfma_f32_16x16x32_bf16 v[152:155], v[116:119], a[248:251], v[152:155]
    ds_write_b64 v1, v[18:19] offset:128
    v_mfma_f32_16x16x32_bf16 v[152:155], v[96:99], a[244:247], v[152:155]
    s_waitcnt lgkmcnt(5)
    buffer_store_dwordx4 v[168:171], v3, s[16:19], s28 offen offset:256 nt
    v_mfma_f32_16x16x32_bf16 v[152:155], v[92:95], a[240:243], v[152:155]
    ds_write_b64 v1, v[20:21] offset:288
    v_mfma_f32_16x16x32_bf16 a[152:155], v[100:103], a[192:195], a[152:155]
    ds_read_b64_tr_b16 a[24:25], v2 offset:33824
    v_mfma_f32_16x16x32_bf16 a[152:155], v[104:107], a[196:199], a[152:155]
    ds_write_b64 v1, v[22:23] offset:416
    v_mfma_f32_16x16x32_bf16 a[152:155], v[124:127], a[200:203], a[152:155]
    ds_read_b64_tr_b16 v[36:37], v5 offset:0
    v_mfma_f32_16x16x32_bf16 a[152:155], v[128:131], a[204:207], a[152:155]
    s_waitcnt lgkmcnt(4)
    buffer_store_dwordx4 v[180:183], v4, s[16:19], s28 offen offset:256 nt
    v_pk_fma_f32 v[52:53], v[52:53], v[28:29], v[80:81]
    v_pk_fma_f32 v[54:55], v[54:55], v[30:31], v[82:83]
    v_pk_fma_f32 v[56:57], v[56:57], v[28:29], v[80:81]
    v_pk_fma_f32 v[58:59], v[58:59], v[30:31], v[82:83]
    v_pk_fma_f32 v[140:141], v[140:141], v[28:29], v[80:81]
    v_pk_fma_f32 v[142:143], v[142:143], v[30:31], v[82:83]
    v_pk_fma_f32 v[152:153], v[152:153], v[28:29], v[80:81]
    v_pk_fma_f32 v[154:155], v[154:155], v[30:31], v[82:83]
    v_mfma_f32_16x16x32_bf16 v[132:135], v[128:131], a[220:223], v[132:135]
    ds_read_b64_tr_b16 a[26:27], v2 offset:34336
    v_cvt_pk_bf16_f32 v68, v52, v56
    v_mfma_f32_16x16x32_bf16 v[132:135], v[124:127], a[216:219], v[132:135]
    ds_read_b64_tr_b16 a[20:21], v2 offset:16928
    v_cvt_pk_bf16_f32 v70, v53, v57
    v_mfma_f32_16x16x32_bf16 v[132:135], v[104:107], a[212:215], v[132:135]
    ds_read_b64_tr_b16 a[22:23], v2 offset:17440
    v_cvt_pk_bf16_f32 v72, v54, v58
    v_mfma_f32_16x16x32_bf16 v[132:135], v[100:103], a[208:211], v[132:135]
    ds_read_b64_tr_b16 v[38:39], v5 offset:32
    v_cvt_pk_bf16_f32 v74, v55, v59
    v_mfma_f32_16x16x32_bf16 v[144:147], v[100:103], a[224:227], v[144:147]
    ds_read_b64_tr_b16 v[40:41], v5 offset:1152
    v_cvt_pk_bf16_f32 v69, v140, v152
    v_cvt_pk_bf16_f32 v71, v141, v153
    v_cvt_pk_bf16_f32 v73, v142, v154
    v_mfma_f32_16x16x32_bf16 v[144:147], v[104:107], a[228:231], v[144:147]
    ds_read_b64_tr_b16 v[42:43], v5 offset:1184
    v_cvt_pk_bf16_f32 v75, v143, v155
    v_mfma_f32_16x16x32_bf16 v[144:147], v[124:127], a[232:235], v[144:147]
    ds_write_b64 v1, v[68:69] offset:2304
    ds_read_b64_tr_b16 a[16:17], v2 offset:32
    v_mfma_f32_16x16x32_bf16 v[144:147], v[128:131], a[236:239], v[144:147]
    ds_read_b64_tr_b16 a[18:19], v2 offset:544
    ds_read_b64_tr_b16 a[32:33], v2 offset:64
    v_mfma_f32_16x16x32_bf16 v[156:159], v[128:131], a[252:255], v[156:159]
    s_waitcnt lgkmcnt(7)
    ds_write_b64 v1, v[70:71] offset:2432
    ds_read_b64_tr_b16 a[34:35], v2 offset:576
    v_mfma_f32_16x16x32_bf16 v[156:159], v[124:127], a[248:251], v[156:159]
    s_waitcnt lgkmcnt(8)
    buffer_store_dwordx4 v[36:39], v3, s[16:19], 0 offen offset:128 nt
    ds_read_b64_tr_b16 a[36:37], v2 offset:16960
    v_mfma_f32_16x16x32_bf16 v[156:159], v[104:107], a[244:247], v[156:159]
    ds_write_b64 v1, v[72:73] offset:2592
    ds_read_b64_tr_b16 a[38:39], v2 offset:17472
    v_mfma_f32_16x16x32_bf16 v[156:159], v[100:103], a[240:243], v[156:159]
    ds_read_b64_tr_b16 a[40:41], v2 offset:33856
    ds_read_b64_tr_b16 a[42:43], v2 offset:34368
    v_accvgpr_read_b32 v36, a152
    v_mfma_f32_16x16x32_bf16 a[96:99], v[84:87], a[0:3], a[96:99]
    ds_write_b64 v1, v[74:75] offset:2720
    ds_read_b64_tr_b16 a[44:45], v2 offset:50752
    v_mfma_f32_16x16x32_bf16 a[96:99], v[88:91], a[4:7], a[96:99]
    s_waitcnt lgkmcnt(9)
    ds_read_b64_tr_b16 v[52:53], v5 offset:2304
    ds_read_b64_tr_b16 a[46:47], v2 offset:51264
    v_accvgpr_read_b32 v37, a153
    v_accvgpr_read_b32 v38, a154
    v_mfma_f32_16x16x32_bf16 a[96:99], v[108:111], a[8:11], a[96:99]
    ds_read_b64_tr_b16 v[54:55], v5 offset:2336
    ds_read_b64_tr_b16 a[60:61], v2 offset:50784
    v_accvgpr_read_b32 v39, a155
    v_mfma_f32_16x16x32_bf16 a[96:99], v[112:115], a[12:15], a[96:99]
    buffer_store_dwordx4 v[40:43], v4, s[16:19], 0 offen offset:128 nt
    v_pk_fma_f32 v[36:37], v[36:37], v[32:33], v[12:13]
    v_pk_fma_f32 v[38:39], v[38:39], v[34:35], v[14:15]
    v_pk_fma_f32 v[132:133], v[132:133], v[32:33], v[12:13]
    v_pk_fma_f32 v[134:135], v[134:135], v[34:35], v[14:15]
    v_pk_fma_f32 v[144:145], v[144:145], v[32:33], v[12:13]
    v_pk_fma_f32 v[146:147], v[146:147], v[34:35], v[14:15]
    v_pk_fma_f32 v[156:157], v[156:157], v[32:33], v[12:13]
    v_pk_fma_f32 v[158:159], v[158:159], v[34:35], v[14:15]
    v_mfma_f32_16x16x32_bf16 a[108:111], v[112:115], a[28:31], a[108:111]
    ds_read_b64_tr_b16 a[62:63], v2 offset:51296
    ds_read_b64_tr_b16 a[56:57], v2 offset:33888
    v_mfma_f32_16x16x32_bf16 a[108:111], v[108:111], a[24:27], a[108:111]
    s_waitcnt lgkmcnt(8)
    ds_read_b64_tr_b16 a[58:59], v2 offset:34400
    ds_read_b64_tr_b16 a[52:53], v2 offset:16992
    v_mfma_f32_16x16x32_bf16 a[108:111], v[88:91], a[20:23], a[108:111]
    ds_read_b64_tr_b16 a[54:55], v2 offset:17504
    v_cvt_pk_bf16_f32 v16, v36, v132
    v_mfma_f32_16x16x32_bf16 a[108:111], v[84:87], a[16:19], a[108:111]
    ds_read_b64_tr_b16 v[56:57], v5 offset:3456
    ds_read_b64_tr_b16 a[48:49], v2 offset:96
    ds_read_b64_tr_b16 a[50:51], v2 offset:608
    v_mfma_f32_16x16x32_bf16 a[120:123], v[84:87], a[32:35], a[120:123]
    s_waitcnt lgkmcnt(8)
    ds_read_b64_tr_b16 v[58:59], v5 offset:3488
    buffer_store_dwordx4 v[52:55], v3, s[16:19], s27 offen offset:128 nt
    v_mfma_f32_16x16x32_bf16 a[120:123], v[88:91], a[36:39], a[120:123]
    v_cvt_pk_bf16_f32 v18, v37, v133
    v_cvt_pk_bf16_f32 v20, v38, v134
    v_mfma_f32_16x16x32_bf16 a[120:123], v[108:111], a[40:43], a[120:123]
    v_cvt_pk_bf16_f32 v22, v39, v135
    v_cvt_pk_bf16_f32 v17, v144, v156
    v_cvt_pk_bf16_f32 v19, v145, v157
    v_mfma_f32_16x16x32_bf16 a[120:123], v[112:115], a[44:47], a[120:123]
    s_waitcnt lgkmcnt(5)
    ds_write_b64 v1, v[16:17] offset:4608
    v_cvt_pk_bf16_f32 v21, v146, v158
    v_mfma_f32_16x16x32_bf16 a[132:135], v[112:115], a[60:63], a[132:135]
    v_cvt_pk_bf16_f32 v23, v147, v159
    v_accvgpr_read_b32 v52, a96
    v_accvgpr_read_b32 v53, a97
    v_accvgpr_read_b32 v54, a98
    v_mfma_f32_16x16x32_bf16 a[132:135], v[108:111], a[56:59], a[132:135]
    s_waitcnt lgkmcnt(2)
    ds_write_b64 v1, v[18:19] offset:4736
    v_accvgpr_read_b32 v55, a99
    v_mfma_f32_16x16x32_bf16 a[132:135], v[88:91], a[52:55], a[132:135]
    s_waitcnt lgkmcnt(2)
    buffer_store_dwordx4 v[56:59], v4, s[16:19], s27 offen offset:128 nt
    v_mfma_f32_16x16x32_bf16 a[132:135], v[84:87], a[48:51], a[132:135]
    ds_write_b64 v1, v[20:21] offset:4896
    v_mfma_f32_16x16x32_bf16 a[100:103], v[92:95], a[0:3], a[100:103]
    v_accvgpr_read_b32 v56, a108
    v_accvgpr_read_b32 v57, a109
    v_accvgpr_read_b32 v58, a110
    v_accvgpr_read_b32 v59, a111
    v_mfma_f32_16x16x32_bf16 a[100:103], v[96:99], a[4:7], a[100:103]
    ds_write_b64 v1, v[22:23] offset:5024
    v_accvgpr_read_b32 v60, a120
    v_mfma_f32_16x16x32_bf16 a[100:103], v[116:119], a[8:11], a[100:103]
    ds_read_b64_tr_b16 v[36:37], v5 offset:4608
    v_accvgpr_read_b32 v61, a121
    v_accvgpr_read_b32 v62, a122
    v_accvgpr_read_b32 v63, a123
    v_mfma_f32_16x16x32_bf16 a[100:103], v[120:123], a[12:15], a[100:103]
    ds_read_b64_tr_b16 v[38:39], v5 offset:4640
    v_accvgpr_read_b32 v64, a132
    v_accvgpr_read_b32 v65, a133
    v_accvgpr_read_b32 v66, a134
    v_mfma_f32_16x16x32_bf16 a[112:115], v[120:123], a[28:31], a[112:115]
    ds_read_b64_tr_b16 v[132:133], v5 offset:5760
    v_accvgpr_read_b32 v67, a135
    v_mfma_f32_16x16x32_bf16 a[112:115], v[116:119], a[24:27], a[112:115]
    ds_read_b64_tr_b16 v[134:135], v5 offset:5792
    v_pk_fma_f32 v[52:53], v[52:53], v[24:25], v[76:77]
    v_pk_fma_f32 v[54:55], v[54:55], v[26:27], v[78:79]
    v_pk_fma_f32 v[56:57], v[56:57], v[24:25], v[76:77]
    v_pk_fma_f32 v[58:59], v[58:59], v[26:27], v[78:79]
    v_pk_fma_f32 v[60:61], v[60:61], v[24:25], v[76:77]
    v_pk_fma_f32 v[62:63], v[62:63], v[26:27], v[78:79]
    v_pk_fma_f32 v[64:65], v[64:65], v[24:25], v[76:77]
    v_pk_fma_f32 v[66:67], v[66:67], v[26:27], v[78:79]
    v_mfma_f32_16x16x32_bf16 a[112:115], v[96:99], a[20:23], a[112:115]
    v_cvt_pk_bf16_f32 v68, v52, v56
    v_cvt_pk_bf16_f32 v70, v53, v57
    v_mfma_f32_16x16x32_bf16 a[112:115], v[92:95], a[16:19], a[112:115]
    v_cvt_pk_bf16_f32 v72, v54, v58
    v_cvt_pk_bf16_f32 v74, v55, v59
    v_mfma_f32_16x16x32_bf16 a[124:127], v[92:95], a[32:35], a[124:127]
    v_cvt_pk_bf16_f32 v69, v60, v64
    v_cvt_pk_bf16_f32 v71, v61, v65
    v_cvt_pk_bf16_f32 v73, v62, v66
    v_cvt_pk_bf16_f32 v75, v63, v67
    v_mfma_f32_16x16x32_bf16 a[124:127], v[96:99], a[36:39], a[124:127]
    ds_write_b64 v1, v[68:69] offset:6912
    v_mfma_f32_16x16x32_bf16 a[124:127], v[116:119], a[40:43], a[124:127]
    s_waitcnt lgkmcnt(2)
    buffer_store_dwordx4 v[36:39], v3, s[16:19], s28 offen offset:128 nt
    v_mfma_f32_16x16x32_bf16 a[124:127], v[120:123], a[44:47], a[124:127]
    ds_write_b64 v1, v[70:71] offset:7040
    v_accvgpr_read_b32 v36, a100
    v_mfma_f32_16x16x32_bf16 a[136:139], v[120:123], a[60:63], a[136:139]
    s_waitcnt lgkmcnt(2)
    buffer_store_dwordx4 v[132:135], v4, s[16:19], s28 offen offset:128 nt
    v_mfma_f32_16x16x32_bf16 a[136:139], v[116:119], a[56:59], a[136:139]
    ds_write_b64 v1, v[72:73] offset:7200
    v_mfma_f32_16x16x32_bf16 a[136:139], v[96:99], a[52:55], a[136:139]
    v_accvgpr_read_b32 v37, a101
    v_accvgpr_read_b32 v38, a102
    v_accvgpr_read_b32 v39, a103
    v_accvgpr_read_b32 v40, a112
    v_mfma_f32_16x16x32_bf16 a[136:139], v[92:95], a[48:51], a[136:139]
    ds_write_b64 v1, v[74:75] offset:7328
    v_accvgpr_read_b32 v41, a113
    v_mfma_f32_16x16x32_bf16 a[104:107], v[100:103], a[0:3], a[104:107]
    ds_read_b64_tr_b16 v[52:53], v5 offset:6912
    v_accvgpr_read_b32 v42, a114
    v_accvgpr_read_b32 v43, a115
    v_accvgpr_read_b32 v44, a124
    v_mfma_f32_16x16x32_bf16 a[104:107], v[104:107], a[4:7], a[104:107]
    ds_read_b64_tr_b16 v[54:55], v5 offset:6944
    v_accvgpr_read_b32 v45, a125
    v_accvgpr_read_b32 v46, a126
    v_accvgpr_read_b32 v47, a127
    v_mfma_f32_16x16x32_bf16 a[104:107], v[124:127], a[8:11], a[104:107]
    ds_read_b64_tr_b16 v[56:57], v5 offset:8064
    v_mfma_f32_16x16x32_bf16 a[104:107], v[128:131], a[12:15], a[104:107]
    ds_read_b64_tr_b16 v[58:59], v5 offset:8096
    v_accvgpr_read_b32 v48, a136
    v_accvgpr_read_b32 v49, a137
    v_accvgpr_read_b32 v50, a138
    v_accvgpr_read_b32 v51, a139
    v_mfma_f32_16x16x32_bf16 a[116:119], v[128:131], a[28:31], a[116:119]
    v_pk_fma_f32 v[36:37], v[36:37], v[28:29], v[80:81]
    v_pk_fma_f32 v[38:39], v[38:39], v[30:31], v[82:83]
    v_pk_fma_f32 v[40:41], v[40:41], v[28:29], v[80:81]
    v_pk_fma_f32 v[42:43], v[42:43], v[30:31], v[82:83]
    v_pk_fma_f32 v[44:45], v[44:45], v[28:29], v[80:81]
    v_pk_fma_f32 v[46:47], v[46:47], v[30:31], v[82:83]
    v_pk_fma_f32 v[48:49], v[48:49], v[28:29], v[80:81]
    v_pk_fma_f32 v[50:51], v[50:51], v[30:31], v[82:83]
    v_mfma_f32_16x16x32_bf16 a[116:119], v[124:127], a[24:27], a[116:119]
    v_cvt_pk_bf16_f32 v16, v36, v40
    v_cvt_pk_bf16_f32 v18, v37, v41
    v_mfma_f32_16x16x32_bf16 a[116:119], v[104:107], a[20:23], a[116:119]
    v_cvt_pk_bf16_f32 v20, v38, v42
    v_cvt_pk_bf16_f32 v22, v39, v43
    v_mfma_f32_16x16x32_bf16 a[116:119], v[100:103], a[16:19], a[116:119]
    s_waitcnt lgkmcnt(2)
    buffer_store_dwordx4 v[52:55], v3, s[16:19], 0 offen offset:0 nt
    v_mfma_f32_16x16x32_bf16 a[128:131], v[100:103], a[32:35], a[128:131]
    v_cvt_pk_bf16_f32 v17, v44, v48
    v_cvt_pk_bf16_f32 v19, v45, v49
    v_cvt_pk_bf16_f32 v21, v46, v50
    v_mfma_f32_16x16x32_bf16 a[128:131], v[104:107], a[36:39], a[128:131]
    ds_write_b64 v1, v[16:17] offset:9216
    v_cvt_pk_bf16_f32 v23, v47, v51
    v_mfma_f32_16x16x32_bf16 a[128:131], v[124:127], a[40:43], a[128:131]
    s_waitcnt lgkmcnt(1)
    buffer_store_dwordx4 v[56:59], v4, s[16:19], 0 offen offset:0 nt
    v_mfma_f32_16x16x32_bf16 a[128:131], v[128:131], a[44:47], a[128:131]
    ds_write_b64 v1, v[18:19] offset:9344
    v_mfma_f32_16x16x32_bf16 a[140:143], v[128:131], a[60:63], a[140:143]
    v_accvgpr_read_b32 v52, a104
    v_accvgpr_read_b32 v53, a105
    v_accvgpr_read_b32 v54, a106
    v_accvgpr_read_b32 v55, a107
    v_mfma_f32_16x16x32_bf16 a[140:143], v[124:127], a[56:59], a[140:143]
    ds_write_b64 v1, v[20:21] offset:9504
    v_accvgpr_read_b32 v56, a116
    v_mfma_f32_16x16x32_bf16 a[140:143], v[104:107], a[52:55], a[140:143]
    v_accvgpr_read_b32 v57, a117
    v_accvgpr_read_b32 v58, a118
    v_accvgpr_read_b32 v59, a119
    v_mfma_f32_16x16x32_bf16 a[140:143], v[100:103], a[48:51], a[140:143]
    ds_write_b64 v1, v[22:23] offset:9632
    v_accvgpr_read_b32 v60, a128
    v_accvgpr_read_b32 v61, a129
    ds_read_b64_tr_b16 v[36:37], v5 offset:9216
    ds_read_b64_tr_b16 v[38:39], v5 offset:9248
    ds_read_b64_tr_b16 v[40:41], v5 offset:10368
    ds_read_b64_tr_b16 v[42:43], v5 offset:10400
    v_accvgpr_read_b32 v62, a130
    v_accvgpr_read_b32 v63, a131
    v_accvgpr_read_b32 v64, a140
    v_accvgpr_read_b32 v65, a141
    v_accvgpr_read_b32 v66, a142
    v_accvgpr_read_b32 v67, a143
    v_pk_fma_f32 v[52:53], v[52:53], v[32:33], v[12:13]
    v_pk_fma_f32 v[54:55], v[54:55], v[34:35], v[14:15]
    v_pk_fma_f32 v[56:57], v[56:57], v[32:33], v[12:13]
    v_pk_fma_f32 v[58:59], v[58:59], v[34:35], v[14:15]
    v_pk_fma_f32 v[60:61], v[60:61], v[32:33], v[12:13]
    v_pk_fma_f32 v[62:63], v[62:63], v[34:35], v[14:15]
    v_pk_fma_f32 v[64:65], v[64:65], v[32:33], v[12:13]
    v_pk_fma_f32 v[66:67], v[66:67], v[34:35], v[14:15]
    v_cvt_pk_bf16_f32 v68, v52, v56
    v_cvt_pk_bf16_f32 v70, v53, v57
    v_cvt_pk_bf16_f32 v72, v54, v58
    v_cvt_pk_bf16_f32 v74, v55, v59
    v_cvt_pk_bf16_f32 v69, v60, v64
    v_cvt_pk_bf16_f32 v71, v61, v65
    v_cvt_pk_bf16_f32 v73, v62, v66
    v_cvt_pk_bf16_f32 v75, v63, v67
    ds_write_b64 v1, v[68:69] offset:11520
    ds_write_b64 v1, v[70:71] offset:11648
    ds_write_b64 v1, v[72:73] offset:11808
    ds_write_b64 v1, v[74:75] offset:11936
    s_waitcnt lgkmcnt(4)
    ds_read_b64_tr_b16 v[52:53], v5 offset:11520
    ds_read_b64_tr_b16 v[54:55], v5 offset:11552
    ds_read_b64_tr_b16 v[56:57], v5 offset:12672
    ds_read_b64_tr_b16 v[58:59], v5 offset:12704
    buffer_store_dwordx4 v[36:39], v3, s[16:19], s27 offen offset:0 nt
    buffer_store_dwordx4 v[40:43], v4, s[16:19], s27 offen offset:0 nt
    s_waitcnt lgkmcnt(0)
    buffer_store_dwordx4 v[52:55], v3, s[16:19], s28 offen offset:0 nt
    buffer_store_dwordx4 v[56:59], v4, s[16:19], s28 offen offset:0 nt
L_end:
    s_endpgm
L_code_end:
L_rare0_0:
    s_nop 15
    s_nop 7
    v_max3_f32 v12, v36, v37, v38
    v_max3_f32 v12, v12, v39, v48
    v_max3_f32 v12, v12, v49, v50
    v_max3_f32 v12, v12, v51, v60
    v_max3_f32 v12, v12, v61, v62
    v_max3_f32 v12, v12, v63, v72
    v_max3_f32 v12, v12, v73, v74
    v_max_f32 v12, v12, v75
    v_mov_b32 v13, v12
    s_nop 1
    v_permlane16_swap_b32 v13, v12
    s_nop 1
    v_max_f32 v12, v13, v12
    v_mov_b32 v13, v12
    s_nop 1
    v_permlane32_swap_b32 v13, v12
    s_nop 1
    v_max_f32 v12, v13, v12
    v_add_f32 v12, 0x42080000, v12
    v_max_f32 v12, 0, v12
    v_sub_f32 v24, v24, v12
    v_sub_f32 v25, v25, v12
    v_sub_f32 v26, v26, v12
    v_sub_f32 v27, v27, v12
    v_exp_f32 v14, -v12
    s_nop 0
    v_mul_f32 v9, v9, v14
    v_and_b32 v13, 48, v0
    ds_bpermute_b32 v20, v13, v14 offset:0
    ds_bpermute_b32 v21, v13, v14 offset:4
    ds_bpermute_b32 v22, v13, v14 offset:8
    ds_bpermute_b32 v23, v13, v14 offset:12
    s_waitcnt lgkmcnt(0)
    v_accvgpr_read_b32 v16, a96
    v_accvgpr_read_b32 v17, a97
    v_accvgpr_read_b32 v18, a98
    v_accvgpr_read_b32 v19, a99
    v_mul_f32 v16, v16, v20
    v_mul_f32 v17, v17, v21
    v_mul_f32 v18, v18, v22
    v_mul_f32 v19, v19, v23
    v_accvgpr_write_b32 a96, v16
    v_accvgpr_write_b32 a97, v17
    v_accvgpr_write_b32 a98, v18
    v_accvgpr_write_b32 a99, v19
    v_accvgpr_read_b32 v16, a108
    v_accvgpr_read_b32 v17, a109
    v_accvgpr_read_b32 v18, a110
    v_accvgpr_read_b32 v19, a111
    v_mul_f32 v16, v16, v20
    v_mul_f32 v17, v17, v21
    v_mul_f32 v18, v18, v22
    v_mul_f32 v19, v19, v23
    v_accvgpr_write_b32 a108, v16
    v_accvgpr_write_b32 a109, v17
    v_accvgpr_write_b32 a110, v18
    v_accvgpr_write_b32 a111, v19
    v_accvgpr_read_b32 v16, a120
    v_accvgpr_read_b32 v17, a121
    v_accvgpr_read_b32 v18, a122
    v_accvgpr_read_b32 v19, a123
    v_mul_f32 v16, v16, v20
    v_mul_f32 v17, v17, v21
    v_mul_f32 v18, v18, v22
    v_mul_f32 v19, v19, v23
    v_accvgpr_write_b32 a120, v16
    v_accvgpr_write_b32 a121, v17
    v_accvgpr_write_b32 a122, v18
    v_accvgpr_write_b32 a123, v19
    v_accvgpr_read_b32 v16, a132
    v_accvgpr_read_b32 v17, a133
    v_accvgpr_read_b32 v18, a134
    v_accvgpr_read_b32 v19, a135
    v_mul_f32 v16, v16, v20
    v_mul_f32 v17, v17, v21
    v_mul_f32 v18, v18, v22
    v_mul_f32 v19, v19, v23
    v_accvgpr_write_b32 a132, v16
    v_accvgpr_write_b32 a133, v17
    v_accvgpr_write_b32 a134, v18
    v_accvgpr_write_b32 a135, v19
    v_accvgpr_read_b32 v16, a144
    v_accvgpr_read_b32 v17, a145
    v_accvgpr_read_b32 v18, a146
    v_accvgpr_read_b32 v19, a147
    v_mul_f32 v16, v16, v20
    v_mul_f32 v17, v17, v21
    v_mul_f32 v18, v18, v22
    v_mul_f32 v19, v19, v23
    v_accvgpr_write_b32 a144, v16
    v_accvgpr_write_b32 a145, v17
    v_accvgpr_write_b32 a146, v18
    v_accvgpr_write_b32 a147, v19
    v_accvgpr_read_b32 v16, a156
    v_accvgpr_read_b32 v17, a157
    v_accvgpr_read_b32 v18, a158
    v_accvgpr_read_b32 v19, a159
    v_mul_f32 v16, v16, v20
    v_mul_f32 v17, v17, v21
    v_mul_f32 v18, v18, v22
    v_mul_f32 v19, v19, v23
    v_accvgpr_write_b32 a156, v16
    v_accvgpr_write_b32 a157, v17
    v_accvgpr_write_b32 a158, v18
    v_accvgpr_write_b32 a159, v19
    v_mul_f32 v136, v136, v20
    v_mul_f32 v137, v137, v21
    v_mul_f32 v138, v138, v22
    v_mul_f32 v139, v139, v23
    v_mul_f32 v148, v148, v20
    v_mul_f32 v149, v149, v21
    v_mul_f32 v150, v150, v22
    v_mul_f32 v151, v151, v23
    v_mul_f32 v160, v160, v20
    v_mul_f32 v161, v161, v21
    v_mul_f32 v162, v162, v22
    v_mul_f32 v163, v163, v23
    v_mul_f32 v172, v172, v20
    v_mul_f32 v173, v173, v21
    v_mul_f32 v174, v174, v22
    v_mul_f32 v175, v175, v23
    v_mul_f32 v184, v184, v20
    v_mul_f32 v185, v185, v21
    v_mul_f32 v186, v186, v22
    v_mul_f32 v187, v187, v23
    v_mul_f32 v196, v196, v20
    v_mul_f32 v197, v197, v21
    v_mul_f32 v198, v198, v22
    v_mul_f32 v199, v199, v23
    v_mul_f32 v208, v208, v20
    v_mul_f32 v209, v209, v21
    v_mul_f32 v210, v210, v22
    v_mul_f32 v211, v211, v23
    v_mul_f32 v220, v220, v20
    v_mul_f32 v221, v221, v21
    v_mul_f32 v222, v222, v22
    v_mul_f32 v223, v223, v23
    v_mul_f32 v232, v232, v20
    v_mul_f32 v233, v233, v21
    v_mul_f32 v234, v234, v22
    v_mul_f32 v235, v235, v23
    v_mul_f32 v244, v244, v20
    v_mul_f32 v245, v245, v21
    v_mul_f32 v246, v246, v22
    v_mul_f32 v247, v247, v23
    v_accvgpr_read_b32 v16, a172
    v_accvgpr_read_b32 v17, a173
    v_accvgpr_read_b32 v18, a174
    v_accvgpr_read_b32 v19, a175
    v_mul_f32 v16, v16, v20
    v_mul_f32 v17, v17, v21
    v_mul_f32 v18, v18, v22
    v_mul_f32 v19, v19, v23
    v_accvgpr_write_b32 a172, v16
    v_accvgpr_write_b32 a173, v17
    v_accvgpr_write_b32 a174, v18
    v_accvgpr_write_b32 a175, v19
    v_sub_f32 v16, v36, v12
    v_sub_f32 v17, v37, v12
    v_sub_f32 v18, v38, v12
    v_sub_f32 v19, v39, v12
    v_exp_f32 v16, v16
    v_exp_f32 v17, v17
    v_exp_f32 v18, v18
    v_exp_f32 v19, v19
    v_add_f32 v6, v16, v17
    v_cvt_pk_bf16_f32 v108, v16, v17
    v_add_f32 v6, v6, v18
    v_add_f32 v6, v6, v19
    v_cvt_pk_bf16_f32 v109, v18, v19
    v_sub_f32 v20, v48, v12
    v_sub_f32 v21, v49, v12
    v_sub_f32 v22, v50, v12
    v_sub_f32 v23, v51, v12
    v_exp_f32 v20, v20
    v_exp_f32 v21, v21
    v_exp_f32 v22, v22
    v_exp_f32 v23, v23
    v_add_f32 v6, v6, v20
    v_add_f32 v6, v6, v21
    v_cvt_pk_bf16_f32 v110, v20, v21
    v_add_f32 v6, v6, v22
    v_add_f32 v6, v6, v23
    v_cvt_pk_bf16_f32 v111, v22, v23
    v_sub_f32 v16, v60, v12
    v_sub_f32 v17, v61, v12
    v_sub_f32 v18, v62, v12
    v_sub_f32 v19, v63, v12
    v_exp_f32 v16, v16
    v_exp_f32 v17, v17
    v_exp_f32 v18, v18
    v_exp_f32 v19, v19
    v_add_f32 v6, v6, v16
    v_add_f32 v6, v6, v17
    v_cvt_pk_bf16_f32 v112, v16, v17
    v_add_f32 v6, v6, v18
    v_add_f32 v6, v6, v19
    v_cvt_pk_bf16_f32 v113, v18, v19
    v_sub_f32 v20, v72, v12
    v_sub_f32 v21, v73, v12
    v_sub_f32 v22, v74, v12
    v_sub_f32 v23, v75, v12
    v_exp_f32 v20, v20
    v_exp_f32 v21, v21
    v_exp_f32 v22, v22
    v_exp_f32 v23, v23
    v_add_f32 v6, v6, v20
    v_add_f32 v6, v6, v21
    v_cvt_pk_bf16_f32 v114, v20, v21
    v_add_f32 v6, v6, v22
    v_add_f32 v6, v6, v23
    v_cvt_pk_bf16_f32 v115, v22, v23
    v_max3_f32 v12, v40, v41, v42
    v_max3_f32 v12, v12, v43, v52
    v_max3_f32 v12, v12, v53, v54
    v_max3_f32 v12, v12, v55, v64
    v_max3_f32 v12, v12, v65, v66
    v_max3_f32 v12, v12, v67, v76
    v_max3_f32 v12, v12, v77, v78
    v_max_f32 v12, v12, v79
    v_mov_b32 v13, v12
    s_nop 1
    v_permlane16_swap_b32 v13, v12
    s_nop 1
    v_max_f32 v12, v13, v12
    v_mov_b32 v13, v12
    s_nop 1
    v_permlane32_swap_b32 v13, v12
    s_nop 1
    v_max_f32 v12, v13, v12
    v_add_f32 v12, 0x42080000, v12
    v_max_f32 v12, 0, v12
    v_sub_f32 v28, v28, v12
    v_sub_f32 v29, v29, v12
    v_sub_f32 v30, v30, v12
    v_sub_f32 v31, v31, v12
    v_exp_f32 v14, -v12
    s_nop 0
    v_mul_f32 v10, v10, v14
    v_and_b32 v13, 48, v0
    ds_bpermute_b32 v20, v13, v14 offset:0
    ds_bpermute_b32 v21, v13, v14 offset:4
    ds_bpermute_b32 v22, v13, v14 offset:8
    ds_bpermute_b32 v23, v13, v14 offset:12
    s_waitcnt lgkmcnt(0)
    v_accvgpr_read_b32 v16, a100
    v_accvgpr_read_b32 v17, a101
    v_accvgpr_read_b32 v18, a102
    v_accvgpr_read_b32 v19, a103
    v_mul_f32 v16, v16, v20
    v_mul_f32 v17, v17, v21
    v_mul_f32 v18, v18, v22
    v_mul_f32 v19, v19, v23
    v_accvgpr_write_b32 a100, v16
    v_accvgpr_write_b32 a101, v17
    v_accvgpr_write_b32 a102, v18
    v_accvgpr_write_b32 a103, v19
    v_accvgpr_read_b32 v16, a112
    v_accvgpr_read_b32 v17, a113
    v_accvgpr_read_b32 v18, a114
    v_accvgpr_read_b32 v19, a115
    v_mul_f32 v16, v16, v20
    v_mul_f32 v17, v17, v21
    v_mul_f32 v18, v18, v22
    v_mul_f32 v19, v19, v23
    v_accvgpr_write_b32 a112, v16
    v_accvgpr_write_b32 a113, v17
    v_accvgpr_write_b32 a114, v18
    v_accvgpr_write_b32 a115, v19
    v_accvgpr_read_b32 v16, a124
    v_accvgpr_read_b32 v17, a125
    v_accvgpr_read_b32 v18, a126
    v_accvgpr_read_b32 v19, a127
    v_mul_f32 v16, v16, v20
    v_mul_f32 v17, v17, v21
    v_mul_f32 v18, v18, v22
    v_mul_f32 v19, v19, v23
    v_accvgpr_write_b32 a124, v16
    v_accvgpr_write_b32 a125, v17
    v_accvgpr_write_b32 a126, v18
    v_accvgpr_write_b32 a127, v19
    v_accvgpr_read_b32 v16, a136
    v_accvgpr_read_b32 v17, a137
    v_accvgpr_read_b32 v18, a138
    v_accvgpr_read_b32 v19, a139
    v_mul_f32 v16, v16, v20
    v_mul_f32 v17, v17, v21
    v_mul_f32 v18, v18, v22
    v_mul_f32 v19, v19, v23
    v_accvgpr_write_b32 a136, v16
    v_accvgpr_write_b32 a137, v17
    v_accvgpr_write_b32 a138, v18
    v_accvgpr_write_b32 a139, v19
    v_accvgpr_read_b32 v16, a148
    v_accvgpr_read_b32 v17, a149
    v_accvgpr_read_b32 v18, a150
    v_accvgpr_read_b32 v19, a151
    v_mul_f32 v16, v16, v20
    v_mul_f32 v17, v17, v21
    v_mul_f32 v18, v18, v22
    v_mul_f32 v19, v19, v23
    v_accvgpr_write_b32 a148, v16
    v_accvgpr_write_b32 a149, v17
    v_accvgpr_write_b32 a150, v18
    v_accvgpr_write_b32 a151, v19
    v_accvgpr_read_b32 v16, a160
    v_accvgpr_read_b32 v17, a161
    v_accvgpr_read_b32 v18, a162
    v_accvgpr_read_b32 v19, a163
    v_mul_f32 v16, v16, v20
    v_mul_f32 v17, v17, v21
    v_mul_f32 v18, v18, v22
    v_mul_f32 v19, v19, v23
    v_accvgpr_write_b32 a160, v16
    v_accvgpr_write_b32 a161, v17
    v_accvgpr_write_b32 a162, v18
    v_accvgpr_write_b32 a163, v19
    v_mul_f32 v140, v140, v20
    v_mul_f32 v141, v141, v21
    v_mul_f32 v142, v142, v22
    v_mul_f32 v143, v143, v23
    v_mul_f32 v152, v152, v20
    v_mul_f32 v153, v153, v21
    v_mul_f32 v154, v154, v22
    v_mul_f32 v155, v155, v23
    v_mul_f32 v164, v164, v20
    v_mul_f32 v165, v165, v21
    v_mul_f32 v166, v166, v22
    v_mul_f32 v167, v167, v23
    v_mul_f32 v176, v176, v20
    v_mul_f32 v177, v177, v21
    v_mul_f32 v178, v178, v22
    v_mul_f32 v179, v179, v23
    v_mul_f32 v188, v188, v20
    v_mul_f32 v189, v189, v21
    v_mul_f32 v190, v190, v22
    v_mul_f32 v191, v191, v23
    v_mul_f32 v200, v200, v20
    v_mul_f32 v201, v201, v21
    v_mul_f32 v202, v202, v22
    v_mul_f32 v203, v203, v23
    v_mul_f32 v212, v212, v20
    v_mul_f32 v213, v213, v21
    v_mul_f32 v214, v214, v22
    v_mul_f32 v215, v215, v23
    v_mul_f32 v224, v224, v20
    v_mul_f32 v225, v225, v21
    v_mul_f32 v226, v226, v22
    v_mul_f32 v227, v227, v23
    v_mul_f32 v236, v236, v20
    v_mul_f32 v237, v237, v21
    v_mul_f32 v238, v238, v22
    v_mul_f32 v239, v239, v23
    v_mul_f32 v248, v248, v20
    v_mul_f32 v249, v249, v21
    v_mul_f32 v250, v250, v22
    v_mul_f32 v251, v251, v23
    v_accvgpr_read_b32 v16, a176
    v_accvgpr_read_b32 v17, a177
    v_accvgpr_read_b32 v18, a178
    v_accvgpr_read_b32 v19, a179
    v_mul_f32 v16, v16, v20
    v_mul_f32 v17, v17, v21
    v_mul_f32 v18, v18, v22
    v_mul_f32 v19, v19, v23
    v_accvgpr_write_b32 a176, v16
    v_accvgpr_write_b32 a177, v17
    v_accvgpr_write_b32 a178, v18
    v_accvgpr_write_b32 a179, v19
    v_sub_f32 v16, v40, v12
    v_sub_f32 v17, v41, v12
    v_sub_f32 v18, v42, v12
    v_sub_f32 v19, v43, v12
    v_exp_f32 v16, v16
    v_exp_f32 v17, v17
    v_exp_f32 v18, v18
    v_exp_f32 v19, v19
    v_add_f32 v7, v16, v17
    v_cvt_pk_bf16_f32 v116, v16, v17
    v_add_f32 v7, v7, v18
    v_add_f32 v7, v7, v19
    v_cvt_pk_bf16_f32 v117, v18, v19
    v_sub_f32 v20, v52, v12
    v_sub_f32 v21, v53, v12
    v_sub_f32 v22, v54, v12
    v_sub_f32 v23, v55, v12
    v_exp_f32 v20, v20
    v_exp_f32 v21, v21
    v_exp_f32 v22, v22
    v_exp_f32 v23, v23
    v_add_f32 v7, v7, v20
    v_add_f32 v7, v7, v21
    v_cvt_pk_bf16_f32 v118, v20, v21
    v_add_f32 v7, v7, v22
    v_add_f32 v7, v7, v23
    v_cvt_pk_bf16_f32 v119, v22, v23
    v_sub_f32 v16, v64, v12
    v_sub_f32 v17, v65, v12
    v_sub_f32 v18, v66, v12
    v_sub_f32 v19, v67, v12
    v_exp_f32 v16, v16
    v_exp_f32 v17, v17
    v_exp_f32 v18, v18
    v_exp_f32 v19, v19
    v_add_f32 v7, v7, v16
    v_add_f32 v7, v7, v17
    v_cvt_pk_bf16_f32 v120, v16, v17
    v_add_f32 v7, v7, v18
    v_add_f32 v7, v7, v19
    v_cvt_pk_bf16_f32 v121, v18, v19
    v_sub_f32 v20, v76, v12
    v_sub_f32 v21, v77, v12
    v_sub_f32 v22, v78, v12
    v_sub_f32 v23, v79, v12
    v_exp_f32 v20, v20
    v_exp_f32 v21, v21
    v_exp_f32 v22, v22
    v_exp_f32 v23, v23
    v_add_f32 v7, v7, v20
    v_add_f32 v7, v7, v21
    v_cvt_pk_bf16_f32 v122, v20, v21
    v_add_f32 v7, v7, v22
    v_add_f32 v7, v7, v23
    v_cvt_pk_bf16_f32 v123, v22, v23
    v_max3_f32 v12, v44, v45, v46
    v_max3_f32 v12, v12, v47, v56
    v_max3_f32 v12, v12, v57, v58
    v_max3_f32 v12, v12, v59, v68
    v_max3_f32 v12, v12, v69, v70
    v_max3_f32 v12, v12, v71, v80
    v_max3_f32 v12, v12, v81, v82
    v_max_f32 v12, v12, v83
    v_mov_b32 v13, v12
    s_nop 1
    v_permlane16_swap_b32 v13, v12
    s_nop 1
    v_max_f32 v12, v13, v12
    v_mov_b32 v13, v12
    s_nop 1
    v_permlane32_swap_b32 v13, v12
    s_nop 1
    v_max_f32 v12, v13, v12
    v_add_f32 v12, 0x42080000, v12
    v_max_f32 v12, 0, v12
    v_sub_f32 v32, v32, v12
    v_sub_f32 v33, v33, v12
    v_sub_f32 v34, v34, v12
    v_sub_f32 v35, v35, v12
    v_exp_f32 v14, -v12
    s_nop 0
    v_mul_f32 v11, v11, v14
    v_and_b32 v13, 48, v0
    ds_bpermute_b32 v20, v13, v14 offset:0
    ds_bpermute_b32 v21, v13, v14 offset:4
    ds_bpermute_b32 v22, v13, v14 offset:8
    ds_bpermute_b32 v23, v13, v14 offset:12
    s_waitcnt lgkmcnt(0)
    v_accvgpr_read_b32 v16, a104
    v_accvgpr_read_b32 v17, a105
    v_accvgpr_read_b32 v18, a106
    v_accvgpr_read_b32 v19, a107
    v_mul_f32 v16, v16, v20
    v_mul_f32 v17, v17, v21
    v_mul_f32 v18, v18, v22
    v_mul_f32 v19, v19, v23
    v_accvgpr_write_b32 a104, v16
    v_accvgpr_write_b32 a105, v17
    v_accvgpr_write_b32 a106, v18
    v_accvgpr_write_b32 a107, v19
    v_accvgpr_read_b32 v16, a116
    v_accvgpr_read_b32 v17, a117
    v_accvgpr_read_b32 v18, a118
    v_accvgpr_read_b32 v19, a119
    v_mul_f32 v16, v16, v20
    v_mul_f32 v17, v17, v21
    v_mul_f32 v18, v18, v22
    v_mul_f32 v19, v19, v23
    v_accvgpr_write_b32 a116, v16
    v_accvgpr_write_b32 a117, v17
    v_accvgpr_write_b32 a118, v18
    v_accvgpr_write_b32 a119, v19
    v_accvgpr_read_b32 v16, a128
    v_accvgpr_read_b32 v17, a129
    v_accvgpr_read_b32 v18, a130
    v_accvgpr_read_b32 v19, a131
    v_mul_f32 v16, v16, v20
    v_mul_f32 v17, v17, v21
    v_mul_f32 v18, v18, v22
    v_mul_f32 v19, v19, v23
    v_accvgpr_write_b32 a128, v16
    v_accvgpr_write_b32 a129, v17
    v_accvgpr_write_b32 a130, v18
    v_accvgpr_write_b32 a131, v19
    v_accvgpr_read_b32 v16, a140
    v_accvgpr_read_b32 v17, a141
    v_accvgpr_read_b32 v18, a142
    v_accvgpr_read_b32 v19, a143
    v_mul_f32 v16, v16, v20
    v_mul_f32 v17, v17, v21
    v_mul_f32 v18, v18, v22
    v_mul_f32 v19, v19, v23
    v_accvgpr_write_b32 a140, v16
    v_accvgpr_write_b32 a141, v17
    v_accvgpr_write_b32 a142, v18
    v_accvgpr_write_b32 a143, v19
    v_accvgpr_read_b32 v16, a152
    v_accvgpr_read_b32 v17, a153
    v_accvgpr_read_b32 v18, a154
    v_accvgpr_read_b32 v19, a155
    v_mul_f32 v16, v16, v20
    v_mul_f32 v17, v17, v21
    v_mul_f32 v18, v18, v22
    v_mul_f32 v19, v19, v23
    v_accvgpr_write_b32 a152, v16
    v_accvgpr_write_b32 a153, v17
    v_accvgpr_write_b32 a154, v18
    v_accvgpr_write_b32 a155, v19
    v_mul_f32 v132, v132, v20
    v_mul_f32 v133, v133, v21
    v_mul_f32 v134, v134, v22
    v_mul_f32 v135, v135, v23
    v_mul_f32 v144, v144, v20
    v_mul_f32 v145, v145, v21
    v_mul_f32 v146, v146, v22
    v_mul_f32 v147, v147, v23
    v_mul_f32 v156, v156, v20
    v_mul_f32 v157, v157, v21
    v_mul_f32 v158, v158, v22
    v_mul_f32 v159, v159, v23
    v_mul_f32 v168, v168, v20
    v_mul_f32 v169, v169, v21
    v_mul_f32 v170, v170, v22
    v_mul_f32 v171, v171, v23
    v_mul_f32 v180, v180, v20
    v_mul_f32 v181, v181, v21
    v_mul_f32 v182, v182, v22
    v_mul_f32 v183, v183, v23
    v_mul_f32 v192, v192, v20
    v_mul_f32 v193, v193, v21
    v_mul_f32 v194, v194, v22
    v_mul_f32 v195, v195, v23
    v_mul_f32 v204, v204, v20
    v_mul_f32 v205, v205, v21
    v_mul_f32 v206, v206, v22
    v_mul_f32 v207, v207, v23
    v_mul_f32 v216, v216, v20
    v_mul_f32 v217, v217, v21
    v_mul_f32 v218, v218, v22
    v_mul_f32 v219, v219, v23
    v_mul_f32 v228, v228, v20
    v_mul_f32 v229, v229, v21
    v_mul_f32 v230, v230, v22
    v_mul_f32 v231, v231, v23
    v_mul_f32 v240, v240, v20
    v_mul_f32 v241, v241, v21
    v_mul_f32 v242, v242, v22
    v_mul_f32 v243, v243, v23
    v_mul_f32 v252, v252, v20
    v_mul_f32 v253, v253, v21
    v_mul_f32 v254, v254, v22
    v_mul_f32 v255, v255, v23
    v_accvgpr_read_b32 v16, a180
    v_accvgpr_read_b32 v17, a181
    v_accvgpr_read_b32 v18, a182
    v_accvgpr_read_b32 v19, a183
    v_mul_f32 v16, v16, v20
    v_mul_f32 v17, v17, v21
    v_mul_f32 v18, v18, v22
    v_mul_f32 v19, v19, v23
    v_accvgpr_write_b32 a180, v16
    v_accvgpr_write_b32 a181, v17
    v_accvgpr_write_b32 a182, v18
    v_accvgpr_write_b32 a183, v19
    v_sub_f32 v16, v44, v12
    v_sub_f32 v17, v45, v12
    v_sub_f32 v18, v46, v12
    v_sub_f32 v19, v47, v12
    v_exp_f32 v16, v16
    v_exp_f32 v17, v17
    v_exp_f32 v18, v18
    v_exp_f32 v19, v19
    v_add_f32 v8, v16, v17
    v_cvt_pk_bf16_f32 v124, v16, v17
    v_add_f32 v8, v8, v18
    v_add_f32 v8, v8, v19
    v_cvt_pk_bf16_f32 v125, v18, v19
    v_sub_f32 v20, v56, v12
    v_sub_f32 v21, v57, v12
    v_sub_f32 v22, v58, v12
    v_sub_f32 v23, v59, v12
    v_exp_f32 v20, v20
    v_exp_f32 v21, v21
    v_exp_f32 v22, v22
    v_exp_f32 v23, v23
    v_add_f32 v8, v8, v20
    v_add_f32 v8, v8, v21
    v_cvt_pk_bf16_f32 v126, v20, v21
    v_add_f32 v8, v8, v22
    v_add_f32 v8, v8, v23
    v_cvt_pk_bf16_f32 v127, v22, v23
    v_sub_f32 v16, v68, v12
    v_sub_f32 v17, v69, v12
    v_sub_f32 v18, v70, v12
    v_sub_f32 v19, v71, v12
    v_exp_f32 v16, v16
    v_exp_f32 v17, v17
    v_exp_f32 v18, v18
    v_exp_f32 v19, v19
    v_add_f32 v8, v8, v16
    v_add_f32 v8, v8, v17
    v_cvt_pk_bf16_f32 v128, v16, v17
    v_add_f32 v8, v8, v18
    v_add_f32 v8, v8, v19
    v_cvt_pk_bf16_f32 v129, v18, v19
    v_sub_f32 v20, v80, v12
    v_sub_f32 v21, v81, v12
    v_sub_f32 v22, v82, v12
    v_sub_f32 v23, v83, v12
    v_exp_f32 v20, v20
    v_exp_f32 v21, v21
    v_exp_f32 v22, v22
    v_exp_f32 v23, v23
    v_add_f32 v8, v8, v20
    v_add_f32 v8, v8, v21
    v_cvt_pk_bf16_f32 v130, v20, v21
    v_add_f32 v8, v8, v22
    v_add_f32 v8, v8, v23
    v_cvt_pk_bf16_f32 v131, v22, v23
    s_nop 3
    s_branch L_j0_0
L_rare1_0:
    s_nop 15
    s_nop 7
    v_max3_f32 v12, v36, v37, v38
    v_max3_f32 v12, v12, v39, v48
    v_max3_f32 v12, v12, v49, v50
    v_max3_f32 v12, v12, v51, v60
    v_max3_f32 v12, v12, v61, v62
    v_max3_f32 v12, v12, v63, v72
    v_max3_f32 v12, v12, v73, v74
    v_max_f32 v12, v12, v75
    v_mov_b32 v13, v12
    s_nop 1
    v_permlane16_swap_b32 v13, v12
    s_nop 1
    v_max_f32 v12, v13, v12
    v_mov_b32 v13, v12
    s_nop 1
    v_permlane32_swap_b32 v13, v12
    s_nop 1
    v_max_f32 v12, v13, v12
    v_add_f32 v12, 0x42080000, v12
    v_max_f32 v12, 0, v12
    v_sub_f32 v24, v24, v12
    v_sub_f32 v25, v25, v12
    v_sub_f32 v26, v26, v12
    v_sub_f32 v27, v27, v12
    v_exp_f32 v14, -v12
    s_nop 0
    v_mul_f32 v9, v9, v14
    v_and_b32 v13, 48, v0
    ds_bpermute_b32 v20, v13, v14 offset:0
    ds_bpermute_b32 v21, v13, v14 offset:4
    ds_bpermute_b32 v22, v13, v14 offset:8
    ds_bpermute_b32 v23, v13, v14 offset:12
    s_waitcnt lgkmcnt(0)
    v_accvgpr_read_b32 v16, a96
    v_accvgpr_read_b32 v17, a97
    v_accvgpr_read_b32 v18, a98
    v_accvgpr_read_b32 v19, a99
    v_mul_f32 v16, v16, v20
    v_mul_f32 v17, v17, v21
    v_mul_f32 v18, v18, v22
    v_mul_f32 v19, v19, v23
    v_accvgpr_write_b32 a96, v16
    v_accvgpr_write_b32 a97, v17
    v_accvgpr_write_b32 a98, v18
    v_accvgpr_write_b32 a99, v19
    v_accvgpr_read_b32 v16, a108
    v_accvgpr_read_b32 v17, a109
    v_accvgpr_read_b32 v18, a110
    v_accvgpr_read_b32 v19, a111
    v_mul_f32 v16, v16, v20
    v_mul_f32 v17, v17, v21
    v_mul_f32 v18, v18, v22
    v_mul_f32 v19, v19, v23
    v_accvgpr_write_b32 a108, v16
    v_accvgpr_write_b32 a109, v17
    v_accvgpr_write_b32 a110, v18
    v_accvgpr_write_b32 a111, v19
    v_accvgpr_read_b32 v16, a120
    v_accvgpr_read_b32 v17, a121
    v_accvgpr_read_b32 v18, a122
    v_accvgpr_read_b32 v19, a123
    v_mul_f32 v16, v16, v20
    v_mul_f32 v17, v17, v21
    v_mul_f32 v18, v18, v22
    v_mul_f32 v19, v19, v23
    v_accvgpr_write_b32 a120, v16
    v_accvgpr_write_b32 a121, v17
    v_accvgpr_write_b32 a122, v18
    v_accvgpr_write_b32 a123, v19
    v_accvgpr_read_b32 v16, a132
    v_accvgpr_read_b32 v17, a133
    v_accvgpr_read_b32 v18, a134
    v_accvgpr_read_b32 v19, a135
    v_mul_f32 v16, v16, v20
    v_mul_f32 v17, v17, v21
    v_mul_f32 v18, v18, v22
    v_mul_f32 v19, v19, v23
    v_accvgpr_write_b32 a132, v16
    v_accvgpr_write_b32 a133, v17
    v_accvgpr_write_b32 a134, v18
    v_accvgpr_write_b32 a135, v19
    v_accvgpr_read_b32 v16, a144
    v_accvgpr_read_b32 v17, a145
    v_accvgpr_read_b32 v18, a146
    v_accvgpr_read_b32 v19, a147
    v_mul_f32 v16, v16, v20
    v_mul_f32 v17, v17, v21
    v_mul_f32 v18, v18, v22
    v_mul_f32 v19, v19, v23
    v_accvgpr_write_b32 a144, v16
    v_accvgpr_write_b32 a145, v17
    v_accvgpr_write_b32 a146, v18
    v_accvgpr_write_b32 a147, v19
    v_accvgpr_read_b32 v16, a156
    v_accvgpr_read_b32 v17, a157
    v_accvgpr_read_b32 v18, a158
    v_accvgpr_read_b32 v19, a159
    v_mul_f32 v16, v16, v20
    v_mul_f32 v17, v17, v21
    v_mul_f32 v18, v18, v22
    v_mul_f32 v19, v19, v23
    v_accvgpr_write_b32 a156, v16
    v_accvgpr_write_b32 a157, v17
    v_accvgpr_write_b32 a158, v18
    v_accvgpr_write_b32 a159, v19
    v_mul_f32 v136, v136, v20
    v_mul_f32 v137, v137, v21
    v_mul_f32 v138, v138, v22
    v_mul_f32 v139, v139, v23
    v_mul_f32 v148, v148, v20
    v_mul_f32 v149, v149, v21
    v_mul_f32 v150, v150, v22
    v_mul_f32 v151, v151, v23
    v_mul_f32 v160, v160, v20
    v_mul_f32 v161, v161, v21
    v_mul_f32 v162, v162, v22
    v_mul_f32 v163, v163, v23
    v_mul_f32 v172, v172, v20
    v_mul_f32 v173, v173, v21
    v_mul_f32 v174, v174, v22
    v_mul_f32 v175, v175, v23
    v_mul_f32 v184, v184, v20
    v_mul_f32 v185, v185, v21
    v_mul_f32 v186, v186, v22
    v_mul_f32 v187, v187, v23
    v_mul_f32 v196, v196, v20
    v_mul_f32 v197, v197, v21
    v_mul_f32 v198, v198, v22
    v_mul_f32 v199, v199, v23
    v_mul_f32 v208, v208, v20
    v_mul_f32 v209, v209, v21
    v_mul_f32 v210, v210, v22
    v_mul_f32 v211, v211, v23
    v_mul_f32 v220, v220, v20
    v_mul_f32 v221, v221, v21
    v_mul_f32 v222, v222, v22
    v_mul_f32 v223, v223, v23
    v_mul_f32 v232, v232, v20
    v_mul_f32 v233, v233, v21
    v_mul_f32 v234, v234, v22
    v_mul_f32 v235, v235, v23
    v_mul_f32 v244, v244, v20
    v_mul_f32 v245, v245, v21
    v_mul_f32 v246, v246, v22
    v_mul_f32 v247, v247, v23
    v_accvgpr_read_b32 v16, a172
    v_accvgpr_read_b32 v17, a173
    v_accvgpr_read_b32 v18, a174
    v_accvgpr_read_b32 v19, a175
    v_mul_f32 v16, v16, v20
    v_mul_f32 v17, v17, v21
    v_mul_f32 v18, v18, v22
    v_mul_f32 v19, v19, v23
    v_accvgpr_write_b32 a172, v16
    v_accvgpr_write_b32 a173, v17
    v_accvgpr_write_b32 a174, v18
    v_accvgpr_write_b32 a175, v19
    v_sub_f32 v16, v36, v12
    v_sub_f32 v17, v37, v12
    v_sub_f32 v18, v38, v12
    v_sub_f32 v19, v39, v12
    v_exp_f32 v16, v16
    v_exp_f32 v17, v17
    v_exp_f32 v18, v18
    v_exp_f32 v19, v19
    v_add_f32 v6, v16, v17
    v_cvt_pk_bf16_f32 v84, v16, v17
    v_add_f32 v6, v6, v18
    v_add_f32 v6, v6, v19
    v_cvt_pk_bf16_f32 v85, v18, v19
    v_sub_f32 v20, v48, v12
    v_sub_f32 v21, v49, v12
    v_sub_f32 v22, v50, v12
    v_sub_f32 v23, v51, v12
    v_exp_f32 v20, v20
    v_exp_f32 v21, v21
    v_exp_f32 v22, v22
    v_exp_f32 v23, v23
    v_add_f32 v6, v6, v20
    v_add_f32 v6, v6, v21
    v_cvt_pk_bf16_f32 v86, v20, v21
    v_add_f32 v6, v6, v22
    v_add_f32 v6, v6, v23
    v_cvt_pk_bf16_f32 v87, v22, v23
    v_sub_f32 v16, v60, v12
    v_sub_f32 v17, v61, v12
    v_sub_f32 v18, v62, v12
    v_sub_f32 v19, v63, v12
    v_exp_f32 v16, v16
    v_exp_f32 v17, v17
    v_exp_f32 v18, v18
    v_exp_f32 v19, v19
    v_add_f32 v6, v6, v16
    v_add_f32 v6, v6, v17
    v_cvt_pk_bf16_f32 v88, v16, v17
    v_add_f32 v6, v6, v18
    v_add_f32 v6, v6, v19
    v_cvt_pk_bf16_f32 v89, v18, v19
    v_sub_f32 v20, v72, v12
    v_sub_f32 v21, v73, v12
    v_sub_f32 v22, v74, v12
    v_sub_f32 v23, v75, v12
    v_exp_f32 v20, v20
    v_exp_f32 v21, v21
    v_exp_f32 v22, v22
    v_exp_f32 v23, v23
    v_add_f32 v6, v6, v20
    v_add_f32 v6, v6, v21
    v_cvt_pk_bf16_f32 v90, v20, v21
    v_add_f32 v6, v6, v22
    v_add_f32 v6, v6, v23
    v_cvt_pk_bf16_f32 v91, v22, v23
    v_max3_f32 v12, v40, v41, v42
    v_max3_f32 v12, v12, v43, v52
    v_max3_f32 v12, v12, v53, v54
    v_max3_f32 v12, v12, v55, v64
    v_max3_f32 v12, v12, v65, v66
    v_max3_f32 v12, v12, v67, v76
    v_max3_f32 v12, v12, v77, v78
    v_max_f32 v12, v12, v79
    v_mov_b32 v13, v12
    s_nop 1
    v_permlane16_swap_b32 v13, v12
    s_nop 1
    v_max_f32 v12, v13, v12
    v_mov_b32 v13, v12
    s_nop 1
    v_permlane32_swap_b32 v13, v12
    s_nop 1
    v_max_f32 v12, v13, v12
    v_add_f32 v12, 0x42080000, v12
    v_max_f32 v12, 0, v12
    v_sub_f32 v28, v28, v12
    v_sub_f32 v29, v29, v12
    v_sub_f32 v30, v30, v12
    v_sub_f32 v31, v31, v12
    v_exp_f32 v14, -v12
    s_nop 0
    v_mul_f32 v10, v10, v14
    v_and_b32 v13, 48, v0
    ds_bpermute_b32 v20, v13, v14 offset:0
    ds_bpermute_b32 v21, v13, v14 offset:4
    ds_bpermute_b32 v22, v13, v14 offset:8
    ds_bpermute_b32 v23, v13, v14 offset:12
    s_waitcnt lgkmcnt(0)
    v_accvgpr_read_b32 v16, a100
    v_accvgpr_read_b32 v17, a101
    v_accvgpr_read_b32 v18, a102
    v_accvgpr_read_b32 v19, a103
    v_mul_f32 v16, v16, v20
    v_mul_f32 v17, v17, v21
    v_mul_f32 v18, v18, v22
    v_mul_f32 v19, v19, v23
    v_accvgpr_write_b32 a100, v16
    v_accvgpr_write_b32 a101, v17
    v_accvgpr_write_b32 a102, v18
    v_accvgpr_write_b32 a103, v19
    v_accvgpr_read_b32 v16, a112
    v_accvgpr_read_b32 v17, a113
    v_accvgpr_read_b32 v18, a114
    v_accvgpr_read_b32 v19, a115
    v_mul_f32 v16, v16, v20
    v_mul_f32 v17, v17, v21
    v_mul_f32 v18, v18, v22
    v_mul_f32 v19, v19, v23
    v_accvgpr_write_b32 a112, v16
    v_accvgpr_write_b32 a113, v17
    v_accvgpr_write_b32 a114, v18
    v_accvgpr_write_b32 a115, v19
    v_accvgpr_read_b32 v16, a124
    v_accvgpr_read_b32 v17, a125
    v_accvgpr_read_b32 v18, a126
    v_accvgpr_read_b32 v19, a127
    v_mul_f32 v16, v16, v20
    v_mul_f32 v17, v17, v21
    v_mul_f32 v18, v18, v22
    v_mul_f32 v19, v19, v23
    v_accvgpr_write_b32 a124, v16
    v_accvgpr_write_b32 a125, v17
    v_accvgpr_write_b32 a126, v18
    v_accvgpr_write_b32 a127, v19
    v_accvgpr_read_b32 v16, a136
    v_accvgpr_read_b32 v17, a137
    v_accvgpr_read_b32 v18, a138
    v_accvgpr_read_b32 v19, a139
    v_mul_f32 v16, v16, v20
    v_mul_f32 v17, v17, v21
    v_mul_f32 v18, v18, v22
    v_mul_f32 v19, v19, v23
    v_accvgpr_write_b32 a136, v16
    v_accvgpr_write_b32 a137, v17
    v_accvgpr_write_b32 a138, v18
    v_accvgpr_write_b32 a139, v19
    v_accvgpr_read_b32 v16, a148
    v_accvgpr_read_b32 v17, a149
    v_accvgpr_read_b32 v18, a150
    v_accvgpr_read_b32 v19, a151
    v_mul_f32 v16, v16, v20
    v_mul_f32 v17, v17, v21
    v_mul_f32 v18, v18, v22
    v_mul_f32 v19, v19, v23
    v_accvgpr_write_b32 a148, v16
    v_accvgpr_write_b32 a149, v17
    v_accvgpr_write_b32 a150, v18
    v_accvgpr_write_b32 a151, v19
    v_accvgpr_read_b32 v16, a160
    v_accvgpr_read_b32 v17, a161
    v_accvgpr_read_b32 v18, a162
    v_accvgpr_read_b32 v19, a163
    v_mul_f32 v16, v16, v20
    v_mul_f32 v17, v17, v21
    v_mul_f32 v18, v18, v22
    v_mul_f32 v19, v19, v23
    v_accvgpr_write_b32 a160, v16
    v_accvgpr_write_b32 a161, v17
    v_accvgpr_write_b32 a162, v18
    v_accvgpr_write_b32 a163, v19
    v_mul_f32 v140, v140, v20
    v_mul_f32 v141, v141, v21
    v_mul_f32 v142, v142, v22
    v_mul_f32 v143, v143, v23
    v_mul_f32 v152, v152, v20
    v_mul_f32 v153, v153, v21
    v_mul_f32 v154, v154, v22
    v_mul_f32 v155, v155, v23
    v_mul_f32 v164, v164, v20
    v_mul_f32 v165, v165, v21
    v_mul_f32 v166, v166, v22
    v_mul_f32 v167, v167, v23
    v_mul_f32 v176, v176, v20
    v_mul_f32 v177, v177, v21
    v_mul_f32 v178, v178, v22
    v_mul_f32 v179, v179, v23
    v_mul_f32 v188, v188, v20
    v_mul_f32 v189, v189, v21
    v_mul_f32 v190, v190, v22
    v_mul_f32 v191, v191, v23
    v_mul_f32 v200, v200, v20
    v_mul_f32 v201, v201, v21
    v_mul_f32 v202, v202, v22
    v_mul_f32 v203, v203, v23
    v_mul_f32 v212, v212, v20
    v_mul_f32 v213, v213, v21
    v_mul_f32 v214, v214, v22
    v_mul_f32 v215, v215, v23
    v_mul_f32 v224, v224, v20
    v_mul_f32 v225, v225, v21
    v_mul_f32 v226, v226, v22
    v_mul_f32 v227, v227, v23
    v_mul_f32 v236, v236, v20
    v_mul_f32 v237, v237, v21
    v_mul_f32 v238, v238, v22
    v_mul_f32 v239, v239, v23
    v_mul_f32 v248, v248, v20
    v_mul_f32 v249, v249, v21
    v_mul_f32 v250, v250, v22
    v_mul_f32 v251, v251, v23
    v_accvgpr_read_b32 v16, a176
    v_accvgpr_read_b32 v17, a177
    v_accvgpr_read_b32 v18, a178
    v_accvgpr_read_b32 v19, a179
    v_mul_f32 v16, v16, v20
    v_mul_f32 v17, v17, v21
    v_mul_f32 v18, v18, v22
    v_mul_f32 v19, v19, v23
    v_accvgpr_write_b32 a176, v16
    v_accvgpr_write_b32 a177, v17
    v_accvgpr_write_b32 a178, v18
    v_accvgpr_write_b32 a179, v19
    v_sub_f32 v16, v40, v12
    v_sub_f32 v17, v41, v12
    v_sub_f32 v18, v42, v12
    v_sub_f32 v19, v43, v12
    v_exp_f32 v16, v16
    v_exp_f32 v17, v17
    v_exp_f32 v18, v18
    v_exp_f32 v19, v19
    v_add_f32 v7, v16, v17
    v_cvt_pk_bf16_f32 v92, v16, v17
    v_add_f32 v7, v7, v18
    v_add_f32 v7, v7, v19
    v_cvt_pk_bf16_f32 v93, v18, v19
    v_sub_f32 v20, v52, v12
    v_sub_f32 v21, v53, v12
    v_sub_f32 v22, v54, v12
    v_sub_f32 v23, v55, v12
    v_exp_f32 v20, v20
    v_exp_f32 v21, v21
    v_exp_f32 v22, v22
    v_exp_f32 v23, v23
    v_add_f32 v7, v7, v20
    v_add_f32 v7, v7, v21
    v_cvt_pk_bf16_f32 v94, v20, v21
    v_add_f32 v7, v7, v22
    v_add_f32 v7, v7, v23
    v_cvt_pk_bf16_f32 v95, v22, v23
    v_sub_f32 v16, v64, v12
    v_sub_f32 v17, v65, v12
    v_sub_f32 v18, v66, v12
    v_sub_f32 v19, v67, v12
    v_exp_f32 v16, v16
    v_exp_f32 v17, v17
    v_exp_f32 v18, v18
    v_exp_f32 v19, v19
    v_add_f32 v7, v7, v16
    v_add_f32 v7, v7, v17
    v_cvt_pk_bf16_f32 v96, v16, v17
    v_add_f32 v7, v7, v18
    v_add_f32 v7, v7, v19
    v_cvt_pk_bf16_f32 v97, v18, v19
    v_sub_f32 v20, v76, v12
    v_sub_f32 v21, v77, v12
    v_sub_f32 v22, v78, v12
    v_sub_f32 v23, v79, v12
    v_exp_f32 v20, v20
    v_exp_f32 v21, v21
    v_exp_f32 v22, v22
    v_exp_f32 v23, v23
    v_add_f32 v7, v7, v20
    v_add_f32 v7, v7, v21
    v_cvt_pk_bf16_f32 v98, v20, v21
    v_add_f32 v7, v7, v22
    v_add_f32 v7, v7, v23
    v_cvt_pk_bf16_f32 v99, v22, v23
    v_max3_f32 v12, v44, v45, v46
    v_max3_f32 v12, v12, v47, v56
    v_max3_f32 v12, v12, v57, v58
    v_max3_f32 v12, v12, v59, v68
    v_max3_f32 v12, v12, v69, v70
    v_max3_f32 v12, v12, v71, v80
    v_max3_f32 v12, v12, v81, v82
    v_max_f32 v12, v12, v83
    v_mov_b32 v13, v12
    s_nop 1
    v_permlane16_swap_b32 v13, v12
    s_nop 1
    v_max_f32 v12, v13, v12
    v_mov_b32 v13, v12
    s_nop 1
    v_permlane32_swap_b32 v13, v12
    s_nop 1
    v_max_f32 v12, v13, v12
    v_add_f32 v12, 0x42080000, v12
    v_max_f32 v12, 0, v12
    v_sub_f32 v32, v32, v12
    v_sub_f32 v33, v33, v12
    v_sub_f32 v34, v34, v12
    v_sub_f32 v35, v35, v12
    v_exp_f32 v14, -v12
    s_nop 0
    v_mul_f32 v11, v11, v14
    v_and_b32 v13, 48, v0
    ds_bpermute_b32 v20, v13, v14 offset:0
    ds_bpermute_b32 v21, v13, v14 offset:4
    ds_bpermute_b32 v22, v13, v14 offset:8
    ds_bpermute_b32 v23, v13, v14 offset:12
    s_waitcnt lgkmcnt(0)
    v_accvgpr_read_b32 v16, a104
    v_accvgpr_read_b32 v17, a105
    v_accvgpr_read_b32 v18, a106
    v_accvgpr_read_b32 v19, a107
    v_mul_f32 v16, v16, v20
    v_mul_f32 v17, v17, v21
    v_mul_f32 v18, v18, v22
    v_mul_f32 v19, v19, v23
    v_accvgpr_write_b32 a104, v16
    v_accvgpr_write_b32 a105, v17
    v_accvgpr_write_b32 a106, v18
    v_accvgpr_write_b32 a107, v19
    v_accvgpr_read_b32 v16, a116
    v_accvgpr_read_b32 v17, a117
    v_accvgpr_read_b32 v18, a118
    v_accvgpr_read_b32 v19, a119
    v_mul_f32 v16, v16, v20
    v_mul_f32 v17, v17, v21
    v_mul_f32 v18, v18, v22
    v_mul_f32 v19, v19, v23
    v_accvgpr_write_b32 a116, v16
    v_accvgpr_write_b32 a117, v17
    v_accvgpr_write_b32 a118, v18
    v_accvgpr_write_b32 a119, v19
    v_accvgpr_read_b32 v16, a128
    v_accvgpr_read_b32 v17, a129
    v_accvgpr_read_b32 v18, a130
    v_accvgpr_read_b32 v19, a131
    v_mul_f32 v16, v16, v20
    v_mul_f32 v17, v17, v21
    v_mul_f32 v18, v18, v22
    v_mul_f32 v19, v19, v23
    v_accvgpr_write_b32 a128, v16
    v_accvgpr_write_b32 a129, v17
    v_accvgpr_write_b32 a130, v18
    v_accvgpr_write_b32 a131, v19
    v_accvgpr_read_b32 v16, a140
    v_accvgpr_read_b32 v17, a141
    v_accvgpr_read_b32 v18, a142
    v_accvgpr_read_b32 v19, a143
    v_mul_f32 v16, v16, v20
    v_mul_f32 v17, v17, v21
    v_mul_f32 v18, v18, v22
    v_mul_f32 v19, v19, v23
    v_accvgpr_write_b32 a140, v16
    v_accvgpr_write_b32 a141, v17
    v_accvgpr_write_b32 a142, v18
    v_accvgpr_write_b32 a143, v19
    v_accvgpr_read_b32 v16, a152
    v_accvgpr_read_b32 v17, a153
    v_accvgpr_read_b32 v18, a154
    v_accvgpr_read_b32 v19, a155
    v_mul_f32 v16, v16, v20
    v_mul_f32 v17, v17, v21
    v_mul_f32 v18, v18, v22
    v_mul_f32 v19, v19, v23
    v_accvgpr_write_b32 a152, v16
    v_accvgpr_write_b32 a153, v17
    v_accvgpr_write_b32 a154, v18
    v_accvgpr_write_b32 a155, v19
    v_mul_f32 v132, v132, v20
    v_mul_f32 v133, v133, v21
    v_mul_f32 v134, v134, v22
    v_mul_f32 v135, v135, v23
    v_mul_f32 v144, v144, v20
    v_mul_f32 v145, v145, v21
    v_mul_f32 v146, v146, v22
    v_mul_f32 v147, v147, v23
    v_mul_f32 v156, v156, v20
    v_mul_f32 v157, v157, v21
    v_mul_f32 v158, v158, v22
    v_mul_f32 v159, v159, v23
    v_mul_f32 v168, v168, v20
    v_mul_f32 v169, v169, v21
    v_mul_f32 v170, v170, v22
    v_mul_f32 v171, v171, v23
    v_mul_f32 v180, v180, v20
    v_mul_f32 v181, v181, v21
    v_mul_f32 v182, v182, v22
    v_mul_f32 v183, v183, v23
    v_mul_f32 v192, v192, v20
    v_mul_f32 v193, v193, v21
    v_mul_f32 v194, v194, v22
    v_mul_f32 v195, v195, v23
    v_mul_f32 v204, v204, v20
    v_mul_f32 v205, v205, v21
    v_mul_f32 v206, v206, v22
    v_mul_f32 v207, v207, v23
    v_mul_f32 v216, v216, v20
    v_mul_f32 v217, v217, v21
    v_mul_f32 v218, v218, v22
    v_mul_f32 v219, v219, v23
    v_mul_f32 v228, v228, v20
    v_mul_f32 v229, v229, v21
    v_mul_f32 v230, v230, v22
    v_mul_f32 v231, v231, v23
    v_mul_f32 v240, v240, v20
    v_mul_f32 v241, v241, v21
    v_mul_f32 v242, v242, v22
    v_mul_f32 v243, v243, v23
    v_mul_f32 v252, v252, v20
    v_mul_f32 v253, v253, v21
    v_mul_f32 v254, v254, v22
    v_mul_f32 v255, v255, v23
    v_accvgpr_read_b32 v16, a180
    v_accvgpr_read_b32 v17, a181
    v_accvgpr_read_b32 v18, a182
    v_accvgpr_read_b32 v19, a183
    v_mul_f32 v16, v16, v20
    v_mul_f32 v17, v17, v21
    v_mul_f32 v18, v18, v22
    v_mul_f32 v19, v19, v23
    v_accvgpr_write_b32 a180, v16
    v_accvgpr_write_b32 a181, v17
    v_accvgpr_write_b32 a182, v18
    v_accvgpr_write_b32 a183, v19
    v_sub_f32 v16, v44, v12
    v_sub_f32 v17, v45, v12
    v_sub_f32 v18, v46, v12
    v_sub_f32 v19, v47, v12
    v_exp_f32 v16, v16
    v_exp_f32 v17, v17
    v_exp_f32 v18, v18
    v_exp_f32 v19, v19
    v_add_f32 v8, v16, v17
    v_cvt_pk_bf16_f32 v100, v16, v17
    v_add_f32 v8, v8, v18
    v_add_f32 v8, v8, v19
    v_cvt_pk_bf16_f32 v101, v18, v19
    v_sub_f32 v20, v56, v12
    v_sub_f32 v21, v57, v12
    v_sub_f32 v22, v58, v12
    v_sub_f32 v23, v59, v12
    v_exp_f32 v20, v20
    v_exp_f32 v21, v21
    v_exp_f32 v22, v22
    v_exp_f32 v23, v23
    v_add_f32 v8, v8, v20
    v_add_f32 v8, v8, v21
    v_cvt_pk_bf16_f32 v102, v20, v21
    v_add_f32 v8, v8, v22
    v_add_f32 v8, v8, v23
    v_cvt_pk_bf16_f32 v103, v22, v23
    v_sub_f32 v16, v68, v12
    v_sub_f32 v17, v69, v12
    v_sub_f32 v18, v70, v12
    v_sub_f32 v19, v71, v12
    v_exp_f32 v16, v16
    v_exp_f32 v17, v17
    v_exp_f32 v18, v18
    v_exp_f32 v19, v19
    v_add_f32 v8, v8, v16
    v_add_f32 v8, v8, v17
    v_cvt_pk_bf16_f32 v104, v16, v17
    v_add_f32 v8, v8, v18
    v_add_f32 v8, v8, v19
    v_cvt_pk_bf16_f32 v105, v18, v19
    v_sub_f32 v20, v80, v12
    v_sub_f32 v21, v81, v12
    v_sub_f32 v22, v82, v12
    v_sub_f32 v23, v83, v12
    v_exp_f32 v20, v20
    v_exp_f32 v21, v21
    v_exp_f32 v22, v22
    v_exp_f32 v23, v23
    v_add_f32 v8, v8, v20
    v_add_f32 v8, v8, v21
    v_cvt_pk_bf16_f32 v106, v20, v21
    v_add_f32 v8, v8, v22
    v_add_f32 v8, v8, v23
    v_cvt_pk_bf16_f32 v107, v22, v23
    s_nop 3
    s_branch L_j1_0
L_rare0_1:
    s_nop 15
    s_nop 7
    v_max3_f32 v12, v36, v37, v38
    v_max3_f32 v12, v12, v39, v48
    v_max3_f32 v12, v12, v49, v50
    v_max3_f32 v12, v12, v51, v60
    v_max3_f32 v12, v12, v61, v62
    v_max3_f32 v12, v12, v63, v72
    v_max3_f32 v12, v12, v73, v74
    v_max_f32 v12, v12, v75
    v_mov_b32 v13, v12
    s_nop 1
    v_permlane16_swap_b32 v13, v12
    s_nop 1
    v_max_f32 v12, v13, v12
    v_mov_b32 v13, v12
    s_nop 1
    v_permlane32_swap_b32 v13, v12
    s_nop 1
    v_max_f32 v12, v13, v12
    v_add_f32 v12, 0x42080000, v12
    v_max_f32 v12, 0, v12
    v_sub_f32 v24, v24, v12
    v_sub_f32 v25, v25, v12
    v_sub_f32 v26, v26, v12
    v_sub_f32 v27, v27, v12
    v_exp_f32 v14, -v12
    s_nop 0
    v_mul_f32 v9, v9, v14
    v_and_b32 v13, 48, v0
    ds_bpermute_b32 v20, v13, v14 offset:0
    ds_bpermute_b32 v21, v13, v14 offset:4
    ds_bpermute_b32 v22, v13, v14 offset:8
    ds_bpermute_b32 v23, v13, v14 offset:12
    s_waitcnt lgkmcnt(0)
    v_accvgpr_read_b32 v16, a96
    v_accvgpr_read_b32 v17, a97
    v_accvgpr_read_b32 v18, a98
    v_accvgpr_read_b32 v19, a99
    v_mul_f32 v16, v16, v20
    v_mul_f32 v17, v17, v21
    v_mul_f32 v18, v18, v22
    v_mul_f32 v19, v19, v23
    v_accvgpr_write_b32 a96, v16
    v_accvgpr_write_b32 a97, v17
    v_accvgpr_write_b32 a98, v18
    v_accvgpr_write_b32 a99, v19
    v_accvgpr_read_b32 v16, a108
    v_accvgpr_read_b32 v17, a109
    v_accvgpr_read_b32 v18, a110
    v_accvgpr_read_b32 v19, a111
    v_mul_f32 v16, v16, v20
    v_mul_f32 v17, v17, v21
    v_mul_f32 v18, v18, v22
    v_mul_f32 v19, v19, v23
    v_accvgpr_write_b32 a108, v16
    v_accvgpr_write_b32 a109, v17
    v_accvgpr_write_b32 a110, v18
    v_accvgpr_write_b32 a111, v19
    v_accvgpr_read_b32 v16, a120
    v_accvgpr_read_b32 v17, a121
    v_accvgpr_read_b32 v18, a122
    v_accvgpr_read_b32 v19, a123
    v_mul_f32 v16, v16, v20
    v_mul_f32 v17, v17, v21
    v_mul_f32 v18, v18, v22
    v_mul_f32 v19, v19, v23
    v_accvgpr_write_b32 a120, v16
    v_accvgpr_write_b32 a121, v17
    v_accvgpr_write_b32 a122, v18
    v_accvgpr_write_b32 a123, v19
    v_accvgpr_read_b32 v16, a132
    v_accvgpr_read_b32 v17, a133
    v_accvgpr_read_b32 v18, a134
    v_accvgpr_read_b32 v19, a135
    v_mul_f32 v16, v16, v20
    v_mul_f32 v17, v17, v21
    v_mul_f32 v18, v18, v22
    v_mul_f32 v19, v19, v23
    v_accvgpr_write_b32 a132, v16
    v_accvgpr_write_b32 a133, v17
    v_accvgpr_write_b32 a134, v18
    v_accvgpr_write_b32 a135, v19
    v_accvgpr_read_b32 v16, a144
    v_accvgpr_read_b32 v17, a145
    v_accvgpr_read_b32 v18, a146
    v_accvgpr_read_b32 v19, a147
    v_mul_f32 v16, v16, v20
    v_mul_f32 v17, v17, v21
    v_mul_f32 v18, v18, v22
    v_mul_f32 v19, v19, v23
    v_accvgpr_write_b32 a144, v16
    v_accvgpr_write_b32 a145, v17
    v_accvgpr_write_b32 a146, v18
    v_accvgpr_write_b32 a147, v19
    v_accvgpr_read_b32 v16, a156
    v_accvgpr_read_b32 v17, a157
    v_accvgpr_read_b32 v18, a158
    v_accvgpr_read_b32 v19, a159
    v_mul_f32 v16, v16, v20
    v_mul_f32 v17, v17, v21
    v_mul_f32 v18, v18, v22
    v_mul_f32 v19, v19, v23
    v_accvgpr_write_b32 a156, v16
    v_accvgpr_write_b32 a157, v17
    v_accvgpr_write_b32 a158, v18
    v_accvgpr_write_b32 a159, v19
    v_mul_f32 v136, v136, v20
    v_mul_f32 v137, v137, v21
    v_mul_f32 v138, v138, v22
    v_mul_f32 v139, v139, v23
    v_mul_f32 v148, v148, v20
    v_mul_f32 v149, v149, v21
    v_mul_f32 v150, v150, v22
    v_mul_f32 v151, v151, v23
    v_mul_f32 v160, v160, v20
    v_mul_f32 v161, v161, v21
    v_mul_f32 v162, v162, v22
    v_mul_f32 v163, v163, v23
    v_mul_f32 v172, v172, v20
    v_mul_f32 v173, v173, v21
    v_mul_f32 v174, v174, v22
    v_mul_f32 v175, v175, v23
    v_mul_f32 v184, v184, v20
    v_mul_f32 v185, v185, v21
    v_mul_f32 v186, v186, v22
    v_mul_f32 v187, v187, v23
    v_mul_f32 v196, v196, v20
    v_mul_f32 v197, v197, v21
    v_mul_f32 v198, v198, v22
    v_mul_f32 v199, v199, v23
    v_mul_f32 v208, v208, v20
    v_mul_f32 v209, v209, v21
    v_mul_f32 v210, v210, v22
    v_mul_f32 v211, v211, v23
    v_mul_f32 v220, v220, v20
    v_mul_f32 v221, v221, v21
    v_mul_f32 v222, v222, v22
    v_mul_f32 v223, v223, v23
    v_mul_f32 v232, v232, v20
    v_mul_f32 v233, v233, v21
    v_mul_f32 v234, v234, v22
    v_mul_f32 v235, v235, v23
    v_mul_f32 v244, v244, v20
    v_mul_f32 v245, v245, v21
    v_mul_f32 v246, v246, v22
    v_mul_f32 v247, v247, v23
    v_accvgpr_read_b32 v16, a172
    v_accvgpr_read_b32 v17, a173
    v_accvgpr_read_b32 v18, a174
    v_accvgpr_read_b32 v19, a175
    v_mul_f32 v16, v16, v20
    v_mul_f32 v17, v17, v21
    v_mul_f32 v18, v18, v22
    v_mul_f32 v19, v19, v23
    v_accvgpr_write_b32 a172, v16
    v_accvgpr_write_b32 a173, v17
    v_accvgpr_write_b32 a174, v18
    v_accvgpr_write_b32 a175, v19
    v_sub_f32 v16, v36, v12
    v_sub_f32 v17, v37, v12
    v_sub_f32 v18, v38, v12
    v_sub_f32 v19, v39, v12
    v_exp_f32 v16, v16
    v_exp_f32 v17, v17
    v_exp_f32 v18, v18
    v_exp_f32 v19, v19
    v_add_f32 v6, v16, v17
    v_cvt_pk_bf16_f32 v108, v16, v17
    v_add_f32 v6, v6, v18
    v_add_f32 v6, v6, v19
    v_cvt_pk_bf16_f32 v109, v18, v19
    v_sub_f32 v20, v48, v12
    v_sub_f32 v21, v49, v12
    v_sub_f32 v22, v50, v12
    v_sub_f32 v23, v51, v12
    v_exp_f32 v20, v20
    v_exp_f32 v21, v21
    v_exp_f32 v22, v22
    v_exp_f32 v23, v23
    v_add_f32 v6, v6, v20
    v_add_f32 v6, v6, v21
    v_cvt_pk_bf16_f32 v110, v20, v21
    v_add_f32 v6, v6, v22
    v_add_f32 v6, v6, v23
    v_cvt_pk_bf16_f32 v111, v22, v23
    v_sub_f32 v16, v60, v12
    v_sub_f32 v17, v61, v12
    v_sub_f32 v18, v62, v12
    v_sub_f32 v19, v63, v12
    v_exp_f32 v16, v16
    v_exp_f32 v17, v17
    v_exp_f32 v18, v18
    v_exp_f32 v19, v19
    v_add_f32 v6, v6, v16
    v_add_f32 v6, v6, v17
    v_cvt_pk_bf16_f32 v112, v16, v17
    v_add_f32 v6, v6, v18
    v_add_f32 v6, v6, v19
    v_cvt_pk_bf16_f32 v113, v18, v19
    v_sub_f32 v20, v72, v12
    v_sub_f32 v21, v73, v12
    v_sub_f32 v22, v74, v12
    v_sub_f32 v23, v75, v12
    v_exp_f32 v20, v20
    v_exp_f32 v21, v21
    v_exp_f32 v22, v22
    v_exp_f32 v23, v23
    v_add_f32 v6, v6, v20
    v_add_f32 v6, v6, v21
    v_cvt_pk_bf16_f32 v114, v20, v21
    v_add_f32 v6, v6, v22
    v_add_f32 v6, v6, v23
    v_cvt_pk_bf16_f32 v115, v22, v23
    v_max3_f32 v12, v40, v41, v42
    v_max3_f32 v12, v12, v43, v52
    v_max3_f32 v12, v12, v53, v54
    v_max3_f32 v12, v12, v55, v64
    v_max3_f32 v12, v12, v65, v66
    v_max3_f32 v12, v12, v67, v76
    v_max3_f32 v12, v12, v77, v78
    v_max_f32 v12, v12, v79
    v_mov_b32 v13, v12
    s_nop 1
    v_permlane16_swap_b32 v13, v12
    s_nop 1
    v_max_f32 v12, v13, v12
    v_mov_b32 v13, v12
    s_nop 1
    v_permlane32_swap_b32 v13, v12
    s_nop 1
    v_max_f32 v12, v13, v12
    v_add_f32 v12, 0x42080000, v12
    v_max_f32 v12, 0, v12
    v_sub_f32 v28, v28, v12
    v_sub_f32 v29, v29, v12
    v_sub_f32 v30, v30, v12
    v_sub_f32 v31, v31, v12
    v_exp_f32 v14, -v12
    s_nop 0
    v_mul_f32 v10, v10, v14
    v_and_b32 v13, 48, v0
    ds_bpermute_b32 v20, v13, v14 offset:0
    ds_bpermute_b32 v21, v13, v14 offset:4
    ds_bpermute_b32 v22, v13, v14 offset:8
    ds_bpermute_b32 v23, v13, v14 offset:12
    s_waitcnt lgkmcnt(0)
    v_accvgpr_read_b32 v16, a100
    v_accvgpr_read_b32 v17, a101
    v_accvgpr_read_b32 v18, a102
    v_accvgpr_read_b32 v19, a103
    v_mul_f32 v16, v16, v20
    v_mul_f32 v17, v17, v21
    v_mul_f32 v18, v18, v22
    v_mul_f32 v19, v19, v23
    v_accvgpr_write_b32 a100, v16
    v_accvgpr_write_b32 a101, v17
    v_accvgpr_write_b32 a102, v18
    v_accvgpr_write_b32 a103, v19
    v_accvgpr_read_b32 v16, a112
    v_accvgpr_read_b32 v17, a113
    v_accvgpr_read_b32 v18, a114
    v_accvgpr_read_b32 v19, a115
    v_mul_f32 v16, v16, v20
    v_mul_f32 v17, v17, v21
    v_mul_f32 v18, v18, v22
    v_mul_f32 v19, v19, v23
    v_accvgpr_write_b32 a112, v16
    v_accvgpr_write_b32 a113, v17
    v_accvgpr_write_b32 a114, v18
    v_accvgpr_write_b32 a115, v19
    v_accvgpr_read_b32 v16, a124
    v_accvgpr_read_b32 v17, a125
    v_accvgpr_read_b32 v18, a126
    v_accvgpr_read_b32 v19, a127
    v_mul_f32 v16, v16, v20
    v_mul_f32 v17, v17, v21
    v_mul_f32 v18, v18, v22
    v_mul_f32 v19, v19, v23
    v_accvgpr_write_b32 a124, v16
    v_accvgpr_write_b32 a125, v17
    v_accvgpr_write_b32 a126, v18
    v_accvgpr_write_b32 a127, v19
    v_accvgpr_read_b32 v16, a136
    v_accvgpr_read_b32 v17, a137
    v_accvgpr_read_b32 v18, a138
    v_accvgpr_read_b32 v19, a139
    v_mul_f32 v16, v16, v20
    v_mul_f32 v17, v17, v21
    v_mul_f32 v18, v18, v22
    v_mul_f32 v19, v19, v23
    v_accvgpr_write_b32 a136, v16
    v_accvgpr_write_b32 a137, v17
    v_accvgpr_write_b32 a138, v18
    v_accvgpr_write_b32 a139, v19
    v_accvgpr_read_b32 v16, a148
    v_accvgpr_read_b32 v17, a149
    v_accvgpr_read_b32 v18, a150
    v_accvgpr_read_b32 v19, a151
    v_mul_f32 v16, v16, v20
    v_mul_f32 v17, v17, v21
    v_mul_f32 v18, v18, v22
    v_mul_f32 v19, v19, v23
    v_accvgpr_write_b32 a148, v16
    v_accvgpr_write_b32 a149, v17
    v_accvgpr_write_b32 a150, v18
    v_accvgpr_write_b32 a151, v19
    v_accvgpr_read_b32 v16, a160
    v_accvgpr_read_b32 v17, a161
    v_accvgpr_read_b32 v18, a162
    v_accvgpr_read_b32 v19, a163
    v_mul_f32 v16, v16, v20
    v_mul_f32 v17, v17, v21
    v_mul_f32 v18, v18, v22
    v_mul_f32 v19, v19, v23
    v_accvgpr_write_b32 a160, v16
    v_accvgpr_write_b32 a161, v17
    v_accvgpr_write_b32 a162, v18
    v_accvgpr_write_b32 a163, v19
    v_mul_f32 v140, v140, v20
    v_mul_f32 v141, v141, v21
    v_mul_f32 v142, v142, v22
    v_mul_f32 v143, v143, v23
    v_mul_f32 v152, v152, v20
    v_mul_f32 v153, v153, v21
    v_mul_f32 v154, v154, v22
    v_mul_f32 v155, v155, v23
    v_mul_f32 v164, v164, v20
    v_mul_f32 v165, v165, v21
    v_mul_f32 v166, v166, v22
    v_mul_f32 v167, v167, v23
    v_mul_f32 v176, v176, v20
    v_mul_f32 v177, v177, v21
    v_mul_f32 v178, v178, v22
    v_mul_f32 v179, v179, v23
    v_mul_f32 v188, v188, v20
    v_mul_f32 v189, v189, v21
    v_mul_f32 v190, v190, v22
    v_mul_f32 v191, v191, v23
    v_mul_f32 v200, v200, v20
    v_mul_f32 v201, v201, v21
    v_mul_f32 v202, v202, v22
    v_mul_f32 v203, v203, v23
    v_mul_f32 v212, v212, v20
    v_mul_f32 v213, v213, v21
    v_mul_f32 v214, v214, v22
    v_mul_f32 v215, v215, v23
    v_mul_f32 v224, v224, v20
    v_mul_f32 v225, v225, v21
    v_mul_f32 v226, v226, v22
    v_mul_f32 v227, v227, v23
    v_mul_f32 v236, v236, v20
    v_mul_f32 v237, v237, v21
    v_mul_f32 v238, v238, v22
    v_mul_f32 v239, v239, v23
    v_mul_f32 v248, v248, v20
    v_mul_f32 v249, v249, v21
    v_mul_f32 v250, v250, v22
    v_mul_f32 v251, v251, v23
    v_accvgpr_read_b32 v16, a176
    v_accvgpr_read_b32 v17, a177
    v_accvgpr_read_b32 v18, a178
    v_accvgpr_read_b32 v19, a179
    v_mul_f32 v16, v16, v20
    v_mul_f32 v17, v17, v21
    v_mul_f32 v18, v18, v22
    v_mul_f32 v19, v19, v23
    v_accvgpr_write_b32 a176, v16
    v_accvgpr_write_b32 a177, v17
    v_accvgpr_write_b32 a178, v18
    v_accvgpr_write_b32 a179, v19
    v_sub_f32 v16, v40, v12
    v_sub_f32 v17, v41, v12
    v_sub_f32 v18, v42, v12
    v_sub_f32 v19, v43, v12
    v_exp_f32 v16, v16
    v_exp_f32 v17, v17
    v_exp_f32 v18, v18
    v_exp_f32 v19, v19
    v_add_f32 v7, v16, v17
    v_cvt_pk_bf16_f32 v116, v16, v17
    v_add_f32 v7, v7, v18
    v_add_f32 v7, v7, v19
    v_cvt_pk_bf16_f32 v117, v18, v19
    v_sub_f32 v20, v52, v12
    v_sub_f32 v21, v53, v12
    v_sub_f32 v22, v54, v12
    v_sub_f32 v23, v55, v12
    v_exp_f32 v20, v20
    v_exp_f32 v21, v21
    v_exp_f32 v22, v22
    v_exp_f32 v23, v23
    v_add_f32 v7, v7, v20
    v_add_f32 v7, v7, v21
    v_cvt_pk_bf16_f32 v118, v20, v21
    v_add_f32 v7, v7, v22
    v_add_f32 v7, v7, v23
    v_cvt_pk_bf16_f32 v119, v22, v23
    v_sub_f32 v16, v64, v12
    v_sub_f32 v17, v65, v12
    v_sub_f32 v18, v66, v12
    v_sub_f32 v19, v67, v12
    v_exp_f32 v16, v16
    v_exp_f32 v17, v17
    v_exp_f32 v18, v18
    v_exp_f32 v19, v19
    v_add_f32 v7, v7, v16
    v_add_f32 v7, v7, v17
    v_cvt_pk_bf16_f32 v120, v16, v17
    v_add_f32 v7, v7, v18
    v_add_f32 v7, v7, v19
    v_cvt_pk_bf16_f32 v121, v18, v19
    v_sub_f32 v20, v76, v12
    v_sub_f32 v21, v77, v12
    v_sub_f32 v22, v78, v12
    v_sub_f32 v23, v79, v12
    v_exp_f32 v20, v20
    v_exp_f32 v21, v21
    v_exp_f32 v22, v22
    v_exp_f32 v23, v23
    v_add_f32 v7, v7, v20
    v_add_f32 v7, v7, v21
    v_cvt_pk_bf16_f32 v122, v20, v21
    v_add_f32 v7, v7, v22
    v_add_f32 v7, v7, v23
    v_cvt_pk_bf16_f32 v123, v22, v23
    v_max3_f32 v12, v44, v45, v46
    v_max3_f32 v12, v12, v47, v56
    v_max3_f32 v12, v12, v57, v58
    v_max3_f32 v12, v12, v59, v68
    v_max3_f32 v12, v12, v69, v70
    v_max3_f32 v12, v12, v71, v80
    v_max3_f32 v12, v12, v81, v82
    v_max_f32 v12, v12, v83
    v_mov_b32 v13, v12
    s_nop 1
    v_permlane16_swap_b32 v13, v12
    s_nop 1
    v_max_f32 v12, v13, v12
    v_mov_b32 v13, v12
    s_nop 1
    v_permlane32_swap_b32 v13, v12
    s_nop 1
    v_max_f32 v12, v13, v12
    v_add_f32 v12, 0x42080000, v12
    v_max_f32 v12, 0, v12
    v_sub_f32 v32, v32, v12
    v_sub_f32 v33, v33, v12
    v_sub_f32 v34, v34, v12
    v_sub_f32 v35, v35, v12
    v_exp_f32 v14, -v12
    s_nop 0
    v_mul_f32 v11, v11, v14
    v_and_b32 v13, 48, v0
    ds_bpermute_b32 v20, v13, v14 offset:0
    ds_bpermute_b32 v21, v13, v14 offset:4
    ds_bpermute_b32 v22, v13, v14 offset:8
    ds_bpermute_b32 v23, v13, v14 offset:12
    s_waitcnt lgkmcnt(0)
    v_accvgpr_read_b32 v16, a104
    v_accvgpr_read_b32 v17, a105
    v_accvgpr_read_b32 v18, a106
    v_accvgpr_read_b32 v19, a107
    v_mul_f32 v16, v16, v20
    v_mul_f32 v17, v17, v21
    v_mul_f32 v18, v18, v22
    v_mul_f32 v19, v19, v23
    v_accvgpr_write_b32 a104, v16
    v_accvgpr_write_b32 a105, v17
    v_accvgpr_write_b32 a106, v18
    v_accvgpr_write_b32 a107, v19
    v_accvgpr_read_b32 v16, a116
    v_accvgpr_read_b32 v17, a117
    v_accvgpr_read_b32 v18, a118
    v_accvgpr_read_b32 v19, a119
    v_mul_f32 v16, v16, v20
    v_mul_f32 v17, v17, v21
    v_mul_f32 v18, v18, v22
    v_mul_f32 v19, v19, v23
    v_accvgpr_write_b32 a116, v16
    v_accvgpr_write_b32 a117, v17
    v_accvgpr_write_b32 a118, v18
    v_accvgpr_write_b32 a119, v19
    v_accvgpr_read_b32 v16, a128
    v_accvgpr_read_b32 v17, a129
    v_accvgpr_read_b32 v18, a130
    v_accvgpr_read_b32 v19, a131
    v_mul_f32 v16, v16, v20
    v_mul_f32 v17, v17, v21
    v_mul_f32 v18, v18, v22
    v_mul_f32 v19, v19, v23
    v_accvgpr_write_b32 a128, v16
    v_accvgpr_write_b32 a129, v17
    v_accvgpr_write_b32 a130, v18
    v_accvgpr_write_b32 a131, v19
    v_accvgpr_read_b32 v16, a140
    v_accvgpr_read_b32 v17, a141
    v_accvgpr_read_b32 v18, a142
    v_accvgpr_read_b32 v19, a143
    v_mul_f32 v16, v16, v20
    v_mul_f32 v17, v17, v21
    v_mul_f32 v18, v18, v22
    v_mul_f32 v19, v19, v23
    v_accvgpr_write_b32 a140, v16
    v_accvgpr_write_b32 a141, v17
    v_accvgpr_write_b32 a142, v18
    v_accvgpr_write_b32 a143, v19
    v_accvgpr_read_b32 v16, a152
    v_accvgpr_read_b32 v17, a153
    v_accvgpr_read_b32 v18, a154
    v_accvgpr_read_b32 v19, a155
    v_mul_f32 v16, v16, v20
    v_mul_f32 v17, v17, v21
    v_mul_f32 v18, v18, v22
    v_mul_f32 v19, v19, v23
    v_accvgpr_write_b32 a152, v16
    v_accvgpr_write_b32 a153, v17
    v_accvgpr_write_b32 a154, v18
    v_accvgpr_write_b32 a155, v19
    v_mul_f32 v132, v132, v20
    v_mul_f32 v133, v133, v21
    v_mul_f32 v134, v134, v22
    v_mul_f32 v135, v135, v23
    v_mul_f32 v144, v144, v20
    v_mul_f32 v145, v145, v21
    v_mul_f32 v146, v146, v22
    v_mul_f32 v147, v147, v23
    v_mul_f32 v156, v156, v20
    v_mul_f32 v157, v157, v21
    v_mul_f32 v158, v158, v22
    v_mul_f32 v159, v159, v23
    v_mul_f32 v168, v168, v20
    v_mul_f32 v169, v169, v21
    v_mul_f32 v170, v170, v22
    v_mul_f32 v171, v171, v23
    v_mul_f32 v180, v180, v20
    v_mul_f32 v181, v181, v21
    v_mul_f32 v182, v182, v22
    v_mul_f32 v183, v183, v23
    v_mul_f32 v192, v192, v20
    v_mul_f32 v193, v193, v21
    v_mul_f32 v194, v194, v22
    v_mul_f32 v195, v195, v23
    v_mul_f32 v204, v204, v20
    v_mul_f32 v205, v205, v21
    v_mul_f32 v206, v206, v22
    v_mul_f32 v207, v207, v23
    v_mul_f32 v216, v216, v20
    v_mul_f32 v217, v217, v21
    v_mul_f32 v218, v218, v22
    v_mul_f32 v219, v219, v23
    v_mul_f32 v228, v228, v20
    v_mul_f32 v229, v229, v21
    v_mul_f32 v230, v230, v22
    v_mul_f32 v231, v231, v23
    v_mul_f32 v240, v240, v20
    v_mul_f32 v241, v241, v21
    v_mul_f32 v242, v242, v22
    v_mul_f32 v243, v243, v23
    v_mul_f32 v252, v252, v20
    v_mul_f32 v253, v253, v21
    v_mul_f32 v254, v254, v22
    v_mul_f32 v255, v255, v23
    v_accvgpr_read_b32 v16, a180
    v_accvgpr_read_b32 v17, a181
    v_accvgpr_read_b32 v18, a182
    v_accvgpr_read_b32 v19, a183
    v_mul_f32 v16, v16, v20
    v_mul_f32 v17, v17, v21
    v_mul_f32 v18, v18, v22
    v_mul_f32 v19, v19, v23
    v_accvgpr_write_b32 a180, v16
    v_accvgpr_write_b32 a181, v17
    v_accvgpr_write_b32 a182, v18
    v_accvgpr_write_b32 a183, v19
    v_sub_f32 v16, v44, v12
    v_sub_f32 v17, v45, v12
    v_sub_f32 v18, v46, v12
    v_sub_f32 v19, v47, v12
    v_exp_f32 v16, v16
    v_exp_f32 v17, v17
    v_exp_f32 v18, v18
    v_exp_f32 v19, v19
    v_add_f32 v8, v16, v17
    v_cvt_pk_bf16_f32 v124, v16, v17
    v_add_f32 v8, v8, v18
    v_add_f32 v8, v8, v19
    v_cvt_pk_bf16_f32 v125, v18, v19
    v_sub_f32 v20, v56, v12
    v_sub_f32 v21, v57, v12
    v_sub_f32 v22, v58, v12
    v_sub_f32 v23, v59, v12
    v_exp_f32 v20, v20
    v_exp_f32 v21, v21
    v_exp_f32 v22, v22
    v_exp_f32 v23, v23
    v_add_f32 v8, v8, v20
    v_add_f32 v8, v8, v21
    v_cvt_pk_bf16_f32 v126, v20, v21
    v_add_f32 v8, v8, v22
    v_add_f32 v8, v8, v23
    v_cvt_pk_bf16_f32 v127, v22, v23
    v_sub_f32 v16, v68, v12
    v_sub_f32 v17, v69, v12
    v_sub_f32 v18, v70, v12
    v_sub_f32 v19, v71, v12
    v_exp_f32 v16, v16
    v_exp_f32 v17, v17
    v_exp_f32 v18, v18
    v_exp_f32 v19, v19
    v_add_f32 v8, v8, v16
    v_add_f32 v8, v8, v17
    v_cvt_pk_bf16_f32 v128, v16, v17
    v_add_f32 v8, v8, v18
    v_add_f32 v8, v8, v19
    v_cvt_pk_bf16_f32 v129, v18, v19
    v_sub_f32 v20, v80, v12
    v_sub_f32 v21, v81, v12
    v_sub_f32 v22, v82, v12
    v_sub_f32 v23, v83, v12
    v_exp_f32 v20, v20
    v_exp_f32 v21, v21
    v_exp_f32 v22, v22
    v_exp_f32 v23, v23
    v_add_f32 v8, v8, v20
    v_add_f32 v8, v8, v21
    v_cvt_pk_bf16_f32 v130, v20, v21
    v_add_f32 v8, v8, v22
    v_add_f32 v8, v8, v23
    v_cvt_pk_bf16_f32 v131, v22, v23
    s_nop 3
    s_branch L_j0_1
L_rare1_1:
    s_nop 15
    s_nop 7
    v_max3_f32 v12, v36, v37, v38
    v_max3_f32 v12, v12, v39, v48
    v_max3_f32 v12, v12, v49, v50
    v_max3_f32 v12, v12, v51, v60
    v_max3_f32 v12, v12, v61, v62
    v_max3_f32 v12, v12, v63, v72
    v_max3_f32 v12, v12, v73, v74
    v_max_f32 v12, v12, v75
    v_mov_b32 v13, v12
    s_nop 1
    v_permlane16_swap_b32 v13, v12
    s_nop 1
    v_max_f32 v12, v13, v12
    v_mov_b32 v13, v12
    s_nop 1
    v_permlane32_swap_b32 v13, v12
    s_nop 1
    v_max_f32 v12, v13, v12
    v_add_f32 v12, 0x42080000, v12
    v_max_f32 v12, 0, v12
    v_sub_f32 v24, v24, v12
    v_sub_f32 v25, v25, v12
    v_sub_f32 v26, v26, v12
    v_sub_f32 v27, v27, v12
    v_exp_f32 v14, -v12
    s_nop 0
    v_mul_f32 v9, v9, v14
    v_and_b32 v13, 48, v0
    ds_bpermute_b32 v20, v13, v14 offset:0
    ds_bpermute_b32 v21, v13, v14 offset:4
    ds_bpermute_b32 v22, v13, v14 offset:8
    ds_bpermute_b32 v23, v13, v14 offset:12
    s_waitcnt lgkmcnt(0)
    v_accvgpr_read_b32 v16, a96
    v_accvgpr_read_b32 v17, a97
    v_accvgpr_read_b32 v18, a98
    v_accvgpr_read_b32 v19, a99
    v_mul_f32 v16, v16, v20
    v_mul_f32 v17, v17, v21
    v_mul_f32 v18, v18, v22
    v_mul_f32 v19, v19, v23
    v_accvgpr_write_b32 a96, v16
    v_accvgpr_write_b32 a97, v17
    v_accvgpr_write_b32 a98, v18
    v_accvgpr_write_b32 a99, v19
    v_accvgpr_read_b32 v16, a108
    v_accvgpr_read_b32 v17, a109
    v_accvgpr_read_b32 v18, a110
    v_accvgpr_read_b32 v19, a111
    v_mul_f32 v16, v16, v20
    v_mul_f32 v17, v17, v21
    v_mul_f32 v18, v18, v22
    v_mul_f32 v19, v19, v23
    v_accvgpr_write_b32 a108, v16
    v_accvgpr_write_b32 a109, v17
    v_accvgpr_write_b32 a110, v18
    v_accvgpr_write_b32 a111, v19
    v_accvgpr_read_b32 v16, a120
    v_accvgpr_read_b32 v17, a121
    v_accvgpr_read_b32 v18, a122
    v_accvgpr_read_b32 v19, a123
    v_mul_f32 v16, v16, v20
    v_mul_f32 v17, v17, v21
    v_mul_f32 v18, v18, v22
    v_mul_f32 v19, v19, v23
    v_accvgpr_write_b32 a120, v16
    v_accvgpr_write_b32 a121, v17
    v_accvgpr_write_b32 a122, v18
    v_accvgpr_write_b32 a123, v19
    v_accvgpr_read_b32 v16, a132
    v_accvgpr_read_b32 v17, a133
    v_accvgpr_read_b32 v18, a134
    v_accvgpr_read_b32 v19, a135
    v_mul_f32 v16, v16, v20
    v_mul_f32 v17, v17, v21
    v_mul_f32 v18, v18, v22
    v_mul_f32 v19, v19, v23
    v_accvgpr_write_b32 a132, v16
    v_accvgpr_write_b32 a133, v17
    v_accvgpr_write_b32 a134, v18
    v_accvgpr_write_b32 a135, v19
    v_accvgpr_read_b32 v16, a144
    v_accvgpr_read_b32 v17, a145
    v_accvgpr_read_b32 v18, a146
    v_accvgpr_read_b32 v19, a147
    v_mul_f32 v16, v16, v20
    v_mul_f32 v17, v17, v21
    v_mul_f32 v18, v18, v22
    v_mul_f32 v19, v19, v23
    v_accvgpr_write_b32 a144, v16
    v_accvgpr_write_b32 a145, v17
    v_accvgpr_write_b32 a146, v18
    v_accvgpr_write_b32 a147, v19
    v_accvgpr_read_b32 v16, a156
    v_accvgpr_read_b32 v17, a157
    v_accvgpr_read_b32 v18, a158
    v_accvgpr_read_b32 v19, a159
    v_mul_f32 v16, v16, v20
    v_mul_f32 v17, v17, v21
    v_mul_f32 v18, v18, v22
    v_mul_f32 v19, v19, v23
    v_accvgpr_write_b32 a156, v16
    v_accvgpr_write_b32 a157, v17
    v_accvgpr_write_b32 a158, v18
    v_accvgpr_write_b32 a159, v19
    v_mul_f32 v136, v136, v20
    v_mul_f32 v137, v137, v21
    v_mul_f32 v138, v138, v22
    v_mul_f32 v139, v139, v23
    v_mul_f32 v148, v148, v20
    v_mul_f32 v149, v149, v21
    v_mul_f32 v150, v150, v22
    v_mul_f32 v151, v151, v23
    v_mul_f32 v160, v160, v20
    v_mul_f32 v161, v161, v21
    v_mul_f32 v162, v162, v22
    v_mul_f32 v163, v163, v23
    v_mul_f32 v172, v172, v20
    v_mul_f32 v173, v173, v21
    v_mul_f32 v174, v174, v22
    v_mul_f32 v175, v175, v23
    v_mul_f32 v184, v184, v20
    v_mul_f32 v185, v185, v21
    v_mul_f32 v186, v186, v22
    v_mul_f32 v187, v187, v23
    v_mul_f32 v196, v196, v20
    v_mul_f32 v197, v197, v21
    v_mul_f32 v198, v198, v22
    v_mul_f32 v199, v199, v23
    v_mul_f32 v208, v208, v20
    v_mul_f32 v209, v209, v21
    v_mul_f32 v210, v210, v22
    v_mul_f32 v211, v211, v23
    v_mul_f32 v220, v220, v20
    v_mul_f32 v221, v221, v21
    v_mul_f32 v222, v222, v22
    v_mul_f32 v223, v223, v23
    v_mul_f32 v232, v232, v20
    v_mul_f32 v233, v233, v21
    v_mul_f32 v234, v234, v22
    v_mul_f32 v235, v235, v23
    v_mul_f32 v244, v244, v20
    v_mul_f32 v245, v245, v21
    v_mul_f32 v246, v246, v22
    v_mul_f32 v247, v247, v23
    v_accvgpr_read_b32 v16, a172
    v_accvgpr_read_b32 v17, a173
    v_accvgpr_read_b32 v18, a174
    v_accvgpr_read_b32 v19, a175
    v_mul_f32 v16, v16, v20
    v_mul_f32 v17, v17, v21
    v_mul_f32 v18, v18, v22
    v_mul_f32 v19, v19, v23
    v_accvgpr_write_b32 a172, v16
    v_accvgpr_write_b32 a173, v17
    v_accvgpr_write_b32 a174, v18
    v_accvgpr_write_b32 a175, v19
    v_sub_f32 v16, v36, v12
    v_sub_f32 v17, v37, v12
    v_sub_f32 v18, v38, v12
    v_sub_f32 v19, v39, v12
    v_exp_f32 v16, v16
    v_exp_f32 v17, v17
    v_exp_f32 v18, v18
    v_exp_f32 v19, v19
    v_add_f32 v6, v16, v17
    v_cvt_pk_bf16_f32 v84, v16, v17
    v_add_f32 v6, v6, v18
    v_add_f32 v6, v6, v19
    v_cvt_pk_bf16_f32 v85, v18, v19
    v_sub_f32 v20, v48, v12
    v_sub_f32 v21, v49, v12
    v_sub_f32 v22, v50, v12
    v_sub_f32 v23, v51, v12
    v_exp_f32 v20, v20
    v_exp_f32 v21, v21
    v_exp_f32 v22, v22
    v_exp_f32 v23, v23
    v_add_f32 v6, v6, v20
    v_add_f32 v6, v6, v21
    v_cvt_pk_bf16_f32 v86, v20, v21
    v_add_f32 v6, v6, v22
    v_add_f32 v6, v6, v23
    v_cvt_pk_bf16_f32 v87, v22, v23
    v_sub_f32 v16, v60, v12
    v_sub_f32 v17, v61, v12
    v_sub_f32 v18, v62, v12
    v_sub_f32 v19, v63, v12
    v_exp_f32 v16, v16
    v_exp_f32 v17, v17
    v_exp_f32 v18, v18
    v_exp_f32 v19, v19
    v_add_f32 v6, v6, v16
    v_add_f32 v6, v6, v17
    v_cvt_pk_bf16_f32 v88, v16, v17
    v_add_f32 v6, v6, v18
    v_add_f32 v6, v6, v19
    v_cvt_pk_bf16_f32 v89, v18, v19
    v_sub_f32 v20, v72, v12
    v_sub_f32 v21, v73, v12
    v_sub_f32 v22, v74, v12
    v_sub_f32 v23, v75, v12
    v_exp_f32 v20, v20
    v_exp_f32 v21, v21
    v_exp_f32 v22, v22
    v_exp_f32 v23, v23
    v_add_f32 v6, v6, v20
    v_add_f32 v6, v6, v21
    v_cvt_pk_bf16_f32 v90, v20, v21
    v_add_f32 v6, v6, v22
    v_add_f32 v6, v6, v23
    v_cvt_pk_bf16_f32 v91, v22, v23
    v_max3_f32 v12, v40, v41, v42
    v_max3_f32 v12, v12, v43, v52
    v_max3_f32 v12, v12, v53, v54
    v_max3_f32 v12, v12, v55, v64
    v_max3_f32 v12, v12, v65, v66
    v_max3_f32 v12, v12, v67, v76
    v_max3_f32 v12, v12, v77, v78
    v_max_f32 v12, v12, v79
    v_mov_b32 v13, v12
    s_nop 1
    v_permlane16_swap_b32 v13, v12
    s_nop 1
    v_max_f32 v12, v13, v12
    v_mov_b32 v13, v12
    s_nop 1
    v_permlane32_swap_b32 v13, v12
    s_nop 1
    v_max_f32 v12, v13, v12
    v_add_f32 v12, 0x42080000, v12
    v_max_f32 v12, 0, v12
    v_sub_f32 v28, v28, v12
    v_sub_f32 v29, v29, v12
    v_sub_f32 v30, v30, v12
    v_sub_f32 v31, v31, v12
    v_exp_f32 v14, -v12
    s_nop 0
    v_mul_f32 v10, v10, v14
    v_and_b32 v13, 48, v0
    ds_bpermute_b32 v20, v13, v14 offset:0
    ds_bpermute_b32 v21, v13, v14 offset:4
    ds_bpermute_b32 v22, v13, v14 offset:8
    ds_bpermute_b32 v23, v13, v14 offset:12
    s_waitcnt lgkmcnt(0)
    v_accvgpr_read_b32 v16, a100
    v_accvgpr_read_b32 v17, a101
    v_accvgpr_read_b32 v18, a102
    v_accvgpr_read_b32 v19, a103
    v_mul_f32 v16, v16, v20
    v_mul_f32 v17, v17, v21
    v_mul_f32 v18, v18, v22
    v_mul_f32 v19, v19, v23
    v_accvgpr_write_b32 a100, v16
    v_accvgpr_write_b32 a101, v17
    v_accvgpr_write_b32 a102, v18
    v_accvgpr_write_b32 a103, v19
    v_accvgpr_read_b32 v16, a112
    v_accvgpr_read_b32 v17, a113
    v_accvgpr_read_b32 v18, a114
    v_accvgpr_read_b32 v19, a115
    v_mul_f32 v16, v16, v20
    v_mul_f32 v17, v17, v21
    v_mul_f32 v18, v18, v22
    v_mul_f32 v19, v19, v23
    v_accvgpr_write_b32 a112, v16
    v_accvgpr_write_b32 a113, v17
    v_accvgpr_write_b32 a114, v18
    v_accvgpr_write_b32 a115, v19
    v_accvgpr_read_b32 v16, a124
    v_accvgpr_read_b32 v17, a125
    v_accvgpr_read_b32 v18, a126
    v_accvgpr_read_b32 v19, a127
    v_mul_f32 v16, v16, v20
    v_mul_f32 v17, v17, v21
    v_mul_f32 v18, v18, v22
    v_mul_f32 v19, v19, v23
    v_accvgpr_write_b32 a124, v16
    v_accvgpr_write_b32 a125, v17
    v_accvgpr_write_b32 a126, v18
    v_accvgpr_write_b32 a127, v19
    v_accvgpr_read_b32 v16, a136
    v_accvgpr_read_b32 v17, a137
    v_accvgpr_read_b32 v18, a138
    v_accvgpr_read_b32 v19, a139
    v_mul_f32 v16, v16, v20
    v_mul_f32 v17, v17, v21
    v_mul_f32 v18, v18, v22
    v_mul_f32 v19, v19, v23
    v_accvgpr_write_b32 a136, v16
    v_accvgpr_write_b32 a137, v17
    v_accvgpr_write_b32 a138, v18
    v_accvgpr_write_b32 a139, v19
    v_accvgpr_read_b32 v16, a148
    v_accvgpr_read_b32 v17, a149
    v_accvgpr_read_b32 v18, a150
    v_accvgpr_read_b32 v19, a151
    v_mul_f32 v16, v16, v20
    v_mul_f32 v17, v17, v21
    v_mul_f32 v18, v18, v22
    v_mul_f32 v19, v19, v23
    v_accvgpr_write_b32 a148, v16
    v_accvgpr_write_b32 a149, v17
    v_accvgpr_write_b32 a150, v18
    v_accvgpr_write_b32 a151, v19
    v_accvgpr_read_b32 v16, a160
    v_accvgpr_read_b32 v17, a161
    v_accvgpr_read_b32 v18, a162
    v_accvgpr_read_b32 v19, a163
    v_mul_f32 v16, v16, v20
    v_mul_f32 v17, v17, v21
    v_mul_f32 v18, v18, v22
    v_mul_f32 v19, v19, v23
    v_accvgpr_write_b32 a160, v16
    v_accvgpr_write_b32 a161, v17
    v_accvgpr_write_b32 a162, v18
    v_accvgpr_write_b32 a163, v19
    v_mul_f32 v140, v140, v20
    v_mul_f32 v141, v141, v21
    v_mul_f32 v142, v142, v22
    v_mul_f32 v143, v143, v23
    v_mul_f32 v152, v152, v20
    v_mul_f32 v153, v153, v21
    v_mul_f32 v154, v154, v22
    v_mul_f32 v155, v155, v23
    v_mul_f32 v164, v164, v20
    v_mul_f32 v165, v165, v21
    v_mul_f32 v166, v166, v22
    v_mul_f32 v167, v167, v23
    v_mul_f32 v176, v176, v20
    v_mul_f32 v177, v177, v21
    v_mul_f32 v178, v178, v22
    v_mul_f32 v179, v179, v23
    v_mul_f32 v188, v188, v20
    v_mul_f32 v189, v189, v21
    v_mul_f32 v190, v190, v22
    v_mul_f32 v191, v191, v23
    v_mul_f32 v200, v200, v20
    v_mul_f32 v201, v201, v21
    v_mul_f32 v202, v202, v22
    v_mul_f32 v203, v203, v23
    v_mul_f32 v212, v212, v20
    v_mul_f32 v213, v213, v21
    v_mul_f32 v214, v214, v22
    v_mul_f32 v215, v215, v23
    v_mul_f32 v224, v224, v20
    v_mul_f32 v225, v225, v21
    v_mul_f32 v226, v226, v22
    v_mul_f32 v227, v227, v23
    v_mul_f32 v236, v236, v20
    v_mul_f32 v237, v237, v21
    v_mul_f32 v238, v238, v22
    v_mul_f32 v239, v239, v23
    v_mul_f32 v248, v248, v20
    v_mul_f32 v249, v249, v21
    v_mul_f32 v250, v250, v22
    v_mul_f32 v251, v251, v23
    v_accvgpr_read_b32 v16, a176
    v_accvgpr_read_b32 v17, a177
    v_accvgpr_read_b32 v18, a178
    v_accvgpr_read_b32 v19, a179
    v_mul_f32 v16, v16, v20
    v_mul_f32 v17, v17, v21
    v_mul_f32 v18, v18, v22
    v_mul_f32 v19, v19, v23
    v_accvgpr_write_b32 a176, v16
    v_accvgpr_write_b32 a177, v17
    v_accvgpr_write_b32 a178, v18
    v_accvgpr_write_b32 a179, v19
    v_sub_f32 v16, v40, v12
    v_sub_f32 v17, v41, v12
    v_sub_f32 v18, v42, v12
    v_sub_f32 v19, v43, v12
    v_exp_f32 v16, v16
    v_exp_f32 v17, v17
    v_exp_f32 v18, v18
    v_exp_f32 v19, v19
    v_add_f32 v7, v16, v17
    v_cvt_pk_bf16_f32 v92, v16, v17
    v_add_f32 v7, v7, v18
    v_add_f32 v7, v7, v19
    v_cvt_pk_bf16_f32 v93, v18, v19
    v_sub_f32 v20, v52, v12
    v_sub_f32 v21, v53, v12
    v_sub_f32 v22, v54, v12
    v_sub_f32 v23, v55, v12
    v_exp_f32 v20, v20
    v_exp_f32 v21, v21
    v_exp_f32 v22, v22
    v_exp_f32 v23, v23
    v_add_f32 v7, v7, v20
    v_add_f32 v7, v7, v21
    v_cvt_pk_bf16_f32 v94, v20, v21
    v_add_f32 v7, v7, v22
    v_add_f32 v7, v7, v23
    v_cvt_pk_bf16_f32 v95, v22, v23
    v_sub_f32 v16, v64, v12
    v_sub_f32 v17, v65, v12
    v_sub_f32 v18, v66, v12
    v_sub_f32 v19, v67, v12
    v_exp_f32 v16, v16
    v_exp_f32 v17, v17
    v_exp_f32 v18, v18
    v_exp_f32 v19, v19
    v_add_f32 v7, v7, v16
    v_add_f32 v7, v7, v17
    v_cvt_pk_bf16_f32 v96, v16, v17
    v_add_f32 v7, v7, v18
    v_add_f32 v7, v7, v19
    v_cvt_pk_bf16_f32 v97, v18, v19
    v_sub_f32 v20, v76, v12
    v_sub_f32 v21, v77, v12
    v_sub_f32 v22, v78, v12
    v_sub_f32 v23, v79, v12
    v_exp_f32 v20, v20
    v_exp_f32 v21, v21
    v_exp_f32 v22, v22
    v_exp_f32 v23, v23
    v_add_f32 v7, v7, v20
    v_add_f32 v7, v7, v21
    v_cvt_pk_bf16_f32 v98, v20, v21
    v_add_f32 v7, v7, v22
    v_add_f32 v7, v7, v23
    v_cvt_pk_bf16_f32 v99, v22, v23
    v_max3_f32 v12, v44, v45, v46
    v_max3_f32 v12, v12, v47, v56
    v_max3_f32 v12, v12, v57, v58
    v_max3_f32 v12, v12, v59, v68
    v_max3_f32 v12, v12, v69, v70
    v_max3_f32 v12, v12, v71, v80
    v_max3_f32 v12, v12, v81, v82
    v_max_f32 v12, v12, v83
    v_mov_b32 v13, v12
    s_nop 1
    v_permlane16_swap_b32 v13, v12
    s_nop 1
    v_max_f32 v12, v13, v12
    v_mov_b32 v13, v12
    s_nop 1
    v_permlane32_swap_b32 v13, v12
    s_nop 1
    v_max_f32 v12, v13, v12
    v_add_f32 v12, 0x42080000, v12
    v_max_f32 v12, 0, v12
    v_sub_f32 v32, v32, v12
    v_sub_f32 v33, v33, v12
    v_sub_f32 v34, v34, v12
    v_sub_f32 v35, v35, v12
    v_exp_f32 v14, -v12
    s_nop 0
    v_mul_f32 v11, v11, v14
    v_and_b32 v13, 48, v0
    ds_bpermute_b32 v20, v13, v14 offset:0
    ds_bpermute_b32 v21, v13, v14 offset:4
    ds_bpermute_b32 v22, v13, v14 offset:8
    ds_bpermute_b32 v23, v13, v14 offset:12
    s_waitcnt lgkmcnt(0)
    v_accvgpr_read_b32 v16, a104
    v_accvgpr_read_b32 v17, a105
    v_accvgpr_read_b32 v18, a106
    v_accvgpr_read_b32 v19, a107
    v_mul_f32 v16, v16, v20
    v_mul_f32 v17, v17, v21
    v_mul_f32 v18, v18, v22
    v_mul_f32 v19, v19, v23
    v_accvgpr_write_b32 a104, v16
    v_accvgpr_write_b32 a105, v17
    v_accvgpr_write_b32 a106, v18
    v_accvgpr_write_b32 a107, v19
    v_accvgpr_read_b32 v16, a116
    v_accvgpr_read_b32 v17, a117
    v_accvgpr_read_b32 v18, a118
    v_accvgpr_read_b32 v19, a119
    v_mul_f32 v16, v16, v20
    v_mul_f32 v17, v17, v21
    v_mul_f32 v18, v18, v22
    v_mul_f32 v19, v19, v23
    v_accvgpr_write_b32 a116, v16
    v_accvgpr_write_b32 a117, v17
    v_accvgpr_write_b32 a118, v18
    v_accvgpr_write_b32 a119, v19
    v_accvgpr_read_b32 v16, a128
    v_accvgpr_read_b32 v17, a129
    v_accvgpr_read_b32 v18, a130
    v_accvgpr_read_b32 v19, a131
    v_mul_f32 v16, v16, v20
    v_mul_f32 v17, v17, v21
    v_mul_f32 v18, v18, v22
    v_mul_f32 v19, v19, v23
    v_accvgpr_write_b32 a128, v16
    v_accvgpr_write_b32 a129, v17
    v_accvgpr_write_b32 a130, v18
    v_accvgpr_write_b32 a131, v19
    v_accvgpr_read_b32 v16, a140
    v_accvgpr_read_b32 v17, a141
    v_accvgpr_read_b32 v18, a142
    v_accvgpr_read_b32 v19, a143
    v_mul_f32 v16, v16, v20
    v_mul_f32 v17, v17, v21
    v_mul_f32 v18, v18, v22
    v_mul_f32 v19, v19, v23
    v_accvgpr_write_b32 a140, v16
    v_accvgpr_write_b32 a141, v17
    v_accvgpr_write_b32 a142, v18
    v_accvgpr_write_b32 a143, v19
    v_accvgpr_read_b32 v16, a152
    v_accvgpr_read_b32 v17, a153
    v_accvgpr_read_b32 v18, a154
    v_accvgpr_read_b32 v19, a155
    v_mul_f32 v16, v16, v20
    v_mul_f32 v17, v17, v21
    v_mul_f32 v18, v18, v22
    v_mul_f32 v19, v19, v23
    v_accvgpr_write_b32 a152, v16
    v_accvgpr_write_b32 a153, v17
    v_accvgpr_write_b32 a154, v18
    v_accvgpr_write_b32 a155, v19
    v_mul_f32 v132, v132, v20
    v_mul_f32 v133, v133, v21
    v_mul_f32 v134, v134, v22
    v_mul_f32 v135, v135, v23
    v_mul_f32 v144, v144, v20
    v_mul_f32 v145, v145, v21
    v_mul_f32 v146, v146, v22
    v_mul_f32 v147, v147, v23
    v_mul_f32 v156, v156, v20
    v_mul_f32 v157, v157, v21
    v_mul_f32 v158, v158, v22
    v_mul_f32 v159, v159, v23
    v_mul_f32 v168, v168, v20
    v_mul_f32 v169, v169, v21
    v_mul_f32 v170, v170, v22
    v_mul_f32 v171, v171, v23
    v_mul_f32 v180, v180, v20
    v_mul_f32 v181, v181, v21
    v_mul_f32 v182, v182, v22
    v_mul_f32 v183, v183, v23
    v_mul_f32 v192, v192, v20
    v_mul_f32 v193, v193, v21
    v_mul_f32 v194, v194, v22
    v_mul_f32 v195, v195, v23
    v_mul_f32 v204, v204, v20
    v_mul_f32 v205, v205, v21
    v_mul_f32 v206, v206, v22
    v_mul_f32 v207, v207, v23
    v_mul_f32 v216, v216, v20
    v_mul_f32 v217, v217, v21
    v_mul_f32 v218, v218, v22
    v_mul_f32 v219, v219, v23
    v_mul_f32 v228, v228, v20
    v_mul_f32 v229, v229, v21
    v_mul_f32 v230, v230, v22
    v_mul_f32 v231, v231, v23
    v_mul_f32 v240, v240, v20
    v_mul_f32 v241, v241, v21
    v_mul_f32 v242, v242, v22
    v_mul_f32 v243, v243, v23
    v_mul_f32 v252, v252, v20
    v_mul_f32 v253, v253, v21
    v_mul_f32 v254, v254, v22
    v_mul_f32 v255, v255, v23
    v_accvgpr_read_b32 v16, a180
    v_accvgpr_read_b32 v17, a181
    v_accvgpr_read_b32 v18, a182
    v_accvgpr_read_b32 v19, a183
    v_mul_f32 v16, v16, v20
    v_mul_f32 v17, v17, v21
    v_mul_f32 v18, v18, v22
    v_mul_f32 v19, v19, v23
    v_accvgpr_write_b32 a180, v16
    v_accvgpr_write_b32 a181, v17
    v_accvgpr_write_b32 a182, v18
    v_accvgpr_write_b32 a183, v19
    v_sub_f32 v16, v44, v12
    v_sub_f32 v17, v45, v12
    v_sub_f32 v18, v46, v12
    v_sub_f32 v19, v47, v12
    v_exp_f32 v16, v16
    v_exp_f32 v17, v17
    v_exp_f32 v18, v18
    v_exp_f32 v19, v19
    v_add_f32 v8, v16, v17
    v_cvt_pk_bf16_f32 v100, v16, v17
    v_add_f32 v8, v8, v18
    v_add_f32 v8, v8, v19
    v_cvt_pk_bf16_f32 v101, v18, v19
    v_sub_f32 v20, v56, v12
    v_sub_f32 v21, v57, v12
    v_sub_f32 v22, v58, v12
    v_sub_f32 v23, v59, v12
    v_exp_f32 v20, v20
    v_exp_f32 v21, v21
    v_exp_f32 v22, v22
    v_exp_f32 v23, v23
    v_add_f32 v8, v8, v20
    v_add_f32 v8, v8, v21
    v_cvt_pk_bf16_f32 v102, v20, v21
    v_add_f32 v8, v8, v22
    v_add_f32 v8, v8, v23
    v_cvt_pk_bf16_f32 v103, v22, v23
    v_sub_f32 v16, v68, v12
    v_sub_f32 v17, v69, v12
    v_sub_f32 v18, v70, v12
    v_sub_f32 v19, v71, v12
    v_exp_f32 v16, v16
    v_exp_f32 v17, v17
    v_exp_f32 v18, v18
    v_exp_f32 v19, v19
    v_add_f32 v8, v8, v16
    v_add_f32 v8, v8, v17
    v_cvt_pk_bf16_f32 v104, v16, v17
    v_add_f32 v8, v8, v18
    v_add_f32 v8, v8, v19
    v_cvt_pk_bf16_f32 v105, v18, v19
    v_sub_f32 v20, v80, v12
    v_sub_f32 v21, v81, v12
    v_sub_f32 v22, v82, v12
    v_sub_f32 v23, v83, v12
    v_exp_f32 v20, v20
    v_exp_f32 v21, v21
    v_exp_f32 v22, v22
    v_exp_f32 v23, v23
    v_add_f32 v8, v8, v20
    v_add_f32 v8, v8, v21
    v_cvt_pk_bf16_f32 v106, v20, v21
    v_add_f32 v8, v8, v22
    v_add_f32 v8, v8, v23
    v_cvt_pk_bf16_f32 v107, v22, v23
    s_nop 3
    s_branch L_j1_1
L_rareA:
    s_nop 15
    s_nop 7
    v_max3_f32 v12, v36, v37, v38
    v_max3_f32 v12, v12, v39, v48
    v_max3_f32 v12, v12, v49, v50
    v_max3_f32 v12, v12, v51, v60
    v_max3_f32 v12, v12, v61, v62
    v_max3_f32 v12, v12, v63, v72
    v_max3_f32 v12, v12, v73, v74
    v_max_f32 v12, v12, v75
    v_mov_b32 v13, v12
    s_nop 1
    v_permlane16_swap_b32 v13, v12
    s_nop 1
    v_max_f32 v12, v13, v12
    v_mov_b32 v13, v12
    s_nop 1
    v_permlane32_swap_b32 v13, v12
    s_nop 1
    v_max_f32 v12, v13, v12
    v_add_f32 v12, 0x42080000, v12
    v_max_f32 v12, 0, v12
    v_sub_f32 v24, v24, v12
    v_sub_f32 v25, v25, v12
    v_sub_f32 v26, v26, v12
    v_sub_f32 v27, v27, v12
    v_exp_f32 v14, -v12
    s_nop 0
    v_mul_f32 v9, v9, v14
    v_lshlrev_b32 v16, 16, v84
    v_and_b32 v17, 0xffff0000, v84
    v_mul_f32 v16, v16, v14
    v_mul_f32 v17, v17, v14
    v_cvt_pk_bf16_f32 v84, v16, v17
    v_lshlrev_b32 v16, 16, v85
    v_and_b32 v17, 0xffff0000, v85
    v_mul_f32 v16, v16, v14
    v_mul_f32 v17, v17, v14
    v_cvt_pk_bf16_f32 v85, v16, v17
    v_lshlrev_b32 v16, 16, v86
    v_and_b32 v17, 0xffff0000, v86
    v_mul_f32 v16, v16, v14
    v_mul_f32 v17, v17, v14
    v_cvt_pk_bf16_f32 v86, v16, v17
    v_lshlrev_b32 v16, 16, v87
    v_and_b32 v17, 0xffff0000, v87
    v_mul_f32 v16, v16, v14
    v_mul_f32 v17, v17, v14
    v_cvt_pk_bf16_f32 v87, v16, v17
    v_lshlrev_b32 v16, 16, v88
    v_and_b32 v17, 0xffff0000, v88
    v_mul_f32 v16, v16, v14
    v_mul_f32 v17, v17, v14
    v_cvt_pk_bf16_f32 v88, v16, v17
    v_lshlrev_b32 v16, 16, v89
    v_and_b32 v17, 0xffff0000, v89
    v_mul_f32 v16, v16, v14
    v_mul_f32 v17, v17, v14
    v_cvt_pk_bf16_f32 v89, v16, v17
    v_lshlrev_b32 v16, 16, v90
    v_and_b32 v17, 0xffff0000, v90
    v_mul_f32 v16, v16, v14
    v_mul_f32 v17, v17, v14
    v_cvt_pk_bf16_f32 v90, v16, v17
    v_lshlrev_b32 v16, 16, v91
    v_and_b32 v17, 0xffff0000, v91
    v_mul_f32 v16, v16, v14
    v_mul_f32 v17, v17, v14
    v_cvt_pk_bf16_f32 v91, v16, v17
    v_and_b32 v13, 48, v0
    ds_bpermute_b32 v20, v13, v14 offset:0
    ds_bpermute_b32 v21, v13, v14 offset:4
    ds_bpermute_b32 v22, v13, v14 offset:8
    ds_bpermute_b32 v23, v13, v14 offset:12
    s_waitcnt lgkmcnt(0)
    v_accvgpr_read_b32 v16, a96
    v_accvgpr_read_b32 v17, a97
    v_accvgpr_read_b32 v18, a98
    v_accvgpr_read_b32 v19, a99
    v_mul_f32 v16, v16, v20
    v_mul_f32 v17, v17, v21
    v_mul_f32 v18, v18, v22
    v_mul_f32 v19, v19, v23
    v_accvgpr_write_b32 a96, v16
    v_accvgpr_write_b32 a97, v17
    v_accvgpr_write_b32 a98, v18
    v_accvgpr_write_b32 a99, v19
    v_accvgpr_read_b32 v16, a108
    v_accvgpr_read_b32 v17, a109
    v_accvgpr_read_b32 v18, a110
    v_accvgpr_read_b32 v19, a111
    v_mul_f32 v16, v16, v20
    v_mul_f32 v17, v17, v21
    v_mul_f32 v18, v18, v22
    v_mul_f32 v19, v19, v23
    v_accvgpr_write_b32 a108, v16
    v_accvgpr_write_b32 a109, v17
    v_accvgpr_write_b32 a110, v18
    v_accvgpr_write_b32 a111, v19
    v_accvgpr_read_b32 v16, a120
    v_accvgpr_read_b32 v17, a121
    v_accvgpr_read_b32 v18, a122
    v_accvgpr_read_b32 v19, a123
    v_mul_f32 v16, v16, v20
    v_mul_f32 v17, v17, v21
    v_mul_f32 v18, v18, v22
    v_mul_f32 v19, v19, v23
    v_accvgpr_write_b32 a120, v16
    v_accvgpr_write_b32 a121, v17
    v_accvgpr_write_b32 a122, v18
    v_accvgpr_write_b32 a123, v19
    v_accvgpr_read_b32 v16, a132
    v_accvgpr_read_b32 v17, a133
    v_accvgpr_read_b32 v18, a134
    v_accvgpr_read_b32 v19, a135
    v_mul_f32 v16, v16, v20
    v_mul_f32 v17, v17, v21
    v_mul_f32 v18, v18, v22
    v_mul_f32 v19, v19, v23
    v_accvgpr_write_b32 a132, v16
    v_accvgpr_write_b32 a133, v17
    v_accvgpr_write_b32 a134, v18
    v_accvgpr_write_b32 a135, v19
    v_accvgpr_read_b32 v16, a144
    v_accvgpr_read_b32 v17, a145
    v_accvgpr_read_b32 v18, a146
    v_accvgpr_read_b32 v19, a147
    v_mul_f32 v16, v16, v20
    v_mul_f32 v17, v17, v21
    v_mul_f32 v18, v18, v22
    v_mul_f32 v19, v19, v23
    v_accvgpr_write_b32 a144, v16
    v_accvgpr_write_b32 a145, v17
    v_accvgpr_write_b32 a146, v18
    v_accvgpr_write_b32 a147, v19
    v_accvgpr_read_b32 v16, a156
    v_accvgpr_read_b32 v17, a157
    v_accvgpr_read_b32 v18, a158
    v_accvgpr_read_b32 v19, a159
    v_mul_f32 v16, v16, v20
    v_mul_f32 v17, v17, v21
    v_mul_f32 v18, v18, v22
    v_mul_f32 v19, v19, v23
    v_accvgpr_write_b32 a156, v16
    v_accvgpr_write_b32 a157, v17
    v_accvgpr_write_b32 a158, v18
    v_accvgpr_write_b32 a159, v19
    v_mul_f32 v136, v136, v20
    v_mul_f32 v137, v137, v21
    v_mul_f32 v138, v138, v22
    v_mul_f32 v139, v139, v23
    v_mul_f32 v148, v148, v20
    v_mul_f32 v149, v149, v21
    v_mul_f32 v150, v150, v22
    v_mul_f32 v151, v151, v23
    v_mul_f32 v160, v160, v20
    v_mul_f32 v161, v161, v21
    v_mul_f32 v162, v162, v22
    v_mul_f32 v163, v163, v23
    v_mul_f32 v172, v172, v20
    v_mul_f32 v173, v173, v21
    v_mul_f32 v174, v174, v22
    v_mul_f32 v175, v175, v23
    v_mul_f32 v184, v184, v20
    v_mul_f32 v185, v185, v21
    v_mul_f32 v186, v186, v22
    v_mul_f32 v187, v187, v23
    v_mul_f32 v196, v196, v20
    v_mul_f32 v197, v197, v21
    v_mul_f32 v198, v198, v22
    v_mul_f32 v199, v199, v23
    v_mul_f32 v208, v208, v20
    v_mul_f32 v209, v209, v21
    v_mul_f32 v210, v210, v22
    v_mul_f32 v211, v211, v23
    v_mul_f32 v220, v220, v20
    v_mul_f32 v221, v221, v21
    v_mul_f32 v222, v222, v22
    v_mul_f32 v223, v223, v23
    v_mul_f32 v232, v232, v20
    v_mul_f32 v233, v233, v21
    v_mul_f32 v234, v234, v22
    v_mul_f32 v235, v235, v23
    v_mul_f32 v244, v244, v20
    v_mul_f32 v245, v245, v21
    v_mul_f32 v246, v246, v22
    v_mul_f32 v247, v247, v23
    v_accvgpr_read_b32 v16, a172
    v_accvgpr_read_b32 v17, a173
    v_accvgpr_read_b32 v18, a174
    v_accvgpr_read_b32 v19, a175
    v_mul_f32 v16, v16, v20
    v_mul_f32 v17, v17, v21
    v_mul_f32 v18, v18, v22
    v_mul_f32 v19, v19, v23
    v_accvgpr_write_b32 a172, v16
    v_accvgpr_write_b32 a173, v17
    v_accvgpr_write_b32 a174, v18
    v_accvgpr_write_b32 a175, v19
    v_sub_f32 v16, v36, v12
    v_sub_f32 v17, v37, v12
    v_sub_f32 v18, v38, v12
    v_sub_f32 v19, v39, v12
    v_exp_f32 v16, v16
    v_exp_f32 v17, v17
    v_exp_f32 v18, v18
    v_exp_f32 v19, v19
    v_add_f32 v6, v16, v17
    v_cvt_pk_bf16_f32 v108, v16, v17
    v_add_f32 v6, v6, v18
    v_add_f32 v6, v6, v19
    v_cvt_pk_bf16_f32 v109, v18, v19
    v_sub_f32 v20, v48, v12
    v_sub_f32 v21, v49, v12
    v_sub_f32 v22, v50, v12
    v_sub_f32 v23, v51, v12
    v_exp_f32 v20, v20
    v_exp_f32 v21, v21
    v_exp_f32 v22, v22
    v_exp_f32 v23, v23
    v_add_f32 v6, v6, v20
    v_add_f32 v6, v6, v21
    v_cvt_pk_bf16_f32 v110, v20, v21
    v_add_f32 v6, v6, v22
    v_add_f32 v6, v6, v23
    v_cvt_pk_bf16_f32 v111, v22, v23
    v_sub_f32 v16, v60, v12
    v_sub_f32 v17, v61, v12
    v_sub_f32 v18, v62, v12
    v_sub_f32 v19, v63, v12
    v_exp_f32 v16, v16
    v_exp_f32 v17, v17
    v_exp_f32 v18, v18
    v_exp_f32 v19, v19
    v_add_f32 v6, v6, v16
    v_add_f32 v6, v6, v17
    v_cvt_pk_bf16_f32 v112, v16, v17
    v_add_f32 v6, v6, v18
    v_add_f32 v6, v6, v19
    v_cvt_pk_bf16_f32 v113, v18, v19
    v_sub_f32 v20, v72, v12
    v_sub_f32 v21, v73, v12
    v_sub_f32 v22, v74, v12
    v_sub_f32 v23, v75, v12
    v_exp_f32 v20, v20
    v_exp_f32 v21, v21
    v_exp_f32 v22, v22
    v_exp_f32 v23, v23
    v_add_f32 v6, v6, v20
    v_add_f32 v6, v6, v21
    v_cvt_pk_bf16_f32 v114, v20, v21
    v_add_f32 v6, v6, v22
    v_add_f32 v6, v6, v23
    v_cvt_pk_bf16_f32 v115, v22, v23
    v_max3_f32 v12, v40, v41, v42
    v_max3_f32 v12, v12, v43, v52
    v_max3_f32 v12, v12, v53, v54
    v_max3_f32 v12, v12, v55, v64
    v_max3_f32 v12, v12, v65, v66
    v_max3_f32 v12, v12, v67, v76
    v_max3_f32 v12, v12, v77, v78
    v_max_f32 v12, v12, v79
    v_mov_b32 v13, v12
    s_nop 1
    v_permlane16_swap_b32 v13, v12
    s_nop 1
    v_max_f32 v12, v13, v12
    v_mov_b32 v13, v12
    s_nop 1
    v_permlane32_swap_b32 v13, v12
    s_nop 1
    v_max_f32 v12, v13, v12
    v_add_f32 v12, 0x42080000, v12
    v_max_f32 v12, 0, v12
    v_sub_f32 v28, v28, v12
    v_sub_f32 v29, v29, v12
    v_sub_f32 v30, v30, v12
    v_sub_f32 v31, v31, v12
    v_exp_f32 v14, -v12
    s_nop 0
    v_mul_f32 v10, v10, v14
    v_lshlrev_b32 v16, 16, v92
    v_and_b32 v17, 0xffff0000, v92
    v_mul_f32 v16, v16, v14
    v_mul_f32 v17, v17, v14
    v_cvt_pk_bf16_f32 v92, v16, v17
    v_lshlrev_b32 v16, 16, v93
    v_and_b32 v17, 0xffff0000, v93
    v_mul_f32 v16, v16, v14
    v_mul_f32 v17, v17, v14
    v_cvt_pk_bf16_f32 v93, v16, v17
    v_lshlrev_b32 v16, 16, v94
    v_and_b32 v17, 0xffff0000, v94
    v_mul_f32 v16, v16, v14
    v_mul_f32 v17, v17, v14
    v_cvt_pk_bf16_f32 v94, v16, v17
    v_lshlrev_b32 v16, 16, v95
    v_and_b32 v17, 0xffff0000, v95
    v_mul_f32 v16, v16, v14
    v_mul_f32 v17, v17, v14
    v_cvt_pk_bf16_f32 v95, v16, v17
    v_lshlrev_b32 v16, 16, v96
    v_and_b32 v17, 0xffff0000, v96
    v_mul_f32 v16, v16, v14
    v_mul_f32 v17, v17, v14
    v_cvt_pk_bf16_f32 v96, v16, v17
    v_lshlrev_b32 v16, 16, v97
    v_and_b32 v17, 0xffff0000, v97
    v_mul_f32 v16, v16, v14
    v_mul_f32 v17, v17, v14
    v_cvt_pk_bf16_f32 v97, v16, v17
    v_lshlrev_b32 v16, 16, v98
    v_and_b32 v17, 0xffff0000, v98
    v_mul_f32 v16, v16, v14
    v_mul_f32 v17, v17, v14
    v_cvt_pk_bf16_f32 v98, v16, v17
    v_lshlrev_b32 v16, 16, v99
    v_and_b32 v17, 0xffff0000, v99
    v_mul_f32 v16, v16, v14
    v_mul_f32 v17, v17, v14
    v_cvt_pk_bf16_f32 v99, v16, v17
    v_and_b32 v13, 48, v0
    ds_bpermute_b32 v20, v13, v14 offset:0
    ds_bpermute_b32 v21, v13, v14 offset:4
    ds_bpermute_b32 v22, v13, v14 offset:8
    ds_bpermute_b32 v23, v13, v14 offset:12
    s_waitcnt lgkmcnt(0)
    v_accvgpr_read_b32 v16, a100
    v_accvgpr_read_b32 v17, a101
    v_accvgpr_read_b32 v18, a102
    v_accvgpr_read_b32 v19, a103
    v_mul_f32 v16, v16, v20
    v_mul_f32 v17, v17, v21
    v_mul_f32 v18, v18, v22
    v_mul_f32 v19, v19, v23
    v_accvgpr_write_b32 a100, v16
    v_accvgpr_write_b32 a101, v17
    v_accvgpr_write_b32 a102, v18
    v_accvgpr_write_b32 a103, v19
    v_accvgpr_read_b32 v16, a112
    v_accvgpr_read_b32 v17, a113
    v_accvgpr_read_b32 v18, a114
    v_accvgpr_read_b32 v19, a115
    v_mul_f32 v16, v16, v20
    v_mul_f32 v17, v17, v21
    v_mul_f32 v18, v18, v22
    v_mul_f32 v19, v19, v23
    v_accvgpr_write_b32 a112, v16
    v_accvgpr_write_b32 a113, v17
    v_accvgpr_write_b32 a114, v18
    v_accvgpr_write_b32 a115, v19
    v_accvgpr_read_b32 v16, a124
    v_accvgpr_read_b32 v17, a125
    v_accvgpr_read_b32 v18, a126
    v_accvgpr_read_b32 v19, a127
    v_mul_f32 v16, v16, v20
    v_mul_f32 v17, v17, v21
    v_mul_f32 v18, v18, v22
    v_mul_f32 v19, v19, v23
    v_accvgpr_write_b32 a124, v16
    v_accvgpr_write_b32 a125, v17
    v_accvgpr_write_b32 a126, v18
    v_accvgpr_write_b32 a127, v19
    v_accvgpr_read_b32 v16, a136
    v_accvgpr_read_b32 v17, a137
    v_accvgpr_read_b32 v18, a138
    v_accvgpr_read_b32 v19, a139
    v_mul_f32 v16, v16, v20
    v_mul_f32 v17, v17, v21
    v_mul_f32 v18, v18, v22
    v_mul_f32 v19, v19, v23
    v_accvgpr_write_b32 a136, v16
    v_accvgpr_write_b32 a137, v17
    v_accvgpr_write_b32 a138, v18
    v_accvgpr_write_b32 a139, v19
    v_accvgpr_read_b32 v16, a148
    v_accvgpr_read_b32 v17, a149
    v_accvgpr_read_b32 v18, a150
    v_accvgpr_read_b32 v19, a151
    v_mul_f32 v16, v16, v20
    v_mul_f32 v17, v17, v21
    v_mul_f32 v18, v18, v22
    v_mul_f32 v19, v19, v23
    v_accvgpr_write_b32 a148, v16
    v_accvgpr_write_b32 a149, v17
    v_accvgpr_write_b32 a150, v18
    v_accvgpr_write_b32 a151, v19
    v_accvgpr_read_b32 v16, a160
    v_accvgpr_read_b32 v17, a161
    v_accvgpr_read_b32 v18, a162
    v_accvgpr_read_b32 v19, a163
    v_mul_f32 v16, v16, v20
    v_mul_f32 v17, v17, v21
    v_mul_f32 v18, v18, v22
    v_mul_f32 v19, v19, v23
    v_accvgpr_write_b32 a160, v16
    v_accvgpr_write_b32 a161, v17
    v_accvgpr_write_b32 a162, v18
    v_accvgpr_write_b32 a163, v19
    v_mul_f32 v140, v140, v20
    v_mul_f32 v141, v141, v21
    v_mul_f32 v142, v142, v22
    v_mul_f32 v143, v143, v23
    v_mul_f32 v152, v152, v20
    v_mul_f32 v153, v153, v21
    v_mul_f32 v154, v154, v22
    v_mul_f32 v155, v155, v23
    v_mul_f32 v164, v164, v20
    v_mul_f32 v165, v165, v21
    v_mul_f32 v166, v166, v22
    v_mul_f32 v167, v167, v23
    v_mul_f32 v176, v176, v20
    v_mul_f32 v177, v177, v21
    v_mul_f32 v178, v178, v22
    v_mul_f32 v179, v179, v23
    v_mul_f32 v188, v188, v20
    v_mul_f32 v189, v189, v21
    v_mul_f32 v190, v190, v22
    v_mul_f32 v191, v191, v23
    v_mul_f32 v200, v200, v20
    v_mul_f32 v201, v201, v21
    v_mul_f32 v202, v202, v22
    v_mul_f32 v203, v203, v23
    v_mul_f32 v212, v212, v20
    v_mul_f32 v213, v213, v21
    v_mul_f32 v214, v214, v22
    v_mul_f32 v215, v215, v23
    v_mul_f32 v224, v224, v20
    v_mul_f32 v225, v225, v21
    v_mul_f32 v226, v226, v22
    v_mul_f32 v227, v227, v23
    v_mul_f32 v236, v236, v20
    v_mul_f32 v237, v237, v21
    v_mul_f32 v238, v238, v22
    v_mul_f32 v239, v239, v23
    v_mul_f32 v248, v248, v20
    v_mul_f32 v249, v249, v21
    v_mul_f32 v250, v250, v22
    v_mul_f32 v251, v251, v23
    v_accvgpr_read_b32 v16, a176
    v_accvgpr_read_b32 v17, a177
    v_accvgpr_read_b32 v18, a178
    v_accvgpr_read_b32 v19, a179
    v_mul_f32 v16, v16, v20
    v_mul_f32 v17, v17, v21
    v_mul_f32 v18, v18, v22
    v_mul_f32 v19, v19, v23
    v_accvgpr_write_b32 a176, v16
    v_accvgpr_write_b32 a177, v17
    v_accvgpr_write_b32 a178, v18
    v_accvgpr_write_b32 a179, v19
    v_sub_f32 v16, v40, v12
    v_sub_f32 v17, v41, v12
    v_sub_f32 v18, v42, v12
    v_sub_f32 v19, v43, v12
    v_exp_f32 v16, v16
    v_exp_f32 v17, v17
    v_exp_f32 v18, v18
    v_exp_f32 v19, v19
    v_add_f32 v7, v16, v17
    v_cvt_pk_bf16_f32 v116, v16, v17
    v_add_f32 v7, v7, v18
    v_add_f32 v7, v7, v19
    v_cvt_pk_bf16_f32 v117, v18, v19
    v_sub_f32 v20, v52, v12
    v_sub_f32 v21, v53, v12
    v_sub_f32 v22, v54, v12
    v_sub_f32 v23, v55, v12
    v_exp_f32 v20, v20
    v_exp_f32 v21, v21
    v_exp_f32 v22, v22
    v_exp_f32 v23, v23
    v_add_f32 v7, v7, v20
    v_add_f32 v7, v7, v21
    v_cvt_pk_bf16_f32 v118, v20, v21
    v_add_f32 v7, v7, v22
    v_add_f32 v7, v7, v23
    v_cvt_pk_bf16_f32 v119, v22, v23
    v_sub_f32 v16, v64, v12
    v_sub_f32 v17, v65, v12
    v_sub_f32 v18, v66, v12
    v_sub_f32 v19, v67, v12
    v_exp_f32 v16, v16
    v_exp_f32 v17, v17
    v_exp_f32 v18, v18
    v_exp_f32 v19, v19
    v_add_f32 v7, v7, v16
    v_add_f32 v7, v7, v17
    v_cvt_pk_bf16_f32 v120, v16, v17
    v_add_f32 v7, v7, v18
    v_add_f32 v7, v7, v19
    v_cvt_pk_bf16_f32 v121, v18, v19
    v_sub_f32 v20, v76, v12
    v_sub_f32 v21, v77, v12
    v_sub_f32 v22, v78, v12
    v_sub_f32 v23, v79, v12
    v_exp_f32 v20, v20
    v_exp_f32 v21, v21
    v_exp_f32 v22, v22
    v_exp_f32 v23, v23
    v_add_f32 v7, v7, v20
    v_add_f32 v7, v7, v21
    v_cvt_pk_bf16_f32 v122, v20, v21
    v_add_f32 v7, v7, v22
    v_add_f32 v7, v7, v23
    v_cvt_pk_bf16_f32 v123, v22, v23
    v_max3_f32 v12, v44, v45, v46
    v_max3_f32 v12, v12, v47, v56
    v_max3_f32 v12, v12, v57, v58
    v_max3_f32 v12, v12, v59, v68
    v_max3_f32 v12, v12, v69, v70
    v_max3_f32 v12, v12, v71, v80
    v_max3_f32 v12, v12, v81, v82
    v_max_f32 v12, v12, v83
    v_mov_b32 v13, v12
    s_nop 1
    v_permlane16_swap_b32 v13, v12
    s_nop 1
    v_max_f32 v12, v13, v12
    v_mov_b32 v13, v12
    s_nop 1
    v_permlane32_swap_b32 v13, v12
    s_nop 1
    v_max_f32 v12, v13, v12
    v_add_f32 v12, 0x42080000, v12
    v_max_f32 v12, 0, v12
    v_sub_f32 v32, v32, v12
    v_sub_f32 v33, v33, v12
    v_sub_f32 v34, v34, v12
    v_sub_f32 v35, v35, v12
    v_exp_f32 v14, -v12
    s_nop 0
    v_mul_f32 v11, v11, v14
    v_lshlrev_b32 v16, 16, v100
    v_and_b32 v17, 0xffff0000, v100
    v_mul_f32 v16, v16, v14
    v_mul_f32 v17, v17, v14
    v_cvt_pk_bf16_f32 v100, v16, v17
    v_lshlrev_b32 v16, 16, v101
    v_and_b32 v17, 0xffff0000, v101
    v_mul_f32 v16, v16, v14
    v_mul_f32 v17, v17, v14
    v_cvt_pk_bf16_f32 v101, v16, v17
    v_lshlrev_b32 v16, 16, v102
    v_and_b32 v17, 0xffff0000, v102
    v_mul_f32 v16, v16, v14
    v_mul_f32 v17, v17, v14
    v_cvt_pk_bf16_f32 v102, v16, v17
    v_lshlrev_b32 v16, 16, v103
    v_and_b32 v17, 0xffff0000, v103
    v_mul_f32 v16, v16, v14
    v_mul_f32 v17, v17, v14
    v_cvt_pk_bf16_f32 v103, v16, v17
    v_lshlrev_b32 v16, 16, v104
    v_and_b32 v17, 0xffff0000, v104
    v_mul_f32 v16, v16, v14
    v_mul_f32 v17, v17, v14
    v_cvt_pk_bf16_f32 v104, v16, v17
    v_lshlrev_b32 v16, 16, v105
    v_and_b32 v17, 0xffff0000, v105
    v_mul_f32 v16, v16, v14
    v_mul_f32 v17, v17, v14
    v_cvt_pk_bf16_f32 v105, v16, v17
    v_lshlrev_b32 v16, 16, v106
    v_and_b32 v17, 0xffff0000, v106
    v_mul_f32 v16, v16, v14
    v_mul_f32 v17, v17, v14
    v_cvt_pk_bf16_f32 v106, v16, v17
    v_lshlrev_b32 v16, 16, v107
    v_and_b32 v17, 0xffff0000, v107
    v_mul_f32 v16, v16, v14
    v_mul_f32 v17, v17, v14
    v_cvt_pk_bf16_f32 v107, v16, v17
    v_and_b32 v13, 48, v0
    ds_bpermute_b32 v20, v13, v14 offset:0
    ds_bpermute_b32 v21, v13, v14 offset:4
    ds_bpermute_b32 v22, v13, v14 offset:8
    ds_bpermute_b32 v23, v13, v14 offset:12
    s_waitcnt lgkmcnt(0)
    v_accvgpr_read_b32 v16, a104
    v_accvgpr_read_b32 v17, a105
    v_accvgpr_read_b32 v18, a106
    v_accvgpr_read_b32 v19, a107
    v_mul_f32 v16, v16, v20
    v_mul_f32 v17, v17, v21
    v_mul_f32 v18, v18, v22
    v_mul_f32 v19, v19, v23
    v_accvgpr_write_b32 a104, v16
    v_accvgpr_write_b32 a105, v17
    v_accvgpr_write_b32 a106, v18
    v_accvgpr_write_b32 a107, v19
    v_accvgpr_read_b32 v16, a116
    v_accvgpr_read_b32 v17, a117
    v_accvgpr_read_b32 v18, a118
    v_accvgpr_read_b32 v19, a119
    v_mul_f32 v16, v16, v20
    v_mul_f32 v17, v17, v21
    v_mul_f32 v18, v18, v22
    v_mul_f32 v19, v19, v23
    v_accvgpr_write_b32 a116, v16
    v_accvgpr_write_b32 a117, v17
    v_accvgpr_write_b32 a118, v18
    v_accvgpr_write_b32 a119, v19
    v_accvgpr_read_b32 v16, a128
    v_accvgpr_read_b32 v17, a129
    v_accvgpr_read_b32 v18, a130
    v_accvgpr_read_b32 v19, a131
    v_mul_f32 v16, v16, v20
    v_mul_f32 v17, v17, v21
    v_mul_f32 v18, v18, v22
    v_mul_f32 v19, v19, v23
    v_accvgpr_write_b32 a128, v16
    v_accvgpr_write_b32 a129, v17
    v_accvgpr_write_b32 a130, v18
    v_accvgpr_write_b32 a131, v19
    v_accvgpr_read_b32 v16, a140
    v_accvgpr_read_b32 v17, a141
    v_accvgpr_read_b32 v18, a142
    v_accvgpr_read_b32 v19, a143
    v_mul_f32 v16, v16, v20
    v_mul_f32 v17, v17, v21
    v_mul_f32 v18, v18, v22
    v_mul_f32 v19, v19, v23
    v_accvgpr_write_b32 a140, v16
    v_accvgpr_write_b32 a141, v17
    v_accvgpr_write_b32 a142, v18
    v_accvgpr_write_b32 a143, v19
    v_accvgpr_read_b32 v16, a152
    v_accvgpr_read_b32 v17, a153
    v_accvgpr_read_b32 v18, a154
    v_accvgpr_read_b32 v19, a155
    v_mul_f32 v16, v16, v20
    v_mul_f32 v17, v17, v21
    v_mul_f32 v18, v18, v22
    v_mul_f32 v19, v19, v23
    v_accvgpr_write_b32 a152, v16
    v_accvgpr_write_b32 a153, v17
    v_accvgpr_write_b32 a154, v18
    v_accvgpr_write_b32 a155, v19
    v_mul_f32 v132, v132, v20
    v_mul_f32 v133, v133, v21
    v_mul_f32 v134, v134, v22
    v_mul_f32 v135, v135, v23
    v_mul_f32 v144, v144, v20
    v_mul_f32 v145, v145, v21
    v_mul_f32 v146, v146, v22
    v_mul_f32 v147, v147, v23
    v_mul_f32 v156, v156, v20
    v_mul_f32 v157, v157, v21
    v_mul_f32 v158, v158, v22
    v_mul_f32 v159, v159, v23
    v_mul_f32 v168, v168, v20
    v_mul_f32 v169, v169, v21
    v_mul_f32 v170, v170, v22
    v_mul_f32 v171, v171, v23
    v_mul_f32 v180, v180, v20
    v_mul_f32 v181, v181, v21
    v_mul_f32 v182, v182, v22
    v_mul_f32 v183, v183, v23
    v_mul_f32 v192, v192, v20
    v_mul_f32 v193, v193, v21
    v_mul_f32 v194, v194, v22
    v_mul_f32 v195, v195, v23
    v_mul_f32 v204, v204, v20
    v_mul_f32 v205, v205, v21
    v_mul_f32 v206, v206, v22
    v_mul_f32 v207, v207, v23
    v_mul_f32 v216, v216, v20
    v_mul_f32 v217, v217, v21
    v_mul_f32 v218, v218, v22
    v_mul_f32 v219, v219, v23
    v_mul_f32 v228, v228, v20
    v_mul_f32 v229, v229, v21
    v_mul_f32 v230, v230, v22
    v_mul_f32 v231, v231, v23
    v_mul_f32 v240, v240, v20
    v_mul_f32 v241, v241, v21
    v_mul_f32 v242, v242, v22
    v_mul_f32 v243, v243, v23
    v_mul_f32 v252, v252, v20
    v_mul_f32 v253, v253, v21
    v_mul_f32 v254, v254, v22
    v_mul_f32 v255, v255, v23
    v_accvgpr_read_b32 v16, a180
    v_accvgpr_read_b32 v17, a181
    v_accvgpr_read_b32 v18, a182
    v_accvgpr_read_b32 v19, a183
    v_mul_f32 v16, v16, v20
    v_mul_f32 v17, v17, v21
    v_mul_f32 v18, v18, v22
    v_mul_f32 v19, v19, v23
    v_accvgpr_write_b32 a180, v16
    v_accvgpr_write_b32 a181, v17
    v_accvgpr_write_b32 a182, v18
    v_accvgpr_write_b32 a183, v19
    v_sub_f32 v16, v44, v12
    v_sub_f32 v17, v45, v12
    v_sub_f32 v18, v46, v12
    v_sub_f32 v19, v47, v12
    v_exp_f32 v16, v16
    v_exp_f32 v17, v17
    v_exp_f32 v18, v18
    v_exp_f32 v19, v19
    v_add_f32 v8, v16, v17
    v_cvt_pk_bf16_f32 v124, v16, v17
    v_add_f32 v8, v8, v18
    v_add_f32 v8, v8, v19
    v_cvt_pk_bf16_f32 v125, v18, v19
    v_sub_f32 v20, v56, v12
    v_sub_f32 v21, v57, v12
    v_sub_f32 v22, v58, v12
    v_sub_f32 v23, v59, v12
    v_exp_f32 v20, v20
    v_exp_f32 v21, v21
    v_exp_f32 v22, v22
    v_exp_f32 v23, v23
    v_add_f32 v8, v8, v20
    v_add_f32 v8, v8, v21
    v_cvt_pk_bf16_f32 v126, v20, v21
    v_add_f32 v8, v8, v22
    v_add_f32 v8, v8, v23
    v_cvt_pk_bf16_f32 v127, v22, v23
    v_sub_f32 v16, v68, v12
    v_sub_f32 v17, v69, v12
    v_sub_f32 v18, v70, v12
    v_sub_f32 v19, v71, v12
    v_exp_f32 v16, v16
    v_exp_f32 v17, v17
    v_exp_f32 v18, v18
    v_exp_f32 v19, v19
    v_add_f32 v8, v8, v16
    v_add_f32 v8, v8, v17
    v_cvt_pk_bf16_f32 v128, v16, v17
    v_add_f32 v8, v8, v18
    v_add_f32 v8, v8, v19
    v_cvt_pk_bf16_f32 v129, v18, v19
    v_sub_f32 v20, v80, v12
    v_sub_f32 v21, v81, v12
    v_sub_f32 v22, v82, v12
    v_sub_f32 v23, v83, v12
    v_exp_f32 v20, v20
    v_exp_f32 v21, v21
    v_exp_f32 v22, v22
    v_exp_f32 v23, v23
    v_add_f32 v8, v8, v20
    v_add_f32 v8, v8, v21
    v_cvt_pk_bf16_f32 v130, v20, v21
    v_add_f32 v8, v8, v22
    v_add_f32 v8, v8, v23
    v_cvt_pk_bf16_f32 v131, v22, v23
    s_nop 3
    s_branch L_jA
    .fill 64, 4, 0xbf800000
.section .rodata,"a"
.p2align 6
.amdhsa_kernel standalone__mha_softmax__near_ridge_kernel
  .amdhsa_next_free_vgpr 512
  .amdhsa_next_free_sgpr 96
  .amdhsa_accum_offset 256
  .amdhsa_group_segment_fixed_size 0
  .amdhsa_kernarg_size 48
  .amdhsa_user_sgpr_count 2
  .amdhsa_user_sgpr_kernarg_segment_ptr 1
  .amdhsa_system_sgpr_workgroup_id_x 1
.end_amdhsa_kernel
```
